```python
import torch

def _softmax(x, axis=-1):
    return torch.softmax(x, dim=axis)

def _gelu(x):
    return torch.nn.functional.gelu(x, approximate='tanh')

def _silu(x):
    return torch.nn.functional.silu(x)

def _sigmoid(x):
    return torch.sigmoid(x)

def _layernorm(x, axis=-1, eps=1e-05):
    m = x.mean(dim=axis, keepdim=True)
    v = x.var(dim=axis, keepdim=True, unbiased=False)
    return (x - m) / torch.sqrt(v + eps)

def _scatter_add(tgt, idx, src, axis=0):
    return tgt.clone().index_add_(axis, idx, src)

def _segment_sum(src, seg, n):
    out = torch.zeros((n,) + src.shape[1:], dtype=src.dtype)
    return out.index_add_(0, seg, src)

def _pad(x, pw):
    flat = tuple((v for pair in reversed(pw) for v in pair))
    return torch.nn.functional.pad(x, flat)
kernel_name = 'sequential_preLN__memory_aug_recurrent_mem_tr__glu_gated_swiglu__prompt'

def setup_inputs():

    _w = lambda a: (lambda t: t.to(torch.bfloat16) if t.is_floating_point() else t)(torch.as_tensor(a))

    def _A_setup():
        B, S, Dm = (1, 2048, 512)
        H, Dh = (32, 128)
        M, seg = (8, 32)
        seg = min(seg, S)
        S = S // seg * seg
        return {'x': _w((lambda *s: torch.randn(*s, dtype=torch.bfloat16) * 0.05)(B, S, Dm)), 'mem0': _w((lambda *s: torch.randn(*s, dtype=torch.bfloat16) * 0.2)(B, M, Dm)), 'Wq': _w((lambda *s: torch.randn(*s, dtype=torch.bfloat16) * 1.6)(Dm, H, Dh) * Dm ** (-0.5)), 'Wk': _w((lambda *s: torch.randn(*s, dtype=torch.bfloat16) * 1.6)(Dm, H, Dh) * Dm ** (-0.5)), 'Wv': _w((lambda *s: torch.randn(*s, dtype=torch.bfloat16) * 0.2)(Dm, H, Dh) * Dm ** (-0.5)), 'Wo': _w((lambda *s: torch.randn(*s, dtype=torch.bfloat16) * 0.2)(H, Dh, Dm) * (H * Dh) ** (-0.5)), 'seg_len': seg}
    _A_in = _A_setup()

    def _B_setup():
        B, S, D, F = (1, 2048, 512, 1792)
        return {'x': _w((lambda *s: torch.randn(*s, dtype=torch.bfloat16) * 0.05)(B, S, D)), 'w1': _w((lambda *s: torch.randn(*s, dtype=torch.bfloat16) * 0.2)(D, F) * (2.0 / D) ** 0.5), 'w3': _w((lambda *s: torch.randn(*s, dtype=torch.bfloat16) * 0.2)(D, F) * (2.0 / D) ** 0.5), 'w2': _w((lambda *s: torch.randn(*s, dtype=torch.bfloat16) * 0.2)(F, D) * (2.0 / F) ** 0.5)}
    _B_in = _B_setup()
    return {'A_x': _A_in['x'], 'A_mem0': _A_in['mem0'], 'A_Wq': _A_in['Wq'], 'A_Wk': _A_in['Wk'], 'A_Wv': _A_in['Wv'], 'A_Wo': _A_in['Wo'], 'A_seg_len': _A_in['seg_len'], 'B_x': _B_in['x'], 'B_w1': _B_in['w1'], 'B_w3': _B_in['w3'], 'B_w2': _B_in['w2']}

def reference(A_x, A_mem0, A_Wq, A_Wk, A_Wv, A_Wo, A_seg_len, B_x, B_w1, B_w3, B_w2):

    def _A_ref(x, mem0, Wq, Wk, Wv, Wo, seg_len):
        B, S, Dm = x.shape
        H, Dh = (Wq.shape[1], Wq.shape[2])
        M = mem0.shape[1]
        scale = Dh ** (-0.5)
        n_seg = S // seg_len
        L = M + seg_len
        idx = torch.arange(L)
        mask = (idx[:, None] < M) | (idx[:, None] >= idx[None, :])
        mem = mem0
        outs = []
        for s in range(n_seg):
            xs = x[:, s * seg_len:(s + 1) * seg_len, :].clone()
            h = torch.concatenate([mem, xs], axis=1)
            q = torch.einsum('btd,dhe->bhte', h, Wq)
            k = torch.einsum('btd,dhe->bhte', h, Wk)
            v = torch.einsum('btd,dhe->bhte', h, Wv)
            scores = torch.einsum('bhqe,bhke->bhqk', q, k) * scale
            scores = torch.where(mask[None, None], scores, -1000000000.0)
            p = _softmax(scores, axis=-1)
            o = torch.einsum('bhqk,bhke->bhqe', p, v)
            o = torch.einsum('bhte,hed->btd', o, Wo)
            mem = o[:, :M, :].clone()
            outs.append(o[:, M:, :])
        return torch.concatenate(outs, axis=1)

    def _B_ref(x, w1, w3, w2):
        gate = torch.einsum('bsd,df->bsf', x, w1)
        up = torch.einsum('bsd,df->bsf', x, w3)
        h = _silu(gate) * up
        out = torch.einsum('bsf,fd->bsd', h, w2)
        return out
    x = A_x
    h = x + _A_ref(_layernorm(x, axis=-1), A_mem0, A_Wq, A_Wk, A_Wv, A_Wo, A_seg_len)
    h2 = h + _B_ref(_layernorm(h, axis=-1), B_w1, B_w3, B_w2)
    return h2
```

```asm
; @launch grid=(256,1,1) block=(256,1,1) lds=163840
.amdgcn_target "amdgcn-amd-amdhsa--gfx950"
.text
.globl sequential_preLN__memory_aug_recurrent_mem_tr__glu_gated_swiglu__prompt_kernel
.p2align 8
.type sequential_preLN__memory_aug_recurrent_mem_tr__glu_gated_swiglu__prompt_kernel,@function
sequential_preLN__memory_aug_recurrent_mem_tr__glu_gated_swiglu__prompt_kernel:
 s_cmp_ge_u32 s2, 256
 s_cbranch_scc1 L_abort
 s_load_dwordx4 s[32:35], s[0:1], 96
 s_load_dwordx16 s[8:23], s[0:1], 0
 s_load_dwordx8 s[24:31], s[0:1], 64
 s_getreg_b32 s6, hwreg(HW_REG_XCC_ID, 0, 4)
 v_lshrrev_b32 v1, 6, v0
 s_lshl_b32 s3, s6, 2
 s_add_u32 s3, s3, 128
 s_cmp_eq_u32 s6, 0
 s_cselect_b32 s3, 0, s3
 v_readfirstlane_b32 s4, v1
 v_mov_b32 v1, s3
 v_mov_b32 v2, 1
 v_mov_b32 v4, 0
 s_waitcnt lgkmcnt(0)
 s_mov_b32 s36, s34
 s_mov_b32 s37, s35
 s_mov_b32 s38, 0x10000000
 s_mov_b32 s39, 0x20000
 s_cmp_lg_u32 s4, 0
 s_cbranch_scc1 L_p1
 s_mov_b64 exec, 1
 global_atomic_add v3, v1, v2, s[32:33] sc0 sc1
 s_mov_b64 exec, -1
L_p1:
 s_getpc_b64 s[40:41]
L_pc:
 s_mov_b32 s42, 0
 s_mov_b32 s43, 0
 s_cmp_eq_u32 s6, 0
 s_cselect_b32 s42, L_chain-L_pc, s42
 s_cselect_b32 s43, L_kv-L_chain, s43
 s_cmp_eq_u32 s6, 1
 s_cselect_b32 s42, L_ffn-L_pc, s42
 s_cselect_b32 s43, L_end-L_ffn, s43
 s_cmp_eq_u32 s6, 2
 s_cselect_b32 s42, L_qo-L_pc, s42
 s_cselect_b32 s43, L_ffn-L_qo, s43
 s_cmp_eq_u32 s6, 3
 s_cselect_b32 s42, L_kv-L_pc, s42
 s_cselect_b32 s43, L_qo-L_kv, s43
 s_cmp_eq_u32 s6, 4
 s_cselect_b32 s42, L_qo-L_pc, s42
 s_cselect_b32 s43, L_ffn-L_qo, s43
 s_cmp_eq_u32 s6, 5
 s_cselect_b32 s42, L_kv-L_pc, s42
 s_cselect_b32 s43, L_qo-L_kv, s43
 s_cmp_eq_u32 s6, 6
 s_cselect_b32 s42, L_qo-L_pc, s42
 s_cselect_b32 s43, L_ffn-L_qo, s43
 s_cmp_eq_u32 s6, 7
 s_cselect_b32 s42, L_ffn-L_pc, s42
 s_cselect_b32 s43, L_end-L_ffn, s43
 s_add_u32 s40, s40, s42
 s_addc_u32 s41, s41, 0
 v_lshlrev_b32 v5, 7, v0
 v_cmp_gt_u32 vcc, s43, v5
 s_and_saveexec_b64 s[44:45], vcc
 s_cbranch_execz L_p2
 global_load_dword v6, v5, s[40:41]
L_p2:
 s_mov_b64 exec, -1
 s_cmp_lg_u32 s4, 0
 s_cbranch_scc1 L_p3
 s_waitcnt vmcnt(1)
L_p6:
 s_mov_b64 exec, 1
 ds_write_b32 v4, v3
 s_waitcnt lgkmcnt(0)
 s_mov_b64 exec, -1
L_p3:
 s_barrier
 ds_read_b32 v3, v4
 s_waitcnt lgkmcnt(0)
 v_readfirstlane_b32 s5, v3
 s_barrier
 s_cmp_ge_u32 s5, 32
 s_cbranch_scc1 L_abort
 s_mov_b32 s3, 0
 s_cmp_eq_u32 s6, 0
 s_cbranch_scc1 L_go_chain
 s_mov_b32 s3, 0
 s_cmp_eq_u32 s6, 1
 s_cbranch_scc1 L_go_ffn
 s_mov_b32 s3, 0
 s_cmp_eq_u32 s6, 2
 s_cbranch_scc1 L_go_qo
 s_mov_b32 s3, 0
 s_cmp_eq_u32 s6, 3
 s_cbranch_scc1 L_go_kv
 s_mov_b32 s3, 1
 s_cmp_eq_u32 s6, 4
 s_cbranch_scc1 L_go_qo
 s_mov_b32 s3, 1
 s_cmp_eq_u32 s6, 5
 s_cbranch_scc1 L_go_kv
 s_mov_b32 s3, 2
 s_cmp_eq_u32 s6, 6
 s_cbranch_scc1 L_go_qo
 s_mov_b32 s3, 1
 s_cmp_eq_u32 s6, 7
 s_cbranch_scc1 L_go_ffn
L_abort:
 s_endpgm
L_go_chain:
 s_branch L_chain
L_go_ffn:
 s_branch L_ffn
L_go_qo:
 s_branch L_qo
L_go_kv:
 s_branch L_kv
L_chain:
 s_mov_b32 s40, s12
 s_mov_b32 s41, s13
 s_mov_b32 s42, 0x400000
 s_mov_b32 s43, 0x20000
 s_mov_b32 s44, s14
 s_mov_b32 s45, s15
 s_mov_b32 s46, 0x400000
 s_mov_b32 s47, 0x20000
 s_mov_b32 s48, s16
 s_mov_b32 s49, s17
 s_mov_b32 s50, 0x400000
 s_mov_b32 s51, 0x20000
 s_mov_b32 s52, s18
 s_mov_b32 s53, s19
 s_mov_b32 s54, 0x400000
 s_mov_b32 s55, 0x20000
 v_and_b32 v20, 63, v0
 v_lshrrev_b32 v24, 4, v20
 s_lshr_b32 s100, s4, 1
 s_lshl_b32 s100, s100, 2
 v_or_b32 v24, s100, v24
 v_bfe_u32 v25, v20, 1, 3
 v_xor_b32 v24, v24, v25
 v_lshlrev_b32 v24, 5, v24
 v_and_b32 v25, 1, v20
 v_lshl_or_b32 v21, v25, 4, v24
 v_bfe_u32 v24, v20, 4, 1
 v_lshrrev_b32 v25, 5, v20
 s_and_b32 s100, s4, 1
 s_lshr_b32 s101, s4, 1
 v_lshl_add_u32 v26, v25, 5, v24
 s_lshl_b32 s3, s101, 4
 v_add_u32 v26, s3, v26
 s_lshl_b32 s3, s100, 1
 v_add_u32 v26, s3, v26
 v_lshl_add_u32 v22, v26, 10, v21
 v_lshlrev_b32 v24, 4, v24
 v_lshl_add_u32 v26, v25, 2, v24
 v_add_u32 v26, s4, v26
 v_lshl_add_u32 v21, v26, 13, v21
 s_lshl_b32 s65, s5, 8
 s_lshl_b32 s3, s5, 1
 s_add_u32 s3, s3, s101
 s_lshr_b32 s101, s3, 5
 s_lshl_b32 s101, s101, 7
 s_and_b32 s3, s3, 31
 s_add_u32 s3, s3, s101
 s_lshl_b32 s3, s3, 13
 s_lshl_b32 s100, s100, 12
 s_add_u32 s3, s3, s100
 v_lshl_add_u32 v27, v20, 6, s3
 s_lshl_b32 s100, s4, 12
 v_lshl_add_u32 v97, v20, 4, s100
 s_mul_i32 s100, s4, 12288
 s_add_u32 s100, s100, 0x10000
 v_lshl_add_u32 v98, v20, 4, s100
 v_lshrrev_b32 v24, 4, v20
 v_bfe_u32 v25, v20, 2, 2
 v_lshl_add_u32 v110, v24, 3, v25
 v_lshlrev_b32 v110, 8, v110
 v_and_b32 v24, 1, v24
 v_lshl_or_b32 v24, v24, 2, v25
 v_lshl_or_b32 v110, v24, 5, v110
 v_and_b32 v24, 3, v20
 v_lshl_or_b32 v110, v24, 3, v110
 s_lshl_b32 s100, s4, 6
 v_xor_b32 v23, s100, v110
 s_add_u32 s100, s5, 0
 s_and_b32 s82, s100, 3
 s_lshl_b32 s100, s82, 8
 s_lshl_b32 s101, s5, 17
 s_add_u32 s78, s100, s101
 s_add_u32 s100, s5, 1
 s_and_b32 s83, s100, 3
 s_lshl_b32 s100, s83, 8
 s_lshl_b32 s101, s5, 17
 s_add_u32 s79, s100, s101
 s_add_u32 s100, s5, 2
 s_and_b32 s84, s100, 3
 s_lshl_b32 s100, s84, 8
 s_lshl_b32 s101, s5, 17
 s_add_u32 s80, s100, s101
 s_add_u32 s100, s5, 3
 s_and_b32 s85, s100, 3
 s_lshl_b32 s100, s85, 8
 s_lshl_b32 s101, s5, 17
 s_add_u32 s81, s100, s101
 v_mov_b64 v[0:1], -1
 v_mov_b64 v[2:3], -1
 s_mul_i32 s62, s5, 8192
 s_add_u32 s62, s62, 14680064
 s_lshl_b32 s100, s4, 11
 s_sub_u32 s62, s62, s100
 v_bfe_u32 v24, v20, 4, 1
 v_and_b32 v25, 3, v20
 s_and_b32 s3, s5, 6
 v_add_u32 v26, s3, v24
 v_lshlrev_b32 v26, 10, v26
 v_lshl_add_u32 v26, v25, 2, v26
 s_lshr_b32 s100, s5, 3
 s_lshl_b32 s57, s100, 8
 s_lshl_b32 s58, s4, 6
 s_add_u32 s57, s57, s58
 s_and_b32 s59, s5, 1
 s_lshl_b32 s58, s59, 4
 s_add_u32 s57, s57, s58
 v_add_u32 v26, s57, v26
 global_load_ushort v8, v26, s[10:11] offset:0
 global_load_ushort v9, v26, s[10:11] offset:32
 global_load_ushort v10, v26, s[10:11] offset:2
 global_load_ushort v11, v26, s[10:11] offset:34
 s_lshl_b32 s101, s4, 10
 s_lshl_b32 s101, s4, 10
 s_add_u32 m0, s101, 0
 s_add_u32 s100, s65, 2097152
 buffer_load_dwordx4 v21, s[44:47], s100 offen  lds
 s_add_u32 m0, s101, 4096
 s_add_u32 s100, s65, 2162688
 buffer_load_dwordx4 v21, s[44:47], s100 offen  lds
 s_add_u32 m0, s101, 8192
 s_add_u32 s100, s65, 3145728
 buffer_load_dwordx4 v21, s[44:47], s100 offen  lds
 s_add_u32 m0, s101, 12288
 s_add_u32 s100, s65, 3211264
 buffer_load_dwordx4 v21, s[44:47], s100 offen  lds
 s_lshl_b32 s101, s4, 10
 s_add_u32 m0, s101, 16384
 s_add_u32 s100, s65, 2359296
 buffer_load_dwordx4 v21, s[44:47], s100 offen  lds
 s_add_u32 m0, s101, 20480
 s_add_u32 s100, s65, 2424832
 buffer_load_dwordx4 v21, s[44:47], s100 offen  lds
 s_add_u32 m0, s101, 24576
 s_add_u32 s100, s65, 3407872
 buffer_load_dwordx4 v21, s[44:47], s100 offen  lds
 s_add_u32 m0, s101, 28672
 s_add_u32 s100, s65, 3473408
 buffer_load_dwordx4 v21, s[44:47], s100 offen  lds
 s_lshl_b32 s101, s4, 10
 s_add_u32 m0, s101, 32768
 s_add_u32 s100, s65, 2621440
 buffer_load_dwordx4 v21, s[44:47], s100 offen  lds
 s_add_u32 m0, s101, 36864
 s_add_u32 s100, s65, 2686976
 buffer_load_dwordx4 v21, s[44:47], s100 offen  lds
 s_add_u32 m0, s101, 40960
 s_add_u32 s100, s65, 3670016
 buffer_load_dwordx4 v21, s[44:47], s100 offen  lds
 s_add_u32 m0, s101, 45056
 s_add_u32 s100, s65, 3735552
 buffer_load_dwordx4 v21, s[44:47], s100 offen  lds
 s_lshl_b32 s101, s4, 10
 s_add_u32 m0, s101, 49152
 s_add_u32 s100, s65, 2883584
 buffer_load_dwordx4 v21, s[44:47], s100 offen  lds
 s_add_u32 m0, s101, 53248
 s_add_u32 s100, s65, 2949120
 buffer_load_dwordx4 v21, s[44:47], s100 offen  lds
 s_add_u32 m0, s101, 57344
 s_add_u32 s100, s65, 3932160
 buffer_load_dwordx4 v21, s[44:47], s100 offen  lds
 s_add_u32 m0, s101, 61440
 s_add_u32 s100, s65, 3997696
 buffer_load_dwordx4 v21, s[44:47], s100 offen  lds
 s_lshl_b32 s101, s4, 10
 s_add_u32 m0, s101, 65536
 s_add_u32 s100, s78, 0
 buffer_load_dwordx4 v22, s[52:55], s100 offen  lds
 s_add_u32 m0, s101, 69632
 s_add_u32 s100, s78, 4096
 buffer_load_dwordx4 v22, s[52:55], s100 offen  lds
 s_add_u32 m0, s101, 73728
 s_add_u32 s100, s78, 8192
 buffer_load_dwordx4 v22, s[52:55], s100 offen  lds
 s_add_u32 m0, s101, 77824
 s_add_u32 s100, s78, 12288
 buffer_load_dwordx4 v22, s[52:55], s100 offen  lds
 s_waitcnt vmcnt(16)
 s_barrier
 s_and_b32 s3, s5, 6
 s_lshr_b32 s100, s5, 3
 v_bfe_u32 v24, v20, 4, 1
 v_and_b32 v25, 3, v20
 s_add_u32 s58, s62, 0
 buffer_store_dwordx4 v[0:3], v97, s[36:39], s58 offen offset:0
 buffer_store_dwordx4 v[0:3], v97, s[36:39], s58 offen offset:1024
 s_add_u32 s58, s62, 327680
 buffer_store_dwordx4 v[0:3], v97, s[36:39], s58 offen offset:0
 buffer_store_dwordx4 v[0:3], v97, s[36:39], s58 offen offset:1024
 s_add_u32 s58, s62, 655360
 buffer_store_dwordx4 v[0:3], v97, s[36:39], s58 offen offset:0
 buffer_store_dwordx4 v[0:3], v97, s[36:39], s58 offen offset:1024
 s_lshl_b32 s57, s4, 1
 s_lshr_b32 s58, s100, 1
 s_add_u32 s57, s57, s58
 s_lshl_b32 s57, s57, 2
 s_and_b32 s100, s100, 1
 s_lshl_b32 s100, s100, 1
 s_add_u32 s57, s57, s100
 s_add_u32 s57, s57, s59
 s_lshl_b32 s57, s57, 8
 s_lshl_b32 s3, s3, 5
 s_add_u32 s57, s57, s3
 v_lshlrev_b32 v103, 4, v24
 v_lshrrev_b32 v24, 1, v25
 v_lshl_or_b32 v103, v24, 5, v103
 v_and_b32 v24, 1, v25
 v_lshl_or_b32 v103, v24, 3, v103
 v_add_u32 v103, s57, v103
 s_mov_b32 s100, 15728640
 v_lshl_or_b32 v8, v9, 16, v8
 v_lshl_or_b32 v9, v11, 16, v10
 v_min_u32 v8, -2, v8
 v_min_u32 v9, -2, v9
 s_mov_b64 exec, 0x000f000f
 buffer_store_dwordx2 v[8:9], v103, s[36:39], s100 offen
 s_add_u32 s100, s100, 8192
 buffer_store_dwordx2 v[0:1], v103, s[36:39], s100 offen
 s_add_u32 s100, s100, 8192
 buffer_store_dwordx2 v[0:1], v103, s[36:39], s100 offen
 s_mov_b64 exec, -1
 s_lshl_b32 s101, s4, 10
 s_add_u32 m0, s101, 81920
 s_add_u32 s100, s79, 0
 buffer_load_dwordx4 v22, s[52:55], s100 offen  lds
 s_add_u32 m0, s101, 86016
 s_add_u32 s100, s79, 4096
 buffer_load_dwordx4 v22, s[52:55], s100 offen  lds
 s_add_u32 m0, s101, 90112
 s_add_u32 s100, s79, 8192
 buffer_load_dwordx4 v22, s[52:55], s100 offen  lds
 s_add_u32 m0, s101, 94208
 s_add_u32 s100, s79, 12288
 buffer_load_dwordx4 v22, s[52:55], s100 offen  lds
 v_add_u32 v24, 0, v23
 v_xor_b32 v25, 32, v24
 ds_read_b64_tr_b16 v[0:1], v24 offset:0
 ds_read_b64_tr_b16 v[2:3], v24 offset:1024
 ds_read_b64_tr_b16 v[4:5], v24 offset:8192
 ds_read_b64_tr_b16 v[6:7], v24 offset:9216
 ds_read_b64_tr_b16 v[8:9], v25 offset:0
 ds_read_b64_tr_b16 v[10:11], v25 offset:1024
 ds_read_b64_tr_b16 v[12:13], v25 offset:8192
 ds_read_b64_tr_b16 v[14:15], v25 offset:9216
 v_add_u32 v24, 0, v97
 s_waitcnt lgkmcnt(0)
 s_barrier
 ds_write_b128 v24, v[0:3] offset:0
 ds_write_b128 v24, v[4:7] offset:1024
 ds_write_b128 v24, v[8:11] offset:2048
 ds_write_b128 v24, v[12:15] offset:3072
 s_waitcnt lgkmcnt(0)
 s_waitcnt vmcnt(16)
 s_barrier
 s_lshl_b32 s101, s4, 10
 s_add_u32 m0, s101, 98304
 s_add_u32 s100, s80, 0
 buffer_load_dwordx4 v22, s[52:55], s100 offen  lds
 s_add_u32 m0, s101, 102400
 s_add_u32 s100, s80, 4096
 buffer_load_dwordx4 v22, s[52:55], s100 offen  lds
 s_add_u32 m0, s101, 106496
 s_add_u32 s100, s80, 8192
 buffer_load_dwordx4 v22, s[52:55], s100 offen  lds
 s_add_u32 m0, s101, 110592
 s_add_u32 s100, s80, 12288
 buffer_load_dwordx4 v22, s[52:55], s100 offen  lds
 v_add_u32 v24, 16384, v23
 v_xor_b32 v25, 32, v24
 ds_read_b64_tr_b16 v[0:1], v24 offset:0
 ds_read_b64_tr_b16 v[2:3], v24 offset:1024
 ds_read_b64_tr_b16 v[4:5], v24 offset:8192
 ds_read_b64_tr_b16 v[6:7], v24 offset:9216
 ds_read_b64_tr_b16 v[8:9], v25 offset:0
 ds_read_b64_tr_b16 v[10:11], v25 offset:1024
 ds_read_b64_tr_b16 v[12:13], v25 offset:8192
 ds_read_b64_tr_b16 v[14:15], v25 offset:9216
 v_add_u32 v24, 16384, v97
 s_waitcnt lgkmcnt(0)
 s_barrier
 ds_write_b128 v24, v[0:3] offset:0
 ds_write_b128 v24, v[4:7] offset:1024
 ds_write_b128 v24, v[8:11] offset:2048
 ds_write_b128 v24, v[12:15] offset:3072
 s_waitcnt lgkmcnt(0)
 s_waitcnt vmcnt(16)
 s_barrier
 s_lshl_b32 s101, s4, 10
 s_add_u32 m0, s101, 147456
 s_add_u32 s100, s81, 0
 buffer_load_dwordx4 v22, s[52:55], s100 offen  lds
 s_add_u32 m0, s101, 151552
 s_add_u32 s100, s81, 4096
 buffer_load_dwordx4 v22, s[52:55], s100 offen  lds
 s_add_u32 m0, s101, 155648
 s_add_u32 s100, s81, 8192
 buffer_load_dwordx4 v22, s[52:55], s100 offen  lds
 s_add_u32 m0, s101, 159744
 s_add_u32 s100, s81, 12288
 buffer_load_dwordx4 v22, s[52:55], s100 offen  lds
 v_add_u32 v24, 32768, v23
 v_xor_b32 v25, 32, v24
 ds_read_b64_tr_b16 v[0:1], v24 offset:0
 ds_read_b64_tr_b16 v[2:3], v24 offset:1024
 ds_read_b64_tr_b16 v[4:5], v24 offset:8192
 ds_read_b64_tr_b16 v[6:7], v24 offset:9216
 ds_read_b64_tr_b16 v[8:9], v25 offset:0
 ds_read_b64_tr_b16 v[10:11], v25 offset:1024
 ds_read_b64_tr_b16 v[12:13], v25 offset:8192
 ds_read_b64_tr_b16 v[14:15], v25 offset:9216
 v_add_u32 v24, 32768, v97
 s_waitcnt lgkmcnt(0)
 s_barrier
 ds_write_b128 v24, v[0:3] offset:0
 ds_write_b128 v24, v[4:7] offset:1024
 ds_write_b128 v24, v[8:11] offset:2048
 ds_write_b128 v24, v[12:15] offset:3072
 s_waitcnt lgkmcnt(0)
 s_waitcnt vmcnt(16)
 s_barrier
 s_lshl_b32 s101, s4, 10
 s_add_u32 m0, s101, 114688
 s_add_u32 s100, s78, 65536
 buffer_load_dwordx4 v22, s[52:55], s100 offen  lds
 s_add_u32 m0, s101, 118784
 s_add_u32 s100, s78, 69632
 buffer_load_dwordx4 v22, s[52:55], s100 offen  lds
 s_add_u32 m0, s101, 122880
 s_add_u32 s100, s78, 73728
 buffer_load_dwordx4 v22, s[52:55], s100 offen  lds
 s_add_u32 m0, s101, 126976
 s_add_u32 s100, s78, 77824
 buffer_load_dwordx4 v22, s[52:55], s100 offen  lds
 v_add_u32 v24, 49152, v23
 v_xor_b32 v25, 32, v24
 ds_read_b64_tr_b16 v[0:1], v24 offset:0
 ds_read_b64_tr_b16 v[2:3], v24 offset:1024
 ds_read_b64_tr_b16 v[4:5], v24 offset:8192
 ds_read_b64_tr_b16 v[6:7], v24 offset:9216
 ds_read_b64_tr_b16 v[8:9], v25 offset:0
 ds_read_b64_tr_b16 v[10:11], v25 offset:1024
 ds_read_b64_tr_b16 v[12:13], v25 offset:8192
 ds_read_b64_tr_b16 v[14:15], v25 offset:9216
 v_add_u32 v24, 49152, v97
 s_waitcnt lgkmcnt(0)
 s_barrier
 ds_write_b128 v24, v[0:3] offset:0
 ds_write_b128 v24, v[4:7] offset:1024
 ds_write_b128 v24, v[8:11] offset:2048
 ds_write_b128 v24, v[12:15] offset:3072
 s_waitcnt lgkmcnt(0)
 s_waitcnt vmcnt(16)
 s_barrier
 s_lshl_b32 s101, s4, 10
 s_add_u32 m0, s101, 131072
 s_add_u32 s100, s79, 65536
 buffer_load_dwordx4 v22, s[52:55], s100 offen  lds
 s_add_u32 m0, s101, 135168
 s_add_u32 s100, s79, 69632
 buffer_load_dwordx4 v22, s[52:55], s100 offen  lds
 s_add_u32 m0, s101, 139264
 s_add_u32 s100, s79, 73728
 buffer_load_dwordx4 v22, s[52:55], s100 offen  lds
 s_add_u32 m0, s101, 143360
 s_add_u32 s100, s79, 77824
 buffer_load_dwordx4 v22, s[52:55], s100 offen  lds
 s_cmp_lg_u32 s4, s82
 s_cbranch_scc1 L1
 v_add_u32 v24, 65536, v110
 v_xor_b32 v25, 0, v24
 ds_read_b64_tr_b16 v[176:177], v25 offset:0
 ds_read_b64_tr_b16 v[178:179], v25 offset:1024
 ds_read_b64_tr_b16 v[180:181], v25 offset:8192
 ds_read_b64_tr_b16 v[182:183], v25 offset:9216
 v_xor_b32 v25, 32, v24
 ds_read_b64_tr_b16 v[192:193], v25 offset:0
 ds_read_b64_tr_b16 v[194:195], v25 offset:1024
 ds_read_b64_tr_b16 v[196:197], v25 offset:8192
 ds_read_b64_tr_b16 v[198:199], v25 offset:9216
 v_xor_b32 v25, 64, v24
 ds_read_b64_tr_b16 v[208:209], v25 offset:0
 ds_read_b64_tr_b16 v[210:211], v25 offset:1024
 ds_read_b64_tr_b16 v[212:213], v25 offset:8192
 ds_read_b64_tr_b16 v[214:215], v25 offset:9216
 v_xor_b32 v25, 96, v24
 ds_read_b64_tr_b16 v[224:225], v25 offset:0
 ds_read_b64_tr_b16 v[226:227], v25 offset:1024
 ds_read_b64_tr_b16 v[228:229], v25 offset:8192
 ds_read_b64_tr_b16 v[230:231], v25 offset:9216
 v_xor_b32 v25, 128, v24
 ds_read_b64_tr_b16 v[240:241], v25 offset:0
 ds_read_b64_tr_b16 v[242:243], v25 offset:1024
 ds_read_b64_tr_b16 v[244:245], v25 offset:8192
 ds_read_b64_tr_b16 v[246:247], v25 offset:9216
 v_xor_b32 v25, 160, v24
 ds_read_b64_tr_b16 v[32:33], v25 offset:0
 ds_read_b64_tr_b16 v[34:35], v25 offset:1024
 ds_read_b64_tr_b16 v[36:37], v25 offset:8192
 ds_read_b64_tr_b16 v[38:39], v25 offset:9216
 v_xor_b32 v25, 192, v24
 ds_read_b64_tr_b16 v[48:49], v25 offset:0
 ds_read_b64_tr_b16 v[50:51], v25 offset:1024
 ds_read_b64_tr_b16 v[52:53], v25 offset:8192
 ds_read_b64_tr_b16 v[54:55], v25 offset:9216
 v_xor_b32 v25, 224, v24
 ds_read_b64_tr_b16 v[64:65], v25 offset:0
 ds_read_b64_tr_b16 v[66:67], v25 offset:1024
 ds_read_b64_tr_b16 v[68:69], v25 offset:8192
 ds_read_b64_tr_b16 v[70:71], v25 offset:9216
L1:
 s_waitcnt lgkmcnt(0)
 s_waitcnt vmcnt(16)
 s_barrier
 s_cmp_lg_u32 s4, 0
 s_cbranch_scc1 L2
 v_mov_b32 v24, 192
 v_mov_b32 v25, 1
 s_mov_b64 exec, 1
 global_atomic_add v24, v25, s[32:33] sc1
 s_mov_b64 exec, -1
L2:
 s_lshl_b32 s101, s4, 10
 s_add_u32 m0, s101, 65536
 s_add_u32 s100, s80, 65536
 buffer_load_dwordx4 v22, s[52:55], s100 offen  lds
 s_add_u32 m0, s101, 69632
 s_add_u32 s100, s80, 69632
 buffer_load_dwordx4 v22, s[52:55], s100 offen  lds
 s_add_u32 m0, s101, 73728
 s_add_u32 s100, s80, 73728
 buffer_load_dwordx4 v22, s[52:55], s100 offen  lds
 s_add_u32 m0, s101, 77824
 s_add_u32 s100, s80, 77824
 buffer_load_dwordx4 v22, s[52:55], s100 offen  lds
 s_cmp_lg_u32 s4, s83
 s_cbranch_scc1 L3
 v_add_u32 v24, 81920, v110
 v_xor_b32 v25, 0, v24
 ds_read_b64_tr_b16 v[176:177], v25 offset:0
 ds_read_b64_tr_b16 v[178:179], v25 offset:1024
 ds_read_b64_tr_b16 v[180:181], v25 offset:8192
 ds_read_b64_tr_b16 v[182:183], v25 offset:9216
 v_xor_b32 v25, 32, v24
 ds_read_b64_tr_b16 v[192:193], v25 offset:0
 ds_read_b64_tr_b16 v[194:195], v25 offset:1024
 ds_read_b64_tr_b16 v[196:197], v25 offset:8192
 ds_read_b64_tr_b16 v[198:199], v25 offset:9216
 v_xor_b32 v25, 64, v24
 ds_read_b64_tr_b16 v[208:209], v25 offset:0
 ds_read_b64_tr_b16 v[210:211], v25 offset:1024
 ds_read_b64_tr_b16 v[212:213], v25 offset:8192
 ds_read_b64_tr_b16 v[214:215], v25 offset:9216
 v_xor_b32 v25, 96, v24
 ds_read_b64_tr_b16 v[224:225], v25 offset:0
 ds_read_b64_tr_b16 v[226:227], v25 offset:1024
 ds_read_b64_tr_b16 v[228:229], v25 offset:8192
 ds_read_b64_tr_b16 v[230:231], v25 offset:9216
 v_xor_b32 v25, 128, v24
 ds_read_b64_tr_b16 v[240:241], v25 offset:0
 ds_read_b64_tr_b16 v[242:243], v25 offset:1024
 ds_read_b64_tr_b16 v[244:245], v25 offset:8192
 ds_read_b64_tr_b16 v[246:247], v25 offset:9216
 v_xor_b32 v25, 160, v24
 ds_read_b64_tr_b16 v[32:33], v25 offset:0
 ds_read_b64_tr_b16 v[34:35], v25 offset:1024
 ds_read_b64_tr_b16 v[36:37], v25 offset:8192
 ds_read_b64_tr_b16 v[38:39], v25 offset:9216
 v_xor_b32 v25, 192, v24
 ds_read_b64_tr_b16 v[48:49], v25 offset:0
 ds_read_b64_tr_b16 v[50:51], v25 offset:1024
 ds_read_b64_tr_b16 v[52:53], v25 offset:8192
 ds_read_b64_tr_b16 v[54:55], v25 offset:9216
 v_xor_b32 v25, 224, v24
 ds_read_b64_tr_b16 v[64:65], v25 offset:0
 ds_read_b64_tr_b16 v[66:67], v25 offset:1024
 ds_read_b64_tr_b16 v[68:69], v25 offset:8192
 ds_read_b64_tr_b16 v[70:71], v25 offset:9216
L3:
 s_waitcnt lgkmcnt(0)
 s_waitcnt vmcnt(16)
 s_barrier
 s_lshl_b32 s101, s4, 10
 s_add_u32 m0, s101, 81920
 s_add_u32 s100, s81, 65536
 buffer_load_dwordx4 v22, s[52:55], s100 offen  lds
 s_add_u32 m0, s101, 86016
 s_add_u32 s100, s81, 69632
 buffer_load_dwordx4 v22, s[52:55], s100 offen  lds
 s_add_u32 m0, s101, 90112
 s_add_u32 s100, s81, 73728
 buffer_load_dwordx4 v22, s[52:55], s100 offen  lds
 s_add_u32 m0, s101, 94208
 s_add_u32 s100, s81, 77824
 buffer_load_dwordx4 v22, s[52:55], s100 offen  lds
 s_cmp_lg_u32 s4, s84
 s_cbranch_scc1 L4
 v_add_u32 v24, 98304, v110
 v_xor_b32 v25, 0, v24
 ds_read_b64_tr_b16 v[176:177], v25 offset:0
 ds_read_b64_tr_b16 v[178:179], v25 offset:1024
 ds_read_b64_tr_b16 v[180:181], v25 offset:8192
 ds_read_b64_tr_b16 v[182:183], v25 offset:9216
 v_xor_b32 v25, 32, v24
 ds_read_b64_tr_b16 v[192:193], v25 offset:0
 ds_read_b64_tr_b16 v[194:195], v25 offset:1024
 ds_read_b64_tr_b16 v[196:197], v25 offset:8192
 ds_read_b64_tr_b16 v[198:199], v25 offset:9216
 v_xor_b32 v25, 64, v24
 ds_read_b64_tr_b16 v[208:209], v25 offset:0
 ds_read_b64_tr_b16 v[210:211], v25 offset:1024
 ds_read_b64_tr_b16 v[212:213], v25 offset:8192
 ds_read_b64_tr_b16 v[214:215], v25 offset:9216
 v_xor_b32 v25, 96, v24
 ds_read_b64_tr_b16 v[224:225], v25 offset:0
 ds_read_b64_tr_b16 v[226:227], v25 offset:1024
 ds_read_b64_tr_b16 v[228:229], v25 offset:8192
 ds_read_b64_tr_b16 v[230:231], v25 offset:9216
 v_xor_b32 v25, 128, v24
 ds_read_b64_tr_b16 v[240:241], v25 offset:0
 ds_read_b64_tr_b16 v[242:243], v25 offset:1024
 ds_read_b64_tr_b16 v[244:245], v25 offset:8192
 ds_read_b64_tr_b16 v[246:247], v25 offset:9216
 v_xor_b32 v25, 160, v24
 ds_read_b64_tr_b16 v[32:33], v25 offset:0
 ds_read_b64_tr_b16 v[34:35], v25 offset:1024
 ds_read_b64_tr_b16 v[36:37], v25 offset:8192
 ds_read_b64_tr_b16 v[38:39], v25 offset:9216
 v_xor_b32 v25, 192, v24
 ds_read_b64_tr_b16 v[48:49], v25 offset:0
 ds_read_b64_tr_b16 v[50:51], v25 offset:1024
 ds_read_b64_tr_b16 v[52:53], v25 offset:8192
 ds_read_b64_tr_b16 v[54:55], v25 offset:9216
 v_xor_b32 v25, 224, v24
 ds_read_b64_tr_b16 v[64:65], v25 offset:0
 ds_read_b64_tr_b16 v[66:67], v25 offset:1024
 ds_read_b64_tr_b16 v[68:69], v25 offset:8192
 ds_read_b64_tr_b16 v[70:71], v25 offset:9216
L4:
 s_waitcnt lgkmcnt(0)
 s_waitcnt vmcnt(16)
 s_barrier
 s_lshl_b32 s101, s4, 10
 s_add_u32 m0, s101, 98304
 s_add_u32 s100, s65, 0
 buffer_load_dwordx4 v21, s[40:43], s100 offen  lds
 s_add_u32 m0, s101, 102400
 s_add_u32 s100, s65, 65536
 buffer_load_dwordx4 v21, s[40:43], s100 offen  lds
 s_add_u32 m0, s101, 106496
 s_add_u32 s100, s65, 1048576
 buffer_load_dwordx4 v21, s[40:43], s100 offen  lds
 s_add_u32 m0, s101, 110592
 s_add_u32 s100, s65, 1114112
 buffer_load_dwordx4 v21, s[40:43], s100 offen  lds
 s_cmp_lg_u32 s4, s85
 s_cbranch_scc1 L5
 v_add_u32 v24, 147456, v110
 v_xor_b32 v25, 0, v24
 ds_read_b64_tr_b16 v[176:177], v25 offset:0
 ds_read_b64_tr_b16 v[178:179], v25 offset:1024
 ds_read_b64_tr_b16 v[180:181], v25 offset:8192
 ds_read_b64_tr_b16 v[182:183], v25 offset:9216
 v_xor_b32 v25, 32, v24
 ds_read_b64_tr_b16 v[192:193], v25 offset:0
 ds_read_b64_tr_b16 v[194:195], v25 offset:1024
 ds_read_b64_tr_b16 v[196:197], v25 offset:8192
 ds_read_b64_tr_b16 v[198:199], v25 offset:9216
 v_xor_b32 v25, 64, v24
 ds_read_b64_tr_b16 v[208:209], v25 offset:0
 ds_read_b64_tr_b16 v[210:211], v25 offset:1024
 ds_read_b64_tr_b16 v[212:213], v25 offset:8192
 ds_read_b64_tr_b16 v[214:215], v25 offset:9216
 v_xor_b32 v25, 96, v24
 ds_read_b64_tr_b16 v[224:225], v25 offset:0
 ds_read_b64_tr_b16 v[226:227], v25 offset:1024
 ds_read_b64_tr_b16 v[228:229], v25 offset:8192
 ds_read_b64_tr_b16 v[230:231], v25 offset:9216
 v_xor_b32 v25, 128, v24
 ds_read_b64_tr_b16 v[240:241], v25 offset:0
 ds_read_b64_tr_b16 v[242:243], v25 offset:1024
 ds_read_b64_tr_b16 v[244:245], v25 offset:8192
 ds_read_b64_tr_b16 v[246:247], v25 offset:9216
 v_xor_b32 v25, 160, v24
 ds_read_b64_tr_b16 v[32:33], v25 offset:0
 ds_read_b64_tr_b16 v[34:35], v25 offset:1024
 ds_read_b64_tr_b16 v[36:37], v25 offset:8192
 ds_read_b64_tr_b16 v[38:39], v25 offset:9216
 v_xor_b32 v25, 192, v24
 ds_read_b64_tr_b16 v[48:49], v25 offset:0
 ds_read_b64_tr_b16 v[50:51], v25 offset:1024
 ds_read_b64_tr_b16 v[52:53], v25 offset:8192
 ds_read_b64_tr_b16 v[54:55], v25 offset:9216
 v_xor_b32 v25, 224, v24
 ds_read_b64_tr_b16 v[64:65], v25 offset:0
 ds_read_b64_tr_b16 v[66:67], v25 offset:1024
 ds_read_b64_tr_b16 v[68:69], v25 offset:8192
 ds_read_b64_tr_b16 v[70:71], v25 offset:9216
L5:
 s_waitcnt lgkmcnt(0)
 s_waitcnt vmcnt(16)
 s_barrier
 s_lshl_b32 s101, s4, 10
 s_add_u32 m0, s101, 147456
 s_add_u32 s100, s65, 2097152
 buffer_load_dwordx4 v21, s[40:43], s100 offen  lds
 s_add_u32 m0, s101, 151552
 s_add_u32 s100, s65, 2162688
 buffer_load_dwordx4 v21, s[40:43], s100 offen  lds
 s_add_u32 m0, s101, 155648
 s_add_u32 s100, s65, 3145728
 buffer_load_dwordx4 v21, s[40:43], s100 offen  lds
 s_add_u32 m0, s101, 159744
 s_add_u32 s100, s65, 3211264
 buffer_load_dwordx4 v21, s[40:43], s100 offen  lds
 s_cmp_lg_u32 s4, s82
 s_cbranch_scc1 L6
 v_add_u32 v24, 114688, v110
 v_xor_b32 v25, 0, v24
 ds_read_b64_tr_b16 v[184:185], v25 offset:0
 ds_read_b64_tr_b16 v[186:187], v25 offset:1024
 ds_read_b64_tr_b16 v[188:189], v25 offset:8192
 ds_read_b64_tr_b16 v[190:191], v25 offset:9216
 v_xor_b32 v25, 32, v24
 ds_read_b64_tr_b16 v[200:201], v25 offset:0
 ds_read_b64_tr_b16 v[202:203], v25 offset:1024
 ds_read_b64_tr_b16 v[204:205], v25 offset:8192
 ds_read_b64_tr_b16 v[206:207], v25 offset:9216
 v_xor_b32 v25, 64, v24
 ds_read_b64_tr_b16 v[216:217], v25 offset:0
 ds_read_b64_tr_b16 v[218:219], v25 offset:1024
 ds_read_b64_tr_b16 v[220:221], v25 offset:8192
 ds_read_b64_tr_b16 v[222:223], v25 offset:9216
 v_xor_b32 v25, 96, v24
 ds_read_b64_tr_b16 v[232:233], v25 offset:0
 ds_read_b64_tr_b16 v[234:235], v25 offset:1024
 ds_read_b64_tr_b16 v[236:237], v25 offset:8192
 ds_read_b64_tr_b16 v[238:239], v25 offset:9216
 v_xor_b32 v25, 128, v24
 ds_read_b64_tr_b16 v[248:249], v25 offset:0
 ds_read_b64_tr_b16 v[250:251], v25 offset:1024
 ds_read_b64_tr_b16 v[252:253], v25 offset:8192
 ds_read_b64_tr_b16 v[254:255], v25 offset:9216
 v_xor_b32 v25, 160, v24
 ds_read_b64_tr_b16 v[40:41], v25 offset:0
 ds_read_b64_tr_b16 v[42:43], v25 offset:1024
 ds_read_b64_tr_b16 v[44:45], v25 offset:8192
 ds_read_b64_tr_b16 v[46:47], v25 offset:9216
 v_xor_b32 v25, 192, v24
 ds_read_b64_tr_b16 v[56:57], v25 offset:0
 ds_read_b64_tr_b16 v[58:59], v25 offset:1024
 ds_read_b64_tr_b16 v[60:61], v25 offset:8192
 ds_read_b64_tr_b16 v[62:63], v25 offset:9216
 v_xor_b32 v25, 224, v24
 ds_read_b64_tr_b16 v[72:73], v25 offset:0
 ds_read_b64_tr_b16 v[74:75], v25 offset:1024
 ds_read_b64_tr_b16 v[76:77], v25 offset:8192
 ds_read_b64_tr_b16 v[78:79], v25 offset:9216
L6:
 s_waitcnt lgkmcnt(0)
 s_waitcnt vmcnt(16)
 s_barrier
 s_lshl_b32 s101, s4, 10
 s_add_u32 m0, s101, 114688
 s_add_u32 s100, s65, 262144
 buffer_load_dwordx4 v21, s[40:43], s100 offen  lds
 s_add_u32 m0, s101, 118784
 s_add_u32 s100, s65, 327680
 buffer_load_dwordx4 v21, s[40:43], s100 offen  lds
 s_add_u32 m0, s101, 122880
 s_add_u32 s100, s65, 1310720
 buffer_load_dwordx4 v21, s[40:43], s100 offen  lds
 s_add_u32 m0, s101, 126976
 s_add_u32 s100, s65, 1376256
 buffer_load_dwordx4 v21, s[40:43], s100 offen  lds
 s_cmp_lg_u32 s4, s83
 s_cbranch_scc1 L7
 v_add_u32 v24, 131072, v110
 v_xor_b32 v25, 0, v24
 ds_read_b64_tr_b16 v[184:185], v25 offset:0
 ds_read_b64_tr_b16 v[186:187], v25 offset:1024
 ds_read_b64_tr_b16 v[188:189], v25 offset:8192
 ds_read_b64_tr_b16 v[190:191], v25 offset:9216
 v_xor_b32 v25, 32, v24
 ds_read_b64_tr_b16 v[200:201], v25 offset:0
 ds_read_b64_tr_b16 v[202:203], v25 offset:1024
 ds_read_b64_tr_b16 v[204:205], v25 offset:8192
 ds_read_b64_tr_b16 v[206:207], v25 offset:9216
 v_xor_b32 v25, 64, v24
 ds_read_b64_tr_b16 v[216:217], v25 offset:0
 ds_read_b64_tr_b16 v[218:219], v25 offset:1024
 ds_read_b64_tr_b16 v[220:221], v25 offset:8192
 ds_read_b64_tr_b16 v[222:223], v25 offset:9216
 v_xor_b32 v25, 96, v24
 ds_read_b64_tr_b16 v[232:233], v25 offset:0
 ds_read_b64_tr_b16 v[234:235], v25 offset:1024
 ds_read_b64_tr_b16 v[236:237], v25 offset:8192
 ds_read_b64_tr_b16 v[238:239], v25 offset:9216
 v_xor_b32 v25, 128, v24
 ds_read_b64_tr_b16 v[248:249], v25 offset:0
 ds_read_b64_tr_b16 v[250:251], v25 offset:1024
 ds_read_b64_tr_b16 v[252:253], v25 offset:8192
 ds_read_b64_tr_b16 v[254:255], v25 offset:9216
 v_xor_b32 v25, 160, v24
 ds_read_b64_tr_b16 v[40:41], v25 offset:0
 ds_read_b64_tr_b16 v[42:43], v25 offset:1024
 ds_read_b64_tr_b16 v[44:45], v25 offset:8192
 ds_read_b64_tr_b16 v[46:47], v25 offset:9216
 v_xor_b32 v25, 192, v24
 ds_read_b64_tr_b16 v[56:57], v25 offset:0
 ds_read_b64_tr_b16 v[58:59], v25 offset:1024
 ds_read_b64_tr_b16 v[60:61], v25 offset:8192
 ds_read_b64_tr_b16 v[62:63], v25 offset:9216
 v_xor_b32 v25, 224, v24
 ds_read_b64_tr_b16 v[72:73], v25 offset:0
 ds_read_b64_tr_b16 v[74:75], v25 offset:1024
 ds_read_b64_tr_b16 v[76:77], v25 offset:8192
 ds_read_b64_tr_b16 v[78:79], v25 offset:9216
L7:
 s_waitcnt lgkmcnt(0)
 s_waitcnt vmcnt(16)
 s_barrier
 s_lshl_b32 s101, s4, 10
 s_add_u32 m0, s101, 131072
 s_add_u32 s100, s65, 2359296
 buffer_load_dwordx4 v21, s[40:43], s100 offen  lds
 s_add_u32 m0, s101, 135168
 s_add_u32 s100, s65, 2424832
 buffer_load_dwordx4 v21, s[40:43], s100 offen  lds
 s_add_u32 m0, s101, 139264
 s_add_u32 s100, s65, 3407872
 buffer_load_dwordx4 v21, s[40:43], s100 offen  lds
 s_add_u32 m0, s101, 143360
 s_add_u32 s100, s65, 3473408
 buffer_load_dwordx4 v21, s[40:43], s100 offen  lds
 s_cmp_lg_u32 s4, s84
 s_cbranch_scc1 L8
 v_add_u32 v24, 65536, v110
 v_xor_b32 v25, 0, v24
 ds_read_b64_tr_b16 v[184:185], v25 offset:0
 ds_read_b64_tr_b16 v[186:187], v25 offset:1024
 ds_read_b64_tr_b16 v[188:189], v25 offset:8192
 ds_read_b64_tr_b16 v[190:191], v25 offset:9216
 v_xor_b32 v25, 32, v24
 ds_read_b64_tr_b16 v[200:201], v25 offset:0
 ds_read_b64_tr_b16 v[202:203], v25 offset:1024
 ds_read_b64_tr_b16 v[204:205], v25 offset:8192
 ds_read_b64_tr_b16 v[206:207], v25 offset:9216
 v_xor_b32 v25, 64, v24
 ds_read_b64_tr_b16 v[216:217], v25 offset:0
 ds_read_b64_tr_b16 v[218:219], v25 offset:1024
 ds_read_b64_tr_b16 v[220:221], v25 offset:8192
 ds_read_b64_tr_b16 v[222:223], v25 offset:9216
 v_xor_b32 v25, 96, v24
 ds_read_b64_tr_b16 v[232:233], v25 offset:0
 ds_read_b64_tr_b16 v[234:235], v25 offset:1024
 ds_read_b64_tr_b16 v[236:237], v25 offset:8192
 ds_read_b64_tr_b16 v[238:239], v25 offset:9216
 v_xor_b32 v25, 128, v24
 ds_read_b64_tr_b16 v[248:249], v25 offset:0
 ds_read_b64_tr_b16 v[250:251], v25 offset:1024
 ds_read_b64_tr_b16 v[252:253], v25 offset:8192
 ds_read_b64_tr_b16 v[254:255], v25 offset:9216
 v_xor_b32 v25, 160, v24
 ds_read_b64_tr_b16 v[40:41], v25 offset:0
 ds_read_b64_tr_b16 v[42:43], v25 offset:1024
 ds_read_b64_tr_b16 v[44:45], v25 offset:8192
 ds_read_b64_tr_b16 v[46:47], v25 offset:9216
 v_xor_b32 v25, 192, v24
 ds_read_b64_tr_b16 v[56:57], v25 offset:0
 ds_read_b64_tr_b16 v[58:59], v25 offset:1024
 ds_read_b64_tr_b16 v[60:61], v25 offset:8192
 ds_read_b64_tr_b16 v[62:63], v25 offset:9216
 v_xor_b32 v25, 224, v24
 ds_read_b64_tr_b16 v[72:73], v25 offset:0
 ds_read_b64_tr_b16 v[74:75], v25 offset:1024
 ds_read_b64_tr_b16 v[76:77], v25 offset:8192
 ds_read_b64_tr_b16 v[78:79], v25 offset:9216
L8:
 s_waitcnt lgkmcnt(0)
 s_waitcnt vmcnt(16)
 s_barrier
 s_lshl_b32 s101, s4, 10
 s_add_u32 m0, s101, 65536
 s_add_u32 s100, s65, 524288
 buffer_load_dwordx4 v21, s[40:43], s100 offen  lds
 s_add_u32 m0, s101, 69632
 s_add_u32 s100, s65, 589824
 buffer_load_dwordx4 v21, s[40:43], s100 offen  lds
 s_add_u32 m0, s101, 73728
 s_add_u32 s100, s65, 1572864
 buffer_load_dwordx4 v21, s[40:43], s100 offen  lds
 s_add_u32 m0, s101, 77824
 s_add_u32 s100, s65, 1638400
 buffer_load_dwordx4 v21, s[40:43], s100 offen  lds
 s_cmp_lg_u32 s4, s85
 s_cbranch_scc1 L9
 v_add_u32 v24, 81920, v110
 v_xor_b32 v25, 0, v24
 ds_read_b64_tr_b16 v[184:185], v25 offset:0
 ds_read_b64_tr_b16 v[186:187], v25 offset:1024
 ds_read_b64_tr_b16 v[188:189], v25 offset:8192
 ds_read_b64_tr_b16 v[190:191], v25 offset:9216
 v_xor_b32 v25, 32, v24
 ds_read_b64_tr_b16 v[200:201], v25 offset:0
 ds_read_b64_tr_b16 v[202:203], v25 offset:1024
 ds_read_b64_tr_b16 v[204:205], v25 offset:8192
 ds_read_b64_tr_b16 v[206:207], v25 offset:9216
 v_xor_b32 v25, 64, v24
 ds_read_b64_tr_b16 v[216:217], v25 offset:0
 ds_read_b64_tr_b16 v[218:219], v25 offset:1024
 ds_read_b64_tr_b16 v[220:221], v25 offset:8192
 ds_read_b64_tr_b16 v[222:223], v25 offset:9216
 v_xor_b32 v25, 96, v24
 ds_read_b64_tr_b16 v[232:233], v25 offset:0
 ds_read_b64_tr_b16 v[234:235], v25 offset:1024
 ds_read_b64_tr_b16 v[236:237], v25 offset:8192
 ds_read_b64_tr_b16 v[238:239], v25 offset:9216
 v_xor_b32 v25, 128, v24
 ds_read_b64_tr_b16 v[248:249], v25 offset:0
 ds_read_b64_tr_b16 v[250:251], v25 offset:1024
 ds_read_b64_tr_b16 v[252:253], v25 offset:8192
 ds_read_b64_tr_b16 v[254:255], v25 offset:9216
 v_xor_b32 v25, 160, v24
 ds_read_b64_tr_b16 v[40:41], v25 offset:0
 ds_read_b64_tr_b16 v[42:43], v25 offset:1024
 ds_read_b64_tr_b16 v[44:45], v25 offset:8192
 ds_read_b64_tr_b16 v[46:47], v25 offset:9216
 v_xor_b32 v25, 192, v24
 ds_read_b64_tr_b16 v[56:57], v25 offset:0
 ds_read_b64_tr_b16 v[58:59], v25 offset:1024
 ds_read_b64_tr_b16 v[60:61], v25 offset:8192
 ds_read_b64_tr_b16 v[62:63], v25 offset:9216
 v_xor_b32 v25, 224, v24
 ds_read_b64_tr_b16 v[72:73], v25 offset:0
 ds_read_b64_tr_b16 v[74:75], v25 offset:1024
 ds_read_b64_tr_b16 v[76:77], v25 offset:8192
 ds_read_b64_tr_b16 v[78:79], v25 offset:9216
L9:
 s_waitcnt lgkmcnt(0)
 s_waitcnt vmcnt(16)
 s_barrier
 s_lshl_b32 s101, s4, 10
 s_add_u32 m0, s101, 81920
 s_add_u32 s100, s65, 2621440
 buffer_load_dwordx4 v21, s[40:43], s100 offen  lds
 s_add_u32 m0, s101, 86016
 s_add_u32 s100, s65, 2686976
 buffer_load_dwordx4 v21, s[40:43], s100 offen  lds
 s_add_u32 m0, s101, 90112
 s_add_u32 s100, s65, 3670016
 buffer_load_dwordx4 v21, s[40:43], s100 offen  lds
 s_add_u32 m0, s101, 94208
 s_add_u32 s100, s65, 3735552
 buffer_load_dwordx4 v21, s[40:43], s100 offen  lds
 v_add_u32 v24, 98304, v23
 v_xor_b32 v25, 32, v24
 ds_read_b64_tr_b16 a[0:1], v24 offset:0
 ds_read_b64_tr_b16 a[2:3], v24 offset:1024
 ds_read_b64_tr_b16 a[4:5], v24 offset:8192
 ds_read_b64_tr_b16 a[6:7], v24 offset:9216
 ds_read_b64_tr_b16 a[8:9], v25 offset:0
 ds_read_b64_tr_b16 a[10:11], v25 offset:1024
 ds_read_b64_tr_b16 a[12:13], v25 offset:8192
 ds_read_b64_tr_b16 a[14:15], v25 offset:9216
 s_waitcnt lgkmcnt(0)
 s_waitcnt vmcnt(16)
 s_barrier
 s_lshl_b32 s101, s4, 10
 s_add_u32 m0, s101, 98304
 s_add_u32 s100, s65, 786432
 buffer_load_dwordx4 v21, s[40:43], s100 offen  lds
 s_add_u32 m0, s101, 102400
 s_add_u32 s100, s65, 851968
 buffer_load_dwordx4 v21, s[40:43], s100 offen  lds
 s_add_u32 m0, s101, 106496
 s_add_u32 s100, s65, 1835008
 buffer_load_dwordx4 v21, s[40:43], s100 offen  lds
 s_add_u32 m0, s101, 110592
 s_add_u32 s100, s65, 1900544
 buffer_load_dwordx4 v21, s[40:43], s100 offen  lds
 v_add_u32 v24, 147456, v23
 v_xor_b32 v25, 32, v24
 ds_read_b64_tr_b16 a[16:17], v24 offset:0
 ds_read_b64_tr_b16 a[18:19], v24 offset:1024
 ds_read_b64_tr_b16 a[20:21], v24 offset:8192
 ds_read_b64_tr_b16 a[22:23], v24 offset:9216
 ds_read_b64_tr_b16 a[24:25], v25 offset:0
 ds_read_b64_tr_b16 a[26:27], v25 offset:1024
 ds_read_b64_tr_b16 a[28:29], v25 offset:8192
 ds_read_b64_tr_b16 a[30:31], v25 offset:9216
 s_waitcnt lgkmcnt(0)
 s_waitcnt vmcnt(16)
 s_barrier
 s_lshl_b32 s101, s4, 10
 s_add_u32 m0, s101, 147456
 s_add_u32 s100, s65, 2883584
 buffer_load_dwordx4 v21, s[40:43], s100 offen  lds
 s_add_u32 m0, s101, 151552
 s_add_u32 s100, s65, 2949120
 buffer_load_dwordx4 v21, s[40:43], s100 offen  lds
 s_add_u32 m0, s101, 155648
 s_add_u32 s100, s65, 3932160
 buffer_load_dwordx4 v21, s[40:43], s100 offen  lds
 s_add_u32 m0, s101, 159744
 s_add_u32 s100, s65, 3997696
 buffer_load_dwordx4 v21, s[40:43], s100 offen  lds
 v_add_u32 v24, 114688, v23
 v_xor_b32 v25, 32, v24
 ds_read_b64_tr_b16 a[32:33], v24 offset:0
 ds_read_b64_tr_b16 a[34:35], v24 offset:1024
 ds_read_b64_tr_b16 a[36:37], v24 offset:8192
 ds_read_b64_tr_b16 a[38:39], v24 offset:9216
 ds_read_b64_tr_b16 a[40:41], v25 offset:0
 ds_read_b64_tr_b16 a[42:43], v25 offset:1024
 ds_read_b64_tr_b16 a[44:45], v25 offset:8192
 ds_read_b64_tr_b16 a[46:47], v25 offset:9216
 s_waitcnt lgkmcnt(0)
 s_waitcnt vmcnt(16)
 s_barrier
 s_lshl_b32 s101, s4, 10
 s_add_u32 m0, s101, 114688
 s_add_u32 s100, s65, 0
 buffer_load_dwordx4 v21, s[44:47], s100 offen  lds
 s_add_u32 m0, s101, 118784
 s_add_u32 s100, s65, 65536
 buffer_load_dwordx4 v21, s[44:47], s100 offen  lds
 s_add_u32 m0, s101, 122880
 s_add_u32 s100, s65, 1048576
 buffer_load_dwordx4 v21, s[44:47], s100 offen  lds
 s_add_u32 m0, s101, 126976
 s_add_u32 s100, s65, 1114112
 buffer_load_dwordx4 v21, s[44:47], s100 offen  lds
 v_add_u32 v24, 131072, v23
 v_xor_b32 v25, 32, v24
 ds_read_b64_tr_b16 a[48:49], v24 offset:0
 ds_read_b64_tr_b16 a[50:51], v24 offset:1024
 ds_read_b64_tr_b16 a[52:53], v24 offset:8192
 ds_read_b64_tr_b16 a[54:55], v24 offset:9216
 ds_read_b64_tr_b16 a[56:57], v25 offset:0
 ds_read_b64_tr_b16 a[58:59], v25 offset:1024
 ds_read_b64_tr_b16 a[60:61], v25 offset:8192
 ds_read_b64_tr_b16 a[62:63], v25 offset:9216
 s_waitcnt lgkmcnt(0)
 s_waitcnt vmcnt(16)
 s_barrier
 s_lshl_b32 s101, s4, 10
 s_add_u32 m0, s101, 131072
 s_add_u32 s100, s65, 262144
 buffer_load_dwordx4 v21, s[44:47], s100 offen  lds
 s_add_u32 m0, s101, 135168
 s_add_u32 s100, s65, 327680
 buffer_load_dwordx4 v21, s[44:47], s100 offen  lds
 s_add_u32 m0, s101, 139264
 s_add_u32 s100, s65, 1310720
 buffer_load_dwordx4 v21, s[44:47], s100 offen  lds
 s_add_u32 m0, s101, 143360
 s_add_u32 s100, s65, 1376256
 buffer_load_dwordx4 v21, s[44:47], s100 offen  lds
 v_add_u32 v24, 65536, v23
 v_xor_b32 v25, 32, v24
 ds_read_b64_tr_b16 a[64:65], v24 offset:0
 ds_read_b64_tr_b16 a[66:67], v24 offset:1024
 ds_read_b64_tr_b16 a[68:69], v24 offset:8192
 ds_read_b64_tr_b16 a[70:71], v24 offset:9216
 ds_read_b64_tr_b16 a[72:73], v25 offset:0
 ds_read_b64_tr_b16 a[74:75], v25 offset:1024
 ds_read_b64_tr_b16 a[76:77], v25 offset:8192
 ds_read_b64_tr_b16 a[78:79], v25 offset:9216
 s_waitcnt lgkmcnt(0)
 s_waitcnt vmcnt(16)
 s_barrier
 s_lshl_b32 s101, s4, 10
 s_add_u32 m0, s101, 65536
 s_add_u32 s100, s65, 524288
 buffer_load_dwordx4 v21, s[44:47], s100 offen  lds
 s_add_u32 m0, s101, 69632
 s_add_u32 s100, s65, 589824
 buffer_load_dwordx4 v21, s[44:47], s100 offen  lds
 s_add_u32 m0, s101, 73728
 s_add_u32 s100, s65, 1572864
 buffer_load_dwordx4 v21, s[44:47], s100 offen  lds
 s_add_u32 m0, s101, 77824
 s_add_u32 s100, s65, 1638400
 buffer_load_dwordx4 v21, s[44:47], s100 offen  lds
 v_add_u32 v24, 81920, v23
 v_xor_b32 v25, 32, v24
 ds_read_b64_tr_b16 a[80:81], v24 offset:0
 ds_read_b64_tr_b16 a[82:83], v24 offset:1024
 ds_read_b64_tr_b16 a[84:85], v24 offset:8192
 ds_read_b64_tr_b16 a[86:87], v24 offset:9216
 ds_read_b64_tr_b16 a[88:89], v25 offset:0
 ds_read_b64_tr_b16 a[90:91], v25 offset:1024
 ds_read_b64_tr_b16 a[92:93], v25 offset:8192
 ds_read_b64_tr_b16 a[94:95], v25 offset:9216
 s_waitcnt lgkmcnt(0)
 s_waitcnt vmcnt(16)
 s_barrier
 s_lshl_b32 s101, s4, 10
 s_add_u32 m0, s101, 81920
 s_add_u32 s100, s65, 786432
 buffer_load_dwordx4 v21, s[44:47], s100 offen  lds
 s_add_u32 m0, s101, 86016
 s_add_u32 s100, s65, 851968
 buffer_load_dwordx4 v21, s[44:47], s100 offen  lds
 s_add_u32 m0, s101, 90112
 s_add_u32 s100, s65, 1835008
 buffer_load_dwordx4 v21, s[44:47], s100 offen  lds
 s_add_u32 m0, s101, 94208
 s_add_u32 s100, s65, 1900544
 buffer_load_dwordx4 v21, s[44:47], s100 offen  lds
 v_add_u32 v24, 98304, v23
 v_xor_b32 v25, 32, v24
 ds_read_b64_tr_b16 a[96:97], v24 offset:0
 ds_read_b64_tr_b16 a[98:99], v24 offset:1024
 ds_read_b64_tr_b16 a[100:101], v24 offset:8192
 ds_read_b64_tr_b16 a[102:103], v24 offset:9216
 ds_read_b64_tr_b16 a[104:105], v25 offset:0
 ds_read_b64_tr_b16 a[106:107], v25 offset:1024
 ds_read_b64_tr_b16 a[108:109], v25 offset:8192
 ds_read_b64_tr_b16 a[110:111], v25 offset:9216
 s_waitcnt lgkmcnt(0)
 s_waitcnt vmcnt(16)
 s_barrier
 s_lshl_b32 s101, s4, 10
 s_add_u32 m0, s101, 98304
 s_add_u32 s100, s65, 0
 buffer_load_dwordx4 v21, s[48:51], s100 offen  lds
 s_add_u32 m0, s101, 102400
 s_add_u32 s100, s65, 65536
 buffer_load_dwordx4 v21, s[48:51], s100 offen  lds
 s_add_u32 m0, s101, 106496
 s_add_u32 s100, s65, 1048576
 buffer_load_dwordx4 v21, s[48:51], s100 offen  lds
 s_add_u32 m0, s101, 110592
 s_add_u32 s100, s65, 1114112
 buffer_load_dwordx4 v21, s[48:51], s100 offen  lds
 v_add_u32 v24, 147456, v23
 v_xor_b32 v25, 32, v24
 ds_read_b64_tr_b16 a[112:113], v24 offset:0
 ds_read_b64_tr_b16 a[114:115], v24 offset:1024
 ds_read_b64_tr_b16 a[116:117], v24 offset:8192
 ds_read_b64_tr_b16 a[118:119], v24 offset:9216
 ds_read_b64_tr_b16 a[120:121], v25 offset:0
 ds_read_b64_tr_b16 a[122:123], v25 offset:1024
 ds_read_b64_tr_b16 a[124:125], v25 offset:8192
 ds_read_b64_tr_b16 a[126:127], v25 offset:9216
 s_waitcnt lgkmcnt(0)
 s_waitcnt vmcnt(16)
 s_barrier
 s_lshl_b32 s101, s4, 10
 s_add_u32 m0, s101, 147456
 s_add_u32 s100, s65, 2097152
 buffer_load_dwordx4 v21, s[48:51], s100 offen  lds
 s_add_u32 m0, s101, 151552
 s_add_u32 s100, s65, 2162688
 buffer_load_dwordx4 v21, s[48:51], s100 offen  lds
 s_add_u32 m0, s101, 155648
 s_add_u32 s100, s65, 3145728
 buffer_load_dwordx4 v21, s[48:51], s100 offen  lds
 s_add_u32 m0, s101, 159744
 s_add_u32 s100, s65, 3211264
 buffer_load_dwordx4 v21, s[48:51], s100 offen  lds
 v_add_u32 v24, 114688, v23
 v_xor_b32 v25, 32, v24
 ds_read_b64_tr_b16 a[128:129], v24 offset:0
 ds_read_b64_tr_b16 a[130:131], v24 offset:1024
 ds_read_b64_tr_b16 a[132:133], v24 offset:8192
 ds_read_b64_tr_b16 a[134:135], v24 offset:9216
 ds_read_b64_tr_b16 a[136:137], v25 offset:0
 ds_read_b64_tr_b16 a[138:139], v25 offset:1024
 ds_read_b64_tr_b16 a[140:141], v25 offset:8192
 ds_read_b64_tr_b16 a[142:143], v25 offset:9216
 s_waitcnt lgkmcnt(0)
 s_waitcnt vmcnt(16)
 s_barrier
 s_lshl_b32 s101, s4, 10
 s_add_u32 m0, s101, 114688
 s_add_u32 s100, s65, 262144
 buffer_load_dwordx4 v21, s[48:51], s100 offen  lds
 s_add_u32 m0, s101, 118784
 s_add_u32 s100, s65, 327680
 buffer_load_dwordx4 v21, s[48:51], s100 offen  lds
 s_add_u32 m0, s101, 122880
 s_add_u32 s100, s65, 1310720
 buffer_load_dwordx4 v21, s[48:51], s100 offen  lds
 s_add_u32 m0, s101, 126976
 s_add_u32 s100, s65, 1376256
 buffer_load_dwordx4 v21, s[48:51], s100 offen  lds
 v_add_u32 v24, 131072, v23
 v_xor_b32 v25, 32, v24
 ds_read_b64_tr_b16 a[144:145], v24 offset:0
 ds_read_b64_tr_b16 a[146:147], v24 offset:1024
 ds_read_b64_tr_b16 a[148:149], v24 offset:8192
 ds_read_b64_tr_b16 a[150:151], v24 offset:9216
 ds_read_b64_tr_b16 a[152:153], v25 offset:0
 ds_read_b64_tr_b16 a[154:155], v25 offset:1024
 ds_read_b64_tr_b16 a[156:157], v25 offset:8192
 ds_read_b64_tr_b16 a[158:159], v25 offset:9216
 s_waitcnt lgkmcnt(0)
 s_waitcnt vmcnt(16)
 s_barrier
 s_lshl_b32 s101, s4, 10
 s_add_u32 m0, s101, 131072
 s_add_u32 s100, s65, 2359296
 buffer_load_dwordx4 v21, s[48:51], s100 offen  lds
 s_add_u32 m0, s101, 135168
 s_add_u32 s100, s65, 2424832
 buffer_load_dwordx4 v21, s[48:51], s100 offen  lds
 s_add_u32 m0, s101, 139264
 s_add_u32 s100, s65, 3407872
 buffer_load_dwordx4 v21, s[48:51], s100 offen  lds
 s_add_u32 m0, s101, 143360
 s_add_u32 s100, s65, 3473408
 buffer_load_dwordx4 v21, s[48:51], s100 offen  lds
 v_add_u32 v24, 65536, v23
 v_xor_b32 v25, 32, v24
 ds_read_b64_tr_b16 a[160:161], v24 offset:0
 ds_read_b64_tr_b16 a[162:163], v24 offset:1024
 ds_read_b64_tr_b16 a[164:165], v24 offset:8192
 ds_read_b64_tr_b16 a[166:167], v24 offset:9216
 ds_read_b64_tr_b16 a[168:169], v25 offset:0
 ds_read_b64_tr_b16 a[170:171], v25 offset:1024
 ds_read_b64_tr_b16 a[172:173], v25 offset:8192
 ds_read_b64_tr_b16 a[174:175], v25 offset:9216
 s_waitcnt lgkmcnt(0)
 s_waitcnt vmcnt(16)
 s_barrier
 s_lshl_b32 s101, s4, 10
 s_add_u32 m0, s101, 65536
 s_add_u32 s100, s65, 524288
 buffer_load_dwordx4 v21, s[48:51], s100 offen  lds
 s_add_u32 m0, s101, 69632
 s_add_u32 s100, s65, 589824
 buffer_load_dwordx4 v21, s[48:51], s100 offen  lds
 s_add_u32 m0, s101, 73728
 s_add_u32 s100, s65, 1572864
 buffer_load_dwordx4 v21, s[48:51], s100 offen  lds
 s_add_u32 m0, s101, 77824
 s_add_u32 s100, s65, 1638400
 buffer_load_dwordx4 v21, s[48:51], s100 offen  lds
 v_add_u32 v24, 81920, v23
 v_xor_b32 v25, 32, v24
 ds_read_b64_tr_b16 a[176:177], v24 offset:0
 ds_read_b64_tr_b16 a[178:179], v24 offset:1024
 ds_read_b64_tr_b16 a[180:181], v24 offset:8192
 ds_read_b64_tr_b16 a[182:183], v24 offset:9216
 ds_read_b64_tr_b16 a[184:185], v25 offset:0
 ds_read_b64_tr_b16 a[186:187], v25 offset:1024
 ds_read_b64_tr_b16 a[188:189], v25 offset:8192
 ds_read_b64_tr_b16 a[190:191], v25 offset:9216
 s_waitcnt lgkmcnt(0)
 s_waitcnt vmcnt(16)
 s_barrier
 s_lshl_b32 s101, s4, 10
 s_add_u32 m0, s101, 81920
 s_add_u32 s100, s65, 2621440
 buffer_load_dwordx4 v21, s[48:51], s100 offen  lds
 s_add_u32 m0, s101, 86016
 s_add_u32 s100, s65, 2686976
 buffer_load_dwordx4 v21, s[48:51], s100 offen  lds
 s_add_u32 m0, s101, 90112
 s_add_u32 s100, s65, 3670016
 buffer_load_dwordx4 v21, s[48:51], s100 offen  lds
 s_add_u32 m0, s101, 94208
 s_add_u32 s100, s65, 3735552
 buffer_load_dwordx4 v21, s[48:51], s100 offen  lds
 v_add_u32 v24, 98304, v23
 v_xor_b32 v25, 32, v24
 ds_read_b64_tr_b16 a[192:193], v24 offset:0
 ds_read_b64_tr_b16 a[194:195], v24 offset:1024
 ds_read_b64_tr_b16 a[196:197], v24 offset:8192
 ds_read_b64_tr_b16 a[198:199], v24 offset:9216
 ds_read_b64_tr_b16 a[200:201], v25 offset:0
 ds_read_b64_tr_b16 a[202:203], v25 offset:1024
 ds_read_b64_tr_b16 a[204:205], v25 offset:8192
 ds_read_b64_tr_b16 a[206:207], v25 offset:9216
 s_waitcnt lgkmcnt(0)
 v_mov_b32 v93, 0
 v_mov_b32 v16, 192
 global_load_dword v17, v16, s[32:33] sc1
 s_waitcnt vmcnt(16)
 s_barrier
 s_lshl_b32 s101, s4, 10
 s_add_u32 m0, s101, 98304
 s_add_u32 s100, s65, 786432
 buffer_load_dwordx4 v21, s[48:51], s100 offen  lds
 s_add_u32 m0, s101, 102400
 s_add_u32 s100, s65, 851968
 buffer_load_dwordx4 v21, s[48:51], s100 offen  lds
 s_add_u32 m0, s101, 106496
 s_add_u32 s100, s65, 1835008
 buffer_load_dwordx4 v21, s[48:51], s100 offen  lds
 s_add_u32 m0, s101, 110592
 s_add_u32 s100, s65, 1900544
 buffer_load_dwordx4 v21, s[48:51], s100 offen  lds
 v_add_u32 v24, 147456, v23
 v_xor_b32 v25, 32, v24
 ds_read_b64_tr_b16 a[208:209], v24 offset:0
 ds_read_b64_tr_b16 a[210:211], v24 offset:1024
 ds_read_b64_tr_b16 a[212:213], v24 offset:8192
 ds_read_b64_tr_b16 a[214:215], v24 offset:9216
 ds_read_b64_tr_b16 a[216:217], v25 offset:0
 ds_read_b64_tr_b16 a[218:219], v25 offset:1024
 ds_read_b64_tr_b16 a[220:221], v25 offset:8192
 ds_read_b64_tr_b16 a[222:223], v25 offset:9216
 s_waitcnt lgkmcnt(0)
 s_waitcnt vmcnt(16)
 s_barrier
 s_lshl_b32 s101, s4, 10
 s_add_u32 m0, s101, 147456
 s_add_u32 s100, s65, 2883584
 buffer_load_dwordx4 v21, s[48:51], s100 offen  lds
 s_add_u32 m0, s101, 151552
 s_add_u32 s100, s65, 2949120
 buffer_load_dwordx4 v21, s[48:51], s100 offen  lds
 s_add_u32 m0, s101, 155648
 s_add_u32 s100, s65, 3932160
 buffer_load_dwordx4 v21, s[48:51], s100 offen  lds
 s_add_u32 m0, s101, 159744
 s_add_u32 s100, s65, 3997696
 buffer_load_dwordx4 v21, s[48:51], s100 offen  lds
 v_add_u32 v24, 114688, v23
 v_xor_b32 v25, 32, v24
 ds_read_b64_tr_b16 a[224:225], v24 offset:0
 ds_read_b64_tr_b16 a[226:227], v24 offset:1024
 ds_read_b64_tr_b16 a[228:229], v24 offset:8192
 ds_read_b64_tr_b16 a[230:231], v24 offset:9216
 ds_read_b64_tr_b16 a[232:233], v25 offset:0
 ds_read_b64_tr_b16 a[234:235], v25 offset:1024
 ds_read_b64_tr_b16 a[236:237], v25 offset:8192
 ds_read_b64_tr_b16 a[238:239], v25 offset:9216
 s_waitcnt lgkmcnt(0)
 s_waitcnt vmcnt(16)
 s_barrier
 v_add_u32 v24, 131072, v23
 v_xor_b32 v25, 32, v24
 ds_read_b64_tr_b16 a[240:241], v24 offset:0
 ds_read_b64_tr_b16 a[242:243], v24 offset:1024
 ds_read_b64_tr_b16 a[244:245], v24 offset:8192
 ds_read_b64_tr_b16 a[246:247], v24 offset:9216
 ds_read_b64_tr_b16 a[248:249], v25 offset:0
 ds_read_b64_tr_b16 a[250:251], v25 offset:1024
 ds_read_b64_tr_b16 a[252:253], v25 offset:8192
 ds_read_b64_tr_b16 a[254:255], v25 offset:9216
 s_waitcnt lgkmcnt(0)
 s_waitcnt vmcnt(12)
 s_barrier
 v_add_u32 v24, 65536, v23
 v_xor_b32 v25, 32, v24
 ds_read_b64_tr_b16 v[112:113], v24 offset:0
 ds_read_b64_tr_b16 v[114:115], v24 offset:1024
 ds_read_b64_tr_b16 v[116:117], v24 offset:8192
 ds_read_b64_tr_b16 v[118:119], v24 offset:9216
 ds_read_b64_tr_b16 v[120:121], v25 offset:0
 ds_read_b64_tr_b16 v[122:123], v25 offset:1024
 ds_read_b64_tr_b16 v[124:125], v25 offset:8192
 ds_read_b64_tr_b16 v[126:127], v25 offset:9216
 s_waitcnt lgkmcnt(0)
 s_waitcnt vmcnt(8)
 s_barrier
 v_add_u32 v24, 81920, v23
 v_xor_b32 v25, 32, v24
 ds_read_b64_tr_b16 v[128:129], v24 offset:0
 ds_read_b64_tr_b16 v[130:131], v24 offset:1024
 ds_read_b64_tr_b16 v[132:133], v24 offset:8192
 ds_read_b64_tr_b16 v[134:135], v24 offset:9216
 ds_read_b64_tr_b16 v[136:137], v25 offset:0
 ds_read_b64_tr_b16 v[138:139], v25 offset:1024
 ds_read_b64_tr_b16 v[140:141], v25 offset:8192
 ds_read_b64_tr_b16 v[142:143], v25 offset:9216
 s_waitcnt lgkmcnt(0)
 s_waitcnt vmcnt(4)
 s_barrier
 v_add_u32 v24, 98304, v23
 v_xor_b32 v25, 32, v24
 ds_read_b64_tr_b16 v[144:145], v24 offset:0
 ds_read_b64_tr_b16 v[146:147], v24 offset:1024
 ds_read_b64_tr_b16 v[148:149], v24 offset:8192
 ds_read_b64_tr_b16 v[150:151], v24 offset:9216
 ds_read_b64_tr_b16 v[152:153], v25 offset:0
 ds_read_b64_tr_b16 v[154:155], v25 offset:1024
 ds_read_b64_tr_b16 v[156:157], v25 offset:8192
 ds_read_b64_tr_b16 v[158:159], v25 offset:9216
 s_waitcnt lgkmcnt(0)
 v_readfirstlane_b32 s100, v17
 s_cmp_ge_u32 s100, 256
 s_cbranch_scc1 L10
 s_mov_b32 s7, 524288
 v_mov_b32 v16, 192
 s_branch L12
L11:
 s_sleep 4
L12:
 global_load_dword v17, v16, s[32:33] sc1
 s_sub_u32 s7, s7, 1
 s_cbranch_scc1 L_abort
 s_waitcnt vmcnt(0)
 v_readfirstlane_b32 s100, v17
 s_cmp_lt_u32 s100, 256
 s_cbranch_scc1 L11
L10:
 s_lshl_b32 s68, s5, 7
 s_add_u32 s68, s68, 15798272
 s_mov_b32 s69, 1
 buffer_load_dword v18, v93, s[36:39], s68 offen sc1
 s_lshl_b32 s68, s5, 7
 s_add_u32 s68, s68, 15794176
 s_mov_b32 s69, 1
 buffer_load_dword v109, v93, s[36:39], s68 offen sc1
 s_waitcnt vmcnt(0)
 s_barrier
 s_mov_b32 s7, 524288
L13:
 v_readfirstlane_b32 s100, v109
 s_cmp_ge_u32 s100, s69
 s_cbranch_scc1 L14
 buffer_load_dword v109, v93, s[36:39], s68 offen sc1
 s_sub_u32 s7, s7, 1
 s_cbranch_scc1 L_abort
 s_waitcnt vmcnt(0)
 s_branch L13
L14:
 s_lshl_b32 s65, s5, 14
 s_add_u32 s65, s65, 33554432
 s_lshl_b32 s66, s4, 12
 s_add_u32 s66, s66, 114688
 s_mov_b32 m0, s66
 v_mov_b32 v109, v18
 buffer_load_dwordx4 v97, s[36:39], s65 offen offset:0 sc1 lds
 buffer_load_dwordx4 v97, s[36:39], s65 offen offset:1024 sc1 lds
 buffer_load_dwordx4 v97, s[36:39], s65 offen offset:2048 sc1 lds
 buffer_load_dwordx4 v97, s[36:39], s65 offen offset:3072 sc1 lds
 v_add_u32 v24, 147456, v23
 v_xor_b32 v25, 32, v24
 ds_read_b64_tr_b16 v[160:161], v24 offset:0
 ds_read_b64_tr_b16 v[162:163], v24 offset:1024
 ds_read_b64_tr_b16 v[164:165], v24 offset:8192
 ds_read_b64_tr_b16 v[166:167], v24 offset:9216
 ds_read_b64_tr_b16 v[168:169], v25 offset:0
 ds_read_b64_tr_b16 v[170:171], v25 offset:1024
 ds_read_b64_tr_b16 v[172:173], v25 offset:8192
 ds_read_b64_tr_b16 v[174:175], v25 offset:9216
 s_waitcnt lgkmcnt(0)
 s_barrier
 ds_write_b128 v98, v[32:35] offset:0
 ds_write_b128 v98, v[36:39] offset:1024
 ds_write_b128 v98, v[40:43] offset:2048
 ds_write_b128 v98, v[44:47] offset:3072
 ds_write_b128 v98, v[48:51] offset:4096
 ds_write_b128 v98, v[52:55] offset:5120
 ds_write_b128 v98, v[56:59] offset:6144
 ds_write_b128 v98, v[60:63] offset:7168
 ds_write_b128 v98, v[64:67] offset:8192
 ds_write_b128 v98, v[68:71] offset:9216
 ds_write_b128 v98, v[72:75] offset:10240
 ds_write_b128 v98, v[76:79] offset:11264
 s_mov_b32 s78, 0x11111111
 s_mov_b32 s79, 0x11111111
 s_mov_b32 s80, 0x22222222
 s_mov_b32 s81, 0x22222222
 s_mov_b32 s82, 0x44444444
 s_mov_b32 s83, 0x44444444
 s_mov_b32 s84, 0x88888888
 s_mov_b32 s85, 0x88888888
 v_and_b32 v24, 15, v20
 v_lshrrev_b32 v25, 4, v20
 v_mov_b32 v96, 0x4444
 v_mov_b32 v26, 0xeeee
 s_mov_b32 vcc_lo, 0xcccccccc
 s_mov_b32 vcc_hi, 0xcccccccc
 v_cndmask_b32 v96, v96, v26, vcc
 v_mov_b32 v108, 0x3f80
 v_mov_b32 v26, 1.0
 s_mov_b32 vcc_lo, 0xf0f0f0f0
 s_mov_b32 vcc_hi, 0xf0f0f0f0
 v_cndmask_b32 v108, v108, v26, vcc
 s_mov_b32 s76, 0x3f803f80
 s_mov_b32 s77, 0x3f803f80
 s_mov_b32 s70, 0x3e0293ee
 s_mov_b32 s88, 0x3e0293ee
 s_mov_b32 s90, 0x427af233
 s_mov_b32 s89, 0x3e0293ee
 v_mov_b32 v94, 0
 v_lshrrev_b32 v27, 2, v24
 v_and_b32 v28, 1, v24
 v_lshl_or_b32 v27, v27, 1, v28
 v_bfe_u32 v28, v24, 1, 1
 v_lshlrev_b32 v101, 4, v20
 v_add_u32 v99, 114688, v101
 v_add_u32 v100, 114688, v97
 v_add_u32 v101, 153600, v101
 s_lshl_b32 s100, s4, 11
 v_add_u32 v111, s100, v101
 s_add_u32 s42, s100, 153600
 s_sub_u32 s73, 15728640, s100
 s_mov_b32 s71, s73
 s_lshl_b32 s100, s4, 10
 s_add_u32 s43, s100, 157696
 s_mul_i32 s100, s4, 3072
 s_sub_u32 s44, 15732736, s100
 s_mov_b32 s72, s44
 s_lshl_b32 s100, s4, 10
 s_add_u32 s100, s100, 147456
 v_lshlrev_b32 v26, 2, v24
 v_lshl_or_b32 v26, v25, 7, v26
 v_add_u32 v104, s100, v26
 v_lshrrev_b32 v26, 3, v24
 v_lshl_or_b32 v26, v25, 1, v26
 s_lshl_b32 s100, s4, 3
 v_add_u32 v26, s100, v26
 v_and_b32 v29, 7, v24
 v_lshlrev_b32 v29, 3, v29
 v_mul_u32_u24 v26, 8192, v26
 v_add_u32 v102, v26, v29
 v_lshlrev_b32 v26, 4, v25
 v_lshl_or_b32 v26, v27, 6, v26
 v_add_u32 v105, 147456, v26
 v_lshlrev_b32 v26, 4, v27
 v_lshl_or_b32 v26, v25, 8, v26
 s_lshr_b32 s100, s4, 1
 s_lshl_b32 s100, s100, 10
 s_and_b32 s101, s4, 1
 s_lshl_b32 s101, s101, 7
 s_add_u32 s100, s100, s101
 s_add_u32 s100, s100, 151552
 v_add_u32 v106, s100, v26
 v_lshl_or_b32 v26, v28, 7, v26
 v_add_u32 v107, 151552, v26
 s_mul_i32 s100, s4, 3072
 s_lshl_b32 s67, s5, 12
 s_add_u32 s67, s67, 6291456
 s_sub_u32 s67, s67, s100
 s_lshl_b32 s40, s5, 6
 s_add_u32 s40, s40, 14680064
 s_mov_b32 s41, s62
 s_mov_b32 s75, 268435456
 s_mov_b32 s56, 0
 s_mov_b32 s57, 0
 s_mov_b32 s58, 8192
 s_mov_b32 s59, 16384
 s_cmp_lt_u32 s4, 0
 s_cselect_b64 s[86:87], -1, 0
 s_lshl_b32 s68, s5, 7
 s_add_u32 s68, s68, 15798272
 s_mov_b32 s69, 1
 s_mov_b32 s7, 524288
L15:
 v_readfirstlane_b32 s100, v109
 s_cmp_ge_u32 s100, s69
 s_cbranch_scc1 L16
 buffer_load_dword v109, v93, s[36:39], s68 offen sc1
 s_sub_u32 s7, s7, 1
 s_cbranch_scc1 L_abort
 s_waitcnt vmcnt(0)
 s_branch L15
L16:
 s_waitcnt lgkmcnt(0)
 v_mov_b64 v[64:65], 0
 v_mov_b64 v[66:67], 0
 v_mov_b64 v[68:69], 0
 v_mov_b64 v[70:71], 0
 v_mov_b64 v[72:73], 0
 v_mov_b64 v[74:75], 0
 v_mov_b64 v[76:77], 0
 v_mov_b64 v[78:79], 0
 v_mov_b64 v[80:81], 0
 v_mov_b64 v[82:83], 0
 v_mov_b64 v[84:85], 0
 v_mov_b64 v[86:87], 0
 ds_read_b128 v[32:35], v97 offset:0
 ds_read_b128 v[36:39], v97 offset:1024
 ds_read_b128 v[40:43], v97 offset:2048
 ds_read_b128 v[44:47], v97 offset:3072
 ds_read_b128 v[48:51], v97 offset:16384
 ds_read_b128 v[52:55], v97 offset:17408
 ds_read_b128 v[56:59], v97 offset:18432
 ds_read_b128 v[60:63], v97 offset:19456
 v_mov_b64 v[24:25], -1
 v_mov_b64 v[26:27], -1
 v_mov_b64 v[28:29], -1
 v_mov_b64 v[30:31], -1
 s_mov_b32 s63, 268435456
 s_mov_b32 s64, 268435456
 s_cmp_eq_u32 s4, 0
 s_cbranch_scc1 L_fetch0
 s_cmp_eq_u32 s4, 1
 s_cbranch_scc1 L_fetch1
 s_cmp_eq_u32 s4, 2
 s_cbranch_scc1 L_fetch2
 s_branch L_fetch3
L_ch_km0:
 buffer_store_dwordx4 v[88:91], v97, s[36:39], s67 offen sc1
 s_cmp_lt_u32 s56, 63
 s_cbranch_scc1 L_ch_kmb0
 s_branch L_ch_exit
.p2align 8
L_fetch0:
 s_mov_b32 s7, 524288
 s_nop 15
 s_nop 15
 buffer_load_dwordx4 v[24:27], v97, s[36:39], s71 offen offset:0 sc1
 buffer_load_dwordx4 v[28:31], v97, s[36:39], s71 offen offset:1024 sc1
 s_nop 15
 buffer_load_dwordx4 v[24:27], v97, s[36:39], s71 offen offset:0 sc1
 buffer_load_dwordx4 v[28:31], v97, s[36:39], s71 offen offset:1024 sc1
 s_nop 15
 s_mov_b64 vcc, -1
L_er0:
 s_mov_b64 exec, vcc
 buffer_load_dwordx4 v[24:27], v97, s[36:39], s71 offen offset:0 sc1
 buffer_load_dwordx4 v[28:31], v97, s[36:39], s71 offen offset:1024 sc1
 s_mov_b64 exec, -1
 s_sub_u32 s7, s7, 1
 s_cbranch_scc1 L_abort
 s_waitcnt vmcnt(4)
 v_max3_u32 v110, v24, v24, v25
 v_max3_u32 v110, v110, v26, v27
 v_max3_u32 v110, v110, v28, v29
 v_max3_u32 v110, v110, v30, v31
 v_cmp_eq_u32 vcc, -1, v110
 s_cbranch_vccnz L_er0
 ds_write_b128 v111, v[24:27]
 ds_write_b128 v111, v[28:31] offset:1024
 s_barrier
 s_waitcnt lgkmcnt(0)
 s_barrier
 ds_read_b128 v[0:3], v101 offset:0
 ds_read_b128 v[4:7], v101 offset:1024
 ds_read_b128 v[8:11], v101 offset:2048
 ds_read_b128 v[12:15], v101 offset:3072
 s_add_u32 s65, s65, 524288
 s_xor_b32 s66, s66, 0x3c000
 s_mov_b32 m0, s66
 s_mul_i32 s100, s57, 40
 s_add_u32 s60, s100, s40
 s_waitcnt lgkmcnt(3)
 v_smfmac_f32_16x16x64_bf16 v[64:67], v[0:3], a[0:7], v96
 buffer_load_dwordx4 v97, s[36:39], s65 offen offset:0 sc1 lds
 s_add_u32 s74, s60, 4096
 s_add_u32 s61, s100, s41
 v_smfmac_f32_16x16x64_bf16 v[68:71], v[0:3], a[8:15], v96
 s_mul_i32 s100, s59, 40
 s_add_u32 s62, s100, s41
 s_add_u32 s63, s58, 15728640
 v_smfmac_f32_16x16x64_bf16 v[72:75], v[0:3], a[128:135], v96
 s_add_u32 s64, s57, 15728640
 s_xor_b32 s68, s68, 4096
 s_lshr_b32 s69, s56, 1
 v_smfmac_f32_16x16x64_bf16 v[76:79], v[0:3], a[136:143], v96
 s_waitcnt lgkmcnt(2)
 s_add_u32 s69, s69, 2
 s_cmp_gt_u32 s56, 61
 s_cselect_b32 s69, 0, s69
 v_smfmac_f32_16x16x64_bf16 v[64:67], v[4:7], a[16:23], v96
 buffer_load_dwordx4 v97, s[36:39], s65 offen offset:1024 sc1 lds
 v_smfmac_f32_16x16x64_bf16 v[68:71], v[4:7], a[24:31], v96
 v_smfmac_f32_16x16x64_bf16 v[72:75], v[4:7], v[32:39], v96
 ds_read_b128 v[32:35], v97 offset:32768
 v_smfmac_f32_16x16x64_bf16 v[76:79], v[4:7], v[40:47], v96
 s_waitcnt lgkmcnt(2)
 v_smfmac_f32_16x16x64_bf16 v[64:67], v[8:11], a[32:39], v96
 ds_read_b128 v[36:39], v97 offset:33792
 buffer_load_dwordx4 v97, s[36:39], s65 offen offset:2048 sc1 lds
 v_smfmac_f32_16x16x64_bf16 v[68:71], v[8:11], a[40:47], v96
 ds_read_b128 v[40:43], v97 offset:34816
 v_smfmac_f32_16x16x64_bf16 v[72:75], v[8:11], a[144:151], v96
 ds_read_b128 v[44:47], v97 offset:35840
 v_smfmac_f32_16x16x64_bf16 v[76:79], v[8:11], a[152:159], v96
 s_waitcnt lgkmcnt(4)
 v_smfmac_f32_16x16x64_bf16 v[64:67], v[12:15], a[48:55], v96
 s_waitcnt vmcnt(3)
 buffer_load_dwordx4 v97, s[36:39], s65 offen offset:3072 sc1 lds
 v_smfmac_f32_16x16x64_bf16 v[68:71], v[12:15], a[56:63], v96
 v_smfmac_f32_16x16x64_bf16 v[72:75], v[12:15], v[48:55], v96
 v_smfmac_f32_16x16x64_bf16 v[76:79], v[12:15], v[56:63], v96
 v_smfmac_f32_16x16x64_bf16 v[80:83], v[0:3], a[192:199], v96
 s_barrier
 ds_read_b128 v[16:19], v101 offset:4096
 v_smfmac_f32_16x16x64_bf16 v[84:87], v[0:3], a[200:207], v96
 buffer_store_dwordx4 v[88:91], v97, s[36:39], s75 offen sc1
 ds_read_b128 v[20:23], v101 offset:5120
 v_smfmac_f32_16x16x64_bf16 v[80:83], v[4:7], a[208:215], v96
 v_mov_b64 v[88:89], -1
 v_smfmac_f32_16x16x64_bf16 v[84:87], v[4:7], a[216:223], v96
 s_waitcnt lgkmcnt(1)
 v_mov_b64 v[90:91], -1
 v_smfmac_f32_16x16x64_bf16 v[64:67], v[16:19], a[64:71], v96
 ds_read_b128 v[24:27], v101 offset:6144
 v_smfmac_f32_16x16x64_bf16 v[68:71], v[16:19], a[72:79], v96
 ds_read_b128 v[48:51], v97 offset:49152
 v_smfmac_f32_16x16x64_bf16 v[72:75], v[16:19], a[160:167], v96
 ds_read_b128 v[28:31], v101 offset:7168
 ds_read_b128 v[52:55], v97 offset:50176
 v_smfmac_f32_16x16x64_bf16 v[76:79], v[16:19], a[168:175], v96
 s_waitcnt lgkmcnt(4)
 v_smfmac_f32_16x16x64_bf16 v[64:67], v[20:23], a[80:87], v96
 v_smfmac_f32_16x16x64_bf16 v[68:71], v[20:23], a[88:95], v96
 buffer_store_dwordx4 v[88:91], v97, s[36:39], s62 offen offset:0
 ds_read_b128 v[56:59], v97 offset:51200
 s_waitcnt lgkmcnt(7)
 v_smfmac_f32_16x16x64_bf16 v[72:75], v[20:23], v[32:39], v96
 ds_read_b128 v[60:63], v97 offset:52224
 v_smfmac_f32_16x16x64_bf16 v[76:79], v[20:23], v[40:47], v96
 s_waitcnt lgkmcnt(5)
 v_smfmac_f32_16x16x64_bf16 v[64:67], v[24:27], a[96:103], v96
 v_smfmac_f32_16x16x64_bf16 v[68:71], v[24:27], a[104:111], v96
 ds_read_b128 v[0:3], v99 offset:2048
 v_smfmac_f32_16x16x64_bf16 v[72:75], v[24:27], a[176:183], v96
 v_smfmac_f32_16x16x64_bf16 v[76:79], v[24:27], a[184:191], v96
 buffer_store_dwordx4 v[88:91], v97, s[36:39], s62 offen offset:1024
 ds_read_b128 v[4:7], v99 offset:3072
 s_waitcnt lgkmcnt(5)
 v_smfmac_f32_16x16x64_bf16 v[64:67], v[28:31], a[112:119], v96
 v_smfmac_f32_16x16x64_bf16 v[68:71], v[28:31], a[120:127], v96
 s_waitcnt lgkmcnt(2)
 v_smfmac_f32_16x16x64_bf16 v[72:75], v[28:31], v[48:55], v96
 v_smfmac_f32_16x16x64_bf16 v[76:79], v[28:31], v[56:63], v96
 v_add_f32 v64, v64, v66
 v_add_f32 v65, v65, v67
 v_add_f32 v68, v68, v70
 v_add_f32 v69, v69, v71
 v_cvt_pk_bf16_f32 v48, v64, v68
 v_cvt_pk_bf16_f32 v49, v65, v69
 ds_write2_b32 v104, v48, v49 offset1:16
 v_add_f32 v72, v72, v74
 v_add_f32 v73, v73, v75
 v_add_f32 v76, v76, v78
 v_add_f32 v77, v77, v79
 v_cvt_pk_bf16_f32 v88, v72, v76
 v_cvt_pk_bf16_f32 v89, v73, v77
 ds_write2_b32 v104, v88, v89 offset0:128 offset1:144
 v_smfmac_f32_16x16x64_bf16 v[80:83], v[8:11], a[224:231], v96
 v_smfmac_f32_16x16x64_bf16 v[84:87], v[8:11], a[232:239], v96
 ds_read_b128 v[8:11], v99 offset:6144
 v_smfmac_f32_16x16x64_bf16 v[80:83], v[12:15], a[240:247], v96
 v_smfmac_f32_16x16x64_bf16 v[84:87], v[12:15], a[248:255], v96
 ds_read_b128 v[12:15], v99 offset:7168
 v_smfmac_f32_16x16x64_bf16 v[80:83], v[16:19], v[112:119], v96
 s_waitcnt lgkmcnt(2)
 s_barrier
 v_smfmac_f32_16x16x64_bf16 v[84:87], v[16:19], v[120:127], v96
 ds_read_b128 v[32:35], v105 offset:0
 v_smfmac_f32_16x16x64_bf16 v[80:83], v[20:23], v[128:135], v96
 ds_read_b128 v[36:39], v105 offset:512
 v_smfmac_f32_16x16x64_bf16 v[84:87], v[20:23], v[136:143], v96
 ds_read_b128 v[40:43], v105 offset:1024
 v_smfmac_f32_16x16x64_bf16 v[80:83], v[24:27], v[144:151], v96
 ds_read_b128 v[44:47], v105 offset:1536
 v_smfmac_f32_16x16x64_bf16 v[84:87], v[24:27], v[152:159], v96
 ds_read_b128 v[16:19], v99 offset:10240
 v_smfmac_f32_16x16x64_bf16 v[80:83], v[28:31], v[160:167], v96
 ds_read_b128 v[48:51], v105 offset:2048
 v_smfmac_f32_16x16x64_bf16 v[84:87], v[28:31], v[168:175], v96
 ds_read_b128 v[20:23], v99 offset:11264
 s_waitcnt lgkmcnt(5)
 v_mfma_f32_16x16x32_bf16 v[68:71], v[0:3], v[32:35], 0
 ds_read_b128 v[52:55], v105 offset:2560
 v_mfma_f32_16x16x32_bf16 v[72:75], v[4:7], v[32:35], 0
 ds_read_b128 v[24:27], v99 offset:14336
 v_mfma_f32_16x16x32_bf16 v[64:67], v[36:39], v[32:35], 0
 ds_read_b128 v[56:59], v105 offset:3072
 v_add_f32 v80, v80, v82
 v_add_f32 v81, v81, v83
 s_waitcnt lgkmcnt(6)
 v_mfma_f32_16x16x32_bf16 v[68:71], v[8:11], v[40:43], v[68:71]
 ds_read_b128 v[28:31], v99 offset:15360
 v_add_f32 v84, v84, v86
 v_add_f32 v85, v85, v87
 v_mfma_f32_16x16x32_bf16 v[72:75], v[12:15], v[40:43], v[72:75]
 ds_read_b128 v[60:63], v105 offset:3584
 v_cvt_pk_bf16_f32 v90, v80, v81
 v_cvt_pk_bf16_f32 v91, v84, v85
 s_cmp_ge_u32 s56, 60
 v_mfma_f32_16x16x32_bf16 v[64:67], v[44:47], v[40:43], v[64:67]
 ds_read_b128 v[32:35], v100 offset:0
 s_cbranch_scc1 L_ch_km0
L_ch_kmb0:
 s_waitcnt lgkmcnt(5)
 v_mfma_f32_16x16x32_bf16 v[68:71], v[16:19], v[48:51], v[68:71]
 ds_read_b128 v[36:39], v100 offset:1024
 v_mfma_f32_16x16x32_bf16 v[72:75], v[20:23], v[48:51], v[72:75]
 v_mov_b64 v[40:41], s[76:77]
 v_mov_b64 v[42:43], s[76:77]
 v_mfma_f32_16x16x32_bf16 v[64:67], v[52:55], v[48:51], v[64:67]
 v_mov_b64 v[0:1], 0
 v_mov_b64 v[2:3], 0
 s_waitcnt lgkmcnt(2)
 v_mfma_f32_16x16x32_bf16 v[68:71], v[24:27], v[56:59], v[68:71]
 v_mov_b64 v[4:5], 0
 v_mov_b64 v[6:7], 0
 v_mfma_f32_16x16x32_bf16 v[72:75], v[28:31], v[56:59], v[72:75]
 v_mov_b64 v[8:9], 0
 v_mov_b64 v[10:11], 0
 v_mfma_f32_16x16x32_bf16 v[64:67], v[60:63], v[56:59], v[64:67]
 v_mov_b64 v[12:13], 0
 v_mov_b64 v[14:15], 0
 v_mov_b64 v[16:17], 0
 v_max3_f32 v60, |v68|, |v69|, |v70|
 v_max3_f32 v61, |v71|, |v72|, |v73|
 v_max3_f32 v62, |v74|, |v75|, v60
 s_nop 0
 v_max3_f32 v60, |v64|, |v65|, v61
 v_max_f32 v60, v60, v62
 v_cmp_nge_f32 vcc, s90, v60
 v_pk_mul_f32 v[68:69], v[68:69], s[88:89]
 v_pk_mul_f32 v[70:71], v[70:71], s[88:89]
 v_pk_mul_f32 v[72:73], v[72:73], s[88:89]
 v_pk_mul_f32 v[74:75], v[74:75], s[88:89]
 v_pk_mul_f32 v[64:65], v[64:65], s[88:89]
 s_cbranch_vccnz L_mx0
L_mxb0:
 v_exp_f32 v64, v64
 v_exp_f32 v65, v65
 v_exp_f32 v68, v68
 v_cvt_pk_bf16_f32 v92, v64, v65
 v_cvt_pk_bf16_f32 v95, v64, v65
 v_exp_f32 v69, v69
 v_mfma_f32_16x16x16_bf16 v[56:59], v[40:41], v[92:93], 0
 v_exp_f32 v70, v70
 v_cvt_pk_bf16_f32 v44, v68, v69
 v_exp_f32 v71, v71
 v_mfma_f32_16x16x16_bf16 v[48:51], v[90:91], v[92:93], 0
 v_exp_f32 v72, v72
 v_cvt_pk_bf16_f32 v45, v70, v71
 v_exp_f32 v73, v73
 v_mfma_f32_16x16x16_bf16 v[52:55], v[90:91], v[94:95], 0
 v_exp_f32 v74, v74
 v_cvt_pk_bf16_f32 v46, v72, v73
 v_exp_f32 v75, v75
 s_waitcnt lgkmcnt(0)
 v_cvt_pk_bf16_f32 v47, v74, v75
 v_mov_b64 v[18:19], 0
 v_mov_b64 v[20:21], 0
 v_mfma_f32_16x16x32_bf16 v[56:59], v[40:43], v[44:47], v[56:59]
 v_mov_b64 v[22:23], 0
 v_mov_b64 v[24:25], 0
 v_mfma_f32_16x16x32_bf16 v[48:51], v[32:35], v[44:47], v[48:51]
 v_mov_b64 v[26:27], 0
 v_mov_b64 v[28:29], 0
 v_mfma_f32_16x16x32_bf16 v[52:55], v[36:39], v[44:47], v[52:55]
 v_mov_b64 v[30:31], 0
 ds_read_b128 v[80:83], v98 offset:0
 v_rcp_f32 v56, v56
 ds_read_b128 v[84:87], v98 offset:1024
 v_mul_f32 v48, v48, v56
 v_mul_f32 v49, v49, v56
 v_mul_f32 v50, v50, v56
 v_mul_f32 v51, v51, v56
 v_cvt_pk_bf16_f32 v44, v48, v49
 v_cvt_pk_bf16_f32 v45, v50, v51
 v_mul_f32 v52, v52, v56
 v_mul_f32 v53, v53, v56
 v_mul_f32 v54, v54, v56
 v_mul_f32 v55, v55, v56
 v_cvt_pk_bf16_f32 v46, v52, v53
 v_cvt_pk_bf16_f32 v47, v54, v55
 ds_write_b128 v106, v[44:47]
 ds_read_b128 v[32:35], v98 offset:2048
 ds_read_b128 v[36:39], v98 offset:3072
 s_waitcnt lgkmcnt(2)
 s_barrier
 ds_read_b128 v[64:67], v107
 ds_read_b128 v[68:71], v107 offset:1024
 s_waitcnt lgkmcnt(1)
 v_smfmac_f32_16x16x64_bf16 v[0:3], v[64:67], v[176:183], v96
 s_waitcnt lgkmcnt(0)
 ds_read_b128 v[72:75], v98 offset:4096
 v_smfmac_f32_16x16x64_bf16 v[0:3], v[68:71], v[184:191], v96
 ds_read_b128 v[76:79], v98 offset:5120
 s_add_u32 s71, s58, s73
 v_xor_b32 v99, 0x3c000, v99
 v_smfmac_f32_16x16x64_bf16 v[4:7], v[64:67], v[192:199], v96
 ds_read_b128 v[56:59], v98 offset:6144
 s_add_u32 s72, s58, s44
 v_xor_b32 v100, 0x3c000, v100
 v_smfmac_f32_16x16x64_bf16 v[4:7], v[68:71], v[200:207], v96
 ds_read_b128 v[60:63], v98 offset:7168
 s_mov_b32 s100, s57
 v_add_f32 v0, v0, v2
 v_add_f32 v1, v1, v3
 v_smfmac_f32_16x16x64_bf16 v[8:11], v[64:67], v[208:215], v96
 ds_read_b128 v[40:43], v98 offset:8192
 s_mov_b32 s57, s58
 v_cvt_pk_bf16_f32 v48, v0, v1
 v_smfmac_f32_16x16x64_bf16 v[8:11], v[68:71], v[216:223], v96
 ds_read_b128 v[44:47], v98 offset:9216
 s_mov_b32 s58, s59
 v_add_f32 v4, v4, v6
 v_add_f32 v5, v5, v7
 v_smfmac_f32_16x16x64_bf16 v[12:15], v[64:67], v[224:231], v96
 s_mov_b32 s59, s100
 v_cvt_pk_bf16_f32 v49, v4, v5
 v_smfmac_f32_16x16x64_bf16 v[12:15], v[68:71], v[232:239], v96
 buffer_store_dwordx2 v[48:49], v102, s[36:39], s60 offen offset:0
 s_add_u32 s56, s56, 1
 v_add_f32 v8, v8, v10
 v_add_f32 v9, v9, v11
 v_smfmac_f32_16x16x64_bf16 v[16:19], v[64:67], v[240:247], v96
 s_mov_b32 s75, s67
 v_cvt_pk_bf16_f32 v50, v8, v9
 v_smfmac_f32_16x16x64_bf16 v[16:19], v[68:71], v[248:255], v96
 s_waitcnt lgkmcnt(0)
 s_add_u32 s67, s67, 131072
 v_add_f32 v12, v12, v14
 v_add_f32 v13, v13, v15
 v_smfmac_f32_16x16x64_bf16 v[20:23], v[64:67], v[80:87], v96
 ds_read_b128 v[80:83], v98 offset:10240
 ds_read_b128 v[84:87], v98 offset:11264
 v_cvt_pk_bf16_f32 v51, v12, v13
 v_smfmac_f32_16x16x64_bf16 v[20:23], v[68:71], v[32:39], v96
 buffer_store_dwordx2 v[50:51], v102, s[36:39], s60 offen offset:2048
 v_add_f32 v16, v16, v18
 v_add_f32 v17, v17, v19
 v_smfmac_f32_16x16x64_bf16 v[24:27], v[64:67], v[72:79], v96
 v_cvt_pk_bf16_f32 v52, v16, v17
 v_smfmac_f32_16x16x64_bf16 v[24:27], v[68:71], v[56:63], v96
 v_add_f32 v20, v20, v22
 v_add_f32 v21, v21, v23
 v_smfmac_f32_16x16x64_bf16 v[28:31], v[64:67], v[40:47], v96
 s_waitcnt lgkmcnt(0)
 v_cvt_pk_bf16_f32 v53, v20, v21
 v_smfmac_f32_16x16x64_bf16 v[28:31], v[68:71], v[80:87], v96
 buffer_store_dwordx2 v[52:53], v102, s[36:39], s74 offen offset:0
 v_add_f32 v24, v24, v26
 v_add_f32 v25, v25, v27
 v_cvt_pk_bf16_f32 v54, v24, v25
 s_nop 3
 v_add_f32 v28, v28, v30
 v_add_f32 v29, v29, v31
 v_cvt_pk_bf16_f32 v55, v28, v29
 buffer_store_dwordx2 v[54:55], v102, s[36:39], s74 offen offset:2048
 v_cndmask_b32 v0, 0, v108, s[78:79]
 v_cndmask_b32 v1, 0, v108, s[80:81]
 v_cndmask_b32 v2, 0, v108, s[82:83]
 v_cndmask_b32 v3, 0, v108, s[84:85]
 v_mov_b64 v[24:25], -1
 s_nop 3
 buffer_load_dwordx4 v[16:19], v97, s[36:39], s61 offen offset:0 sc1
 buffer_load_dwordx4 v[20:23], v97, s[36:39], s61 offen offset:1024 sc1
 v_mov_b64 v[64:65], 0
 v_mov_b64 v[66:67], 0
 v_mov_b64 v[68:69], 0
 v_mov_b64 v[70:71], 0
 v_mov_b64 v[72:73], 0
 v_mov_b64 v[74:75], 0
 v_mov_b64 v[76:77], 0
 v_mov_b64 v[78:79], 0
 v_mov_b64 v[80:81], 0
 v_mov_b64 v[82:83], 0
 v_mov_b64 v[84:85], 0
 v_mov_b64 v[86:87], 0
 ds_read_b128 v[32:35], v97 offset:0
 ds_read_b128 v[36:39], v97 offset:1024
 ds_read_b128 v[40:43], v97 offset:2048
 ds_read_b128 v[44:47], v97 offset:3072
 ds_read_b128 v[48:51], v97 offset:16384
 ds_read_b128 v[52:55], v97 offset:17408
 ds_read_b128 v[56:59], v97 offset:18432
 ds_read_b128 v[60:63], v97 offset:19456
 s_nop 7
 s_mov_b32 s7, 524288
 s_mov_b64 vcc, -1
L_red0:
 s_mov_b64 exec, vcc
 buffer_load_dwordx4 v[16:19], v97, s[36:39], s61 offen offset:0 sc1
 buffer_load_dwordx4 v[20:23], v97, s[36:39], s61 offen offset:1024 sc1
 s_mov_b64 exec, -1
 s_sub_u32 s7, s7, 1
 s_cbranch_scc1 L_abort
 s_waitcnt vmcnt(2)
 v_max3_u32 v110, v16, v16, v17
 v_max3_u32 v110, v110, v18, v19
 v_mfma_f32_16x16x32_bf16 v[4:7], v[0:3], v[16:19], 0
 v_max3_u32 v110, v110, v20, v21
 v_max3_u32 v110, v110, v22, v23
 v_mfma_f32_16x16x32_bf16 v[4:7], v[0:3], v[20:23], v[4:7]
 v_cmp_eq_u32 vcc, -1, v110
 s_cbranch_vccnz L_red0
 s_nop 0
 v_add_f32_dpp v4, v4, v4 row_ror:4 row_mask:0xf bank_mask:0xf
 v_add_f32_dpp v5, v5, v5 row_ror:4 row_mask:0xf bank_mask:0xf
 v_add_f32_dpp v6, v6, v6 row_ror:4 row_mask:0xf bank_mask:0xf
 v_add_f32_dpp v7, v7, v7 row_ror:4 row_mask:0xf bank_mask:0xf
 v_add_f32_dpp v4, v4, v4 row_ror:8 row_mask:0xf bank_mask:0xf
 v_add_f32_dpp v5, v5, v5 row_ror:8 row_mask:0xf bank_mask:0xf
 v_add_f32_dpp v6, v6, v6 row_ror:8 row_mask:0xf bank_mask:0xf
 v_add_f32_dpp v7, v7, v7 row_ror:8 row_mask:0xf bank_mask:0xf
 v_cvt_pk_bf16_f32 v4, v4, v5
 v_cvt_pk_bf16_f32 v5, v6, v7
 s_mov_b64 exec, 0x000f000f
 buffer_store_dwordx2 v[4:5], v103, s[36:39], s63 offen
 buffer_store_dwordx2 v[24:25], v103, s[36:39], s64 offen
 s_mov_b64 exec, -1
 s_branch L_fetch0
L_mx0:
 v_max3_f32 v60, v68, v69, v70
 v_max3_f32 v61, v71, v72, v73
 v_max3_f32 v62, v74, v75, v60
 v_max3_f32 v60, v64, v65, v61
 v_max_f32 v61, v60, v62
 v_max_f32 v63, v60, v62
 s_nop 1
 v_permlane16_swap_b32 v61, v63
 v_max_f32 v60, v61, v63
 v_max_f32 v62, v61, v63
 s_nop 1
 v_permlane32_swap_b32 v60, v62
 v_max_f32 v60, v60, v62
 v_pk_add_f32 v[64:65], v[64:65], v[60:61] op_sel_hi:[1,0] neg_lo:[0,1] neg_hi:[0,1]
 v_pk_add_f32 v[68:69], v[68:69], v[60:61] op_sel_hi:[1,0] neg_lo:[0,1] neg_hi:[0,1]
 v_pk_add_f32 v[70:71], v[70:71], v[60:61] op_sel_hi:[1,0] neg_lo:[0,1] neg_hi:[0,1]
 v_pk_add_f32 v[72:73], v[72:73], v[60:61] op_sel_hi:[1,0] neg_lo:[0,1] neg_hi:[0,1]
 v_pk_add_f32 v[74:75], v[74:75], v[60:61] op_sel_hi:[1,0] neg_lo:[0,1] neg_hi:[0,1]
 s_branch L_mxb0
L_ch_km1:
 buffer_store_dwordx4 v[88:91], v97, s[36:39], s67 offen sc1
 s_cmp_lt_u32 s56, 63
 s_cbranch_scc1 L_ch_kmb1
 s_branch L_ch_exit
.p2align 8
L_fetch1:
 s_mov_b32 s7, 524288
 s_nop 15
 s_nop 15
 buffer_load_dwordx4 v[24:27], v97, s[36:39], s71 offen offset:0 sc1
 buffer_load_dwordx4 v[28:31], v97, s[36:39], s71 offen offset:1024 sc1
 s_nop 15
 buffer_load_dwordx4 v[24:27], v97, s[36:39], s71 offen offset:0 sc1
 buffer_load_dwordx4 v[28:31], v97, s[36:39], s71 offen offset:1024 sc1
 s_nop 15
 s_mov_b64 vcc, -1
L_er1:
 s_mov_b64 exec, vcc
 buffer_load_dwordx4 v[24:27], v97, s[36:39], s71 offen offset:0 sc1
 buffer_load_dwordx4 v[28:31], v97, s[36:39], s71 offen offset:1024 sc1
 s_mov_b64 exec, -1
 s_sub_u32 s7, s7, 1
 s_cbranch_scc1 L_abort
 s_waitcnt vmcnt(4)
 v_max3_u32 v110, v24, v24, v25
 v_max3_u32 v110, v110, v26, v27
 v_max3_u32 v110, v110, v28, v29
 v_max3_u32 v110, v110, v30, v31
 v_cmp_eq_u32 vcc, -1, v110
 s_cbranch_vccnz L_er1
 ds_write_b128 v111, v[24:27]
 ds_write_b128 v111, v[28:31] offset:1024
 s_barrier
 s_waitcnt lgkmcnt(0)
 s_barrier
 ds_read_b128 v[0:3], v101 offset:0
 ds_read_b128 v[4:7], v101 offset:1024
 ds_read_b128 v[8:11], v101 offset:2048
 ds_read_b128 v[12:15], v101 offset:3072
 s_add_u32 s65, s65, 524288
 s_xor_b32 s66, s66, 0x3c000
 s_mov_b32 m0, s66
 s_mul_i32 s100, s57, 40
 s_add_u32 s60, s100, s40
 s_waitcnt lgkmcnt(3)
 v_smfmac_f32_16x16x64_bf16 v[64:67], v[0:3], a[0:7], v96
 s_add_u32 s74, s60, 4096
 s_add_u32 s61, s100, s41
 s_mul_i32 s100, s59, 40
 v_smfmac_f32_16x16x64_bf16 v[68:71], v[0:3], a[8:15], v96
 buffer_load_dwordx4 v97, s[36:39], s65 offen offset:0 sc1 lds
 s_add_u32 s62, s100, s41
 s_add_u32 s63, s58, 15728640
 v_smfmac_f32_16x16x64_bf16 v[72:75], v[0:3], a[128:135], v96
 s_add_u32 s64, s57, 15728640
 s_xor_b32 s68, s68, 4096
 s_lshr_b32 s69, s56, 1
 v_smfmac_f32_16x16x64_bf16 v[76:79], v[0:3], a[136:143], v96
 s_waitcnt lgkmcnt(2)
 s_add_u32 s69, s69, 2
 s_cmp_gt_u32 s56, 61
 s_cselect_b32 s69, 0, s69
 v_smfmac_f32_16x16x64_bf16 v[64:67], v[4:7], a[16:23], v96
 v_smfmac_f32_16x16x64_bf16 v[68:71], v[4:7], a[24:31], v96
 buffer_load_dwordx4 v97, s[36:39], s65 offen offset:1024 sc1 lds
 v_smfmac_f32_16x16x64_bf16 v[72:75], v[4:7], v[32:39], v96
 ds_read_b128 v[32:35], v97 offset:32768
 v_smfmac_f32_16x16x64_bf16 v[76:79], v[4:7], v[40:47], v96
 s_waitcnt lgkmcnt(2)
 v_smfmac_f32_16x16x64_bf16 v[64:67], v[8:11], a[32:39], v96
 ds_read_b128 v[36:39], v97 offset:33792
 v_smfmac_f32_16x16x64_bf16 v[68:71], v[8:11], a[40:47], v96
 ds_read_b128 v[40:43], v97 offset:34816
 buffer_load_dwordx4 v97, s[36:39], s65 offen offset:2048 sc1 lds
 v_smfmac_f32_16x16x64_bf16 v[72:75], v[8:11], a[144:151], v96
 ds_read_b128 v[44:47], v97 offset:35840
 v_smfmac_f32_16x16x64_bf16 v[76:79], v[8:11], a[152:159], v96
 s_waitcnt lgkmcnt(4)
 v_smfmac_f32_16x16x64_bf16 v[64:67], v[12:15], a[48:55], v96
 s_waitcnt vmcnt(3)
 v_smfmac_f32_16x16x64_bf16 v[68:71], v[12:15], a[56:63], v96
 buffer_load_dwordx4 v97, s[36:39], s65 offen offset:3072 sc1 lds
 v_smfmac_f32_16x16x64_bf16 v[72:75], v[12:15], v[48:55], v96
 v_smfmac_f32_16x16x64_bf16 v[76:79], v[12:15], v[56:63], v96
 v_smfmac_f32_16x16x64_bf16 v[80:83], v[0:3], a[192:199], v96
 s_barrier
 ds_read_b128 v[16:19], v101 offset:4096
 v_smfmac_f32_16x16x64_bf16 v[84:87], v[0:3], a[200:207], v96
 ds_read_b128 v[20:23], v101 offset:5120
 v_smfmac_f32_16x16x64_bf16 v[80:83], v[4:7], a[208:215], v96
 v_smfmac_f32_16x16x64_bf16 v[84:87], v[4:7], a[216:223], v96
 buffer_store_dwordx4 v[88:91], v97, s[36:39], s75 offen sc1
 s_waitcnt lgkmcnt(1)
 v_smfmac_f32_16x16x64_bf16 v[64:67], v[16:19], a[64:71], v96
 ds_read_b128 v[24:27], v101 offset:6144
 v_mov_b64 v[88:89], -1
 v_smfmac_f32_16x16x64_bf16 v[68:71], v[16:19], a[72:79], v96
 ds_read_b128 v[48:51], v97 offset:49152
 v_mov_b64 v[90:91], -1
 v_smfmac_f32_16x16x64_bf16 v[72:75], v[16:19], a[160:167], v96
 ds_read_b128 v[28:31], v101 offset:7168
 ds_read_b128 v[52:55], v97 offset:50176
 v_smfmac_f32_16x16x64_bf16 v[76:79], v[16:19], a[168:175], v96
 s_waitcnt lgkmcnt(4)
 v_smfmac_f32_16x16x64_bf16 v[64:67], v[20:23], a[80:87], v96
 v_smfmac_f32_16x16x64_bf16 v[68:71], v[20:23], a[88:95], v96
 ds_read_b128 v[56:59], v97 offset:51200
 s_waitcnt lgkmcnt(7)
 v_smfmac_f32_16x16x64_bf16 v[72:75], v[20:23], v[32:39], v96
 buffer_store_dwordx4 v[88:91], v97, s[36:39], s62 offen offset:0
 ds_read_b128 v[60:63], v97 offset:52224
 v_smfmac_f32_16x16x64_bf16 v[76:79], v[20:23], v[40:47], v96
 s_waitcnt lgkmcnt(5)
 v_smfmac_f32_16x16x64_bf16 v[64:67], v[24:27], a[96:103], v96
 v_smfmac_f32_16x16x64_bf16 v[68:71], v[24:27], a[104:111], v96
 ds_read_b128 v[0:3], v99 offset:2048
 v_smfmac_f32_16x16x64_bf16 v[72:75], v[24:27], a[176:183], v96
 v_smfmac_f32_16x16x64_bf16 v[76:79], v[24:27], a[184:191], v96
 ds_read_b128 v[4:7], v99 offset:3072
 s_waitcnt lgkmcnt(5)
 v_smfmac_f32_16x16x64_bf16 v[64:67], v[28:31], a[112:119], v96
 buffer_store_dwordx4 v[88:91], v97, s[36:39], s62 offen offset:1024
 v_smfmac_f32_16x16x64_bf16 v[68:71], v[28:31], a[120:127], v96
 s_waitcnt lgkmcnt(2)
 v_smfmac_f32_16x16x64_bf16 v[72:75], v[28:31], v[48:55], v96
 v_smfmac_f32_16x16x64_bf16 v[76:79], v[28:31], v[56:63], v96
 v_add_f32 v64, v64, v66
 v_add_f32 v65, v65, v67
 v_add_f32 v68, v68, v70
 v_add_f32 v69, v69, v71
 v_cvt_pk_bf16_f32 v48, v64, v68
 v_cvt_pk_bf16_f32 v49, v65, v69
 ds_write2_b32 v104, v48, v49 offset1:16
 v_add_f32 v72, v72, v74
 v_add_f32 v73, v73, v75
 v_add_f32 v76, v76, v78
 v_add_f32 v77, v77, v79
 v_cvt_pk_bf16_f32 v88, v72, v76
 v_cvt_pk_bf16_f32 v89, v73, v77
 ds_write2_b32 v104, v88, v89 offset0:128 offset1:144
 v_smfmac_f32_16x16x64_bf16 v[80:83], v[8:11], a[224:231], v96
 v_smfmac_f32_16x16x64_bf16 v[84:87], v[8:11], a[232:239], v96
 ds_read_b128 v[8:11], v99 offset:6144
 v_smfmac_f32_16x16x64_bf16 v[80:83], v[12:15], a[240:247], v96
 v_smfmac_f32_16x16x64_bf16 v[84:87], v[12:15], a[248:255], v96
 ds_read_b128 v[12:15], v99 offset:7168
 v_smfmac_f32_16x16x64_bf16 v[80:83], v[16:19], v[112:119], v96
 s_waitcnt lgkmcnt(2)
 s_barrier
 v_smfmac_f32_16x16x64_bf16 v[84:87], v[16:19], v[120:127], v96
 ds_read_b128 v[32:35], v105 offset:0
 v_smfmac_f32_16x16x64_bf16 v[80:83], v[20:23], v[128:135], v96
 ds_read_b128 v[36:39], v105 offset:512
 v_smfmac_f32_16x16x64_bf16 v[84:87], v[20:23], v[136:143], v96
 ds_read_b128 v[40:43], v105 offset:1024
 v_smfmac_f32_16x16x64_bf16 v[80:83], v[24:27], v[144:151], v96
 ds_read_b128 v[44:47], v105 offset:1536
 v_smfmac_f32_16x16x64_bf16 v[84:87], v[24:27], v[152:159], v96
 ds_read_b128 v[16:19], v99 offset:10240
 v_smfmac_f32_16x16x64_bf16 v[80:83], v[28:31], v[160:167], v96
 ds_read_b128 v[48:51], v105 offset:2048
 v_smfmac_f32_16x16x64_bf16 v[84:87], v[28:31], v[168:175], v96
 ds_read_b128 v[20:23], v99 offset:11264
 s_waitcnt lgkmcnt(5)
 v_mfma_f32_16x16x32_bf16 v[68:71], v[0:3], v[32:35], 0
 ds_read_b128 v[52:55], v105 offset:2560
 v_mfma_f32_16x16x32_bf16 v[72:75], v[4:7], v[32:35], 0
 ds_read_b128 v[24:27], v99 offset:14336
 v_mfma_f32_16x16x32_bf16 v[64:67], v[36:39], v[32:35], 0
 ds_read_b128 v[56:59], v105 offset:3072
 v_add_f32 v80, v80, v82
 v_add_f32 v81, v81, v83
 s_waitcnt lgkmcnt(6)
 v_mfma_f32_16x16x32_bf16 v[68:71], v[8:11], v[40:43], v[68:71]
 ds_read_b128 v[28:31], v99 offset:15360
 v_add_f32 v84, v84, v86
 v_add_f32 v85, v85, v87
 v_mfma_f32_16x16x32_bf16 v[72:75], v[12:15], v[40:43], v[72:75]
 ds_read_b128 v[60:63], v105 offset:3584
 v_cvt_pk_bf16_f32 v90, v80, v81
 v_cvt_pk_bf16_f32 v91, v84, v85
 s_cmp_ge_u32 s56, 60
 v_mfma_f32_16x16x32_bf16 v[64:67], v[44:47], v[40:43], v[64:67]
 ds_read_b128 v[32:35], v100 offset:0
 s_cbranch_scc1 L_ch_km1
L_ch_kmb1:
 s_waitcnt lgkmcnt(5)
 v_mfma_f32_16x16x32_bf16 v[68:71], v[16:19], v[48:51], v[68:71]
 ds_read_b128 v[36:39], v100 offset:1024
 v_mfma_f32_16x16x32_bf16 v[72:75], v[20:23], v[48:51], v[72:75]
 v_mov_b64 v[40:41], s[76:77]
 v_mov_b64 v[42:43], s[76:77]
 v_mfma_f32_16x16x32_bf16 v[64:67], v[52:55], v[48:51], v[64:67]
 v_mov_b64 v[0:1], 0
 v_mov_b64 v[2:3], 0
 s_waitcnt lgkmcnt(2)
 v_mfma_f32_16x16x32_bf16 v[68:71], v[24:27], v[56:59], v[68:71]
 v_mov_b64 v[4:5], 0
 v_mov_b64 v[6:7], 0
 v_mfma_f32_16x16x32_bf16 v[72:75], v[28:31], v[56:59], v[72:75]
 v_mov_b64 v[8:9], 0
 v_mov_b64 v[10:11], 0
 v_mfma_f32_16x16x32_bf16 v[64:67], v[60:63], v[56:59], v[64:67]
 v_mov_b64 v[12:13], 0
 v_mov_b64 v[14:15], 0
 v_mov_b64 v[16:17], 0
 v_max3_f32 v60, |v68|, |v69|, |v70|
 v_max3_f32 v61, |v71|, |v72|, |v73|
 v_max3_f32 v62, |v74|, |v75|, v60
 s_nop 0
 v_max3_f32 v60, |v64|, |v65|, v61
 v_max_f32 v60, v60, v62
 v_cmp_nge_f32 vcc, s90, v60
 v_pk_mul_f32 v[68:69], v[68:69], s[88:89]
 v_pk_mul_f32 v[70:71], v[70:71], s[88:89]
 v_pk_mul_f32 v[72:73], v[72:73], s[88:89]
 v_pk_mul_f32 v[74:75], v[74:75], s[88:89]
 v_pk_mul_f32 v[64:65], v[64:65], s[88:89]
 s_cbranch_vccnz L_mx1
L_mxb1:
 v_exp_f32 v64, v64
 v_exp_f32 v65, v65
 v_exp_f32 v68, v68
 v_cvt_pk_bf16_f32 v92, v64, v65
 v_cvt_pk_bf16_f32 v95, v64, v65
 v_exp_f32 v69, v69
 v_mfma_f32_16x16x16_bf16 v[56:59], v[40:41], v[92:93], 0
 v_exp_f32 v70, v70
 v_cvt_pk_bf16_f32 v44, v68, v69
 v_exp_f32 v71, v71
 v_mfma_f32_16x16x16_bf16 v[48:51], v[90:91], v[92:93], 0
 v_exp_f32 v72, v72
 v_cvt_pk_bf16_f32 v45, v70, v71
 v_exp_f32 v73, v73
 v_mfma_f32_16x16x16_bf16 v[52:55], v[90:91], v[94:95], 0
 v_exp_f32 v74, v74
 v_cvt_pk_bf16_f32 v46, v72, v73
 v_exp_f32 v75, v75
 s_waitcnt lgkmcnt(0)
 v_cvt_pk_bf16_f32 v47, v74, v75
 v_mov_b64 v[18:19], 0
 v_mov_b64 v[20:21], 0
 v_mfma_f32_16x16x32_bf16 v[56:59], v[40:43], v[44:47], v[56:59]
 v_mov_b64 v[22:23], 0
 v_mov_b64 v[24:25], 0
 v_mfma_f32_16x16x32_bf16 v[48:51], v[32:35], v[44:47], v[48:51]
 v_mov_b64 v[26:27], 0
 v_mov_b64 v[28:29], 0
 v_mfma_f32_16x16x32_bf16 v[52:55], v[36:39], v[44:47], v[52:55]
 v_mov_b64 v[30:31], 0
 ds_read_b128 v[80:83], v98 offset:0
 v_rcp_f32 v56, v56
 ds_read_b128 v[84:87], v98 offset:1024
 v_mul_f32 v48, v48, v56
 v_mul_f32 v49, v49, v56
 v_mul_f32 v50, v50, v56
 v_mul_f32 v51, v51, v56
 v_cvt_pk_bf16_f32 v44, v48, v49
 v_cvt_pk_bf16_f32 v45, v50, v51
 v_mul_f32 v52, v52, v56
 v_mul_f32 v53, v53, v56
 v_mul_f32 v54, v54, v56
 v_mul_f32 v55, v55, v56
 v_cvt_pk_bf16_f32 v46, v52, v53
 v_cvt_pk_bf16_f32 v47, v54, v55
 ds_write_b128 v106, v[44:47]
 ds_read_b128 v[32:35], v98 offset:2048
 ds_read_b128 v[36:39], v98 offset:3072
 s_waitcnt lgkmcnt(2)
 s_barrier
 ds_read_b128 v[64:67], v107
 ds_read_b128 v[68:71], v107 offset:1024
 s_waitcnt lgkmcnt(1)
 v_smfmac_f32_16x16x64_bf16 v[0:3], v[64:67], v[176:183], v96
 s_waitcnt lgkmcnt(0)
 ds_read_b128 v[72:75], v98 offset:4096
 v_smfmac_f32_16x16x64_bf16 v[0:3], v[68:71], v[184:191], v96
 ds_read_b128 v[76:79], v98 offset:5120
 s_add_u32 s71, s58, s73
 v_xor_b32 v99, 0x3c000, v99
 v_smfmac_f32_16x16x64_bf16 v[4:7], v[64:67], v[192:199], v96
 ds_read_b128 v[56:59], v98 offset:6144
 s_add_u32 s72, s58, s44
 v_xor_b32 v100, 0x3c000, v100
 v_smfmac_f32_16x16x64_bf16 v[4:7], v[68:71], v[200:207], v96
 ds_read_b128 v[60:63], v98 offset:7168
 s_mov_b32 s100, s57
 v_add_f32 v0, v0, v2
 v_add_f32 v1, v1, v3
 v_smfmac_f32_16x16x64_bf16 v[8:11], v[64:67], v[208:215], v96
 ds_read_b128 v[40:43], v98 offset:8192
 s_mov_b32 s57, s58
 v_cvt_pk_bf16_f32 v48, v0, v1
 v_smfmac_f32_16x16x64_bf16 v[8:11], v[68:71], v[216:223], v96
 ds_read_b128 v[44:47], v98 offset:9216
 s_mov_b32 s58, s59
 v_add_f32 v4, v4, v6
 v_add_f32 v5, v5, v7
 v_smfmac_f32_16x16x64_bf16 v[12:15], v[64:67], v[224:231], v96
 s_mov_b32 s59, s100
 v_cvt_pk_bf16_f32 v49, v4, v5
 v_smfmac_f32_16x16x64_bf16 v[12:15], v[68:71], v[232:239], v96
 buffer_store_dwordx2 v[48:49], v102, s[36:39], s60 offen offset:0
 s_add_u32 s56, s56, 1
 v_add_f32 v8, v8, v10
 v_add_f32 v9, v9, v11
 v_smfmac_f32_16x16x64_bf16 v[16:19], v[64:67], v[240:247], v96
 s_mov_b32 s75, s67
 v_cvt_pk_bf16_f32 v50, v8, v9
 v_smfmac_f32_16x16x64_bf16 v[16:19], v[68:71], v[248:255], v96
 s_waitcnt lgkmcnt(0)
 s_add_u32 s67, s67, 131072
 v_add_f32 v12, v12, v14
 v_add_f32 v13, v13, v15
 v_smfmac_f32_16x16x64_bf16 v[20:23], v[64:67], v[80:87], v96
 ds_read_b128 v[80:83], v98 offset:10240
 ds_read_b128 v[84:87], v98 offset:11264
 v_cvt_pk_bf16_f32 v51, v12, v13
 v_smfmac_f32_16x16x64_bf16 v[20:23], v[68:71], v[32:39], v96
 buffer_store_dwordx2 v[50:51], v102, s[36:39], s60 offen offset:2048
 v_add_f32 v16, v16, v18
 v_add_f32 v17, v17, v19
 v_smfmac_f32_16x16x64_bf16 v[24:27], v[64:67], v[72:79], v96
 v_cvt_pk_bf16_f32 v52, v16, v17
 v_smfmac_f32_16x16x64_bf16 v[24:27], v[68:71], v[56:63], v96
 v_add_f32 v20, v20, v22
 v_add_f32 v21, v21, v23
 v_smfmac_f32_16x16x64_bf16 v[28:31], v[64:67], v[40:47], v96
 s_waitcnt lgkmcnt(0)
 v_cvt_pk_bf16_f32 v53, v20, v21
 v_smfmac_f32_16x16x64_bf16 v[28:31], v[68:71], v[80:87], v96
 buffer_store_dwordx2 v[52:53], v102, s[36:39], s74 offen offset:0
 v_add_f32 v24, v24, v26
 v_add_f32 v25, v25, v27
 v_cvt_pk_bf16_f32 v54, v24, v25
 s_nop 3
 v_add_f32 v28, v28, v30
 v_add_f32 v29, v29, v31
 v_cvt_pk_bf16_f32 v55, v28, v29
 buffer_store_dwordx2 v[54:55], v102, s[36:39], s74 offen offset:2048
 v_cndmask_b32 v0, 0, v108, s[78:79]
 v_cndmask_b32 v1, 0, v108, s[80:81]
 v_cndmask_b32 v2, 0, v108, s[82:83]
 v_cndmask_b32 v3, 0, v108, s[84:85]
 v_mov_b64 v[24:25], -1
 s_nop 11
 buffer_load_dwordx4 v[16:19], v97, s[36:39], s61 offen offset:0 sc1
 buffer_load_dwordx4 v[20:23], v97, s[36:39], s61 offen offset:1024 sc1
 v_mov_b64 v[64:65], 0
 v_mov_b64 v[66:67], 0
 v_mov_b64 v[68:69], 0
 v_mov_b64 v[70:71], 0
 v_mov_b64 v[72:73], 0
 v_mov_b64 v[74:75], 0
 v_mov_b64 v[76:77], 0
 v_mov_b64 v[78:79], 0
 v_mov_b64 v[80:81], 0
 v_mov_b64 v[82:83], 0
 v_mov_b64 v[84:85], 0
 v_mov_b64 v[86:87], 0
 ds_read_b128 v[32:35], v97 offset:0
 ds_read_b128 v[36:39], v97 offset:1024
 ds_read_b128 v[40:43], v97 offset:2048
 ds_read_b128 v[44:47], v97 offset:3072
 ds_read_b128 v[48:51], v97 offset:16384
 ds_read_b128 v[52:55], v97 offset:17408
 ds_read_b128 v[56:59], v97 offset:18432
 ds_read_b128 v[60:63], v97 offset:19456
 s_nop 7
 s_mov_b32 s7, 524288
 s_mov_b64 vcc, -1
L_red1:
 s_mov_b64 exec, vcc
 buffer_load_dwordx4 v[16:19], v97, s[36:39], s61 offen offset:0 sc1
 buffer_load_dwordx4 v[20:23], v97, s[36:39], s61 offen offset:1024 sc1
 s_mov_b64 exec, -1
 s_sub_u32 s7, s7, 1
 s_cbranch_scc1 L_abort
 s_waitcnt vmcnt(2)
 v_max3_u32 v110, v16, v16, v17
 v_max3_u32 v110, v110, v18, v19
 v_mfma_f32_16x16x32_bf16 v[4:7], v[0:3], v[16:19], 0
 v_max3_u32 v110, v110, v20, v21
 v_max3_u32 v110, v110, v22, v23
 v_mfma_f32_16x16x32_bf16 v[4:7], v[0:3], v[20:23], v[4:7]
 v_cmp_eq_u32 vcc, -1, v110
 s_cbranch_vccnz L_red1
 s_nop 0
 v_add_f32_dpp v4, v4, v4 row_ror:4 row_mask:0xf bank_mask:0xf
 v_add_f32_dpp v5, v5, v5 row_ror:4 row_mask:0xf bank_mask:0xf
 v_add_f32_dpp v6, v6, v6 row_ror:4 row_mask:0xf bank_mask:0xf
 v_add_f32_dpp v7, v7, v7 row_ror:4 row_mask:0xf bank_mask:0xf
 v_add_f32_dpp v4, v4, v4 row_ror:8 row_mask:0xf bank_mask:0xf
 v_add_f32_dpp v5, v5, v5 row_ror:8 row_mask:0xf bank_mask:0xf
 v_add_f32_dpp v6, v6, v6 row_ror:8 row_mask:0xf bank_mask:0xf
 v_add_f32_dpp v7, v7, v7 row_ror:8 row_mask:0xf bank_mask:0xf
 v_cvt_pk_bf16_f32 v4, v4, v5
 v_cvt_pk_bf16_f32 v5, v6, v7
 s_mov_b64 exec, 0x000f000f
 buffer_store_dwordx2 v[4:5], v103, s[36:39], s63 offen
 buffer_store_dwordx2 v[24:25], v103, s[36:39], s64 offen
 s_mov_b64 exec, -1
 s_branch L_fetch1
L_mx1:
 v_max3_f32 v60, v68, v69, v70
 v_max3_f32 v61, v71, v72, v73
 v_max3_f32 v62, v74, v75, v60
 v_max3_f32 v60, v64, v65, v61
 v_max_f32 v61, v60, v62
 v_max_f32 v63, v60, v62
 s_nop 1
 v_permlane16_swap_b32 v61, v63
 v_max_f32 v60, v61, v63
 v_max_f32 v62, v61, v63
 s_nop 1
 v_permlane32_swap_b32 v60, v62
 v_max_f32 v60, v60, v62
 v_pk_add_f32 v[64:65], v[64:65], v[60:61] op_sel_hi:[1,0] neg_lo:[0,1] neg_hi:[0,1]
 v_pk_add_f32 v[68:69], v[68:69], v[60:61] op_sel_hi:[1,0] neg_lo:[0,1] neg_hi:[0,1]
 v_pk_add_f32 v[70:71], v[70:71], v[60:61] op_sel_hi:[1,0] neg_lo:[0,1] neg_hi:[0,1]
 v_pk_add_f32 v[72:73], v[72:73], v[60:61] op_sel_hi:[1,0] neg_lo:[0,1] neg_hi:[0,1]
 v_pk_add_f32 v[74:75], v[74:75], v[60:61] op_sel_hi:[1,0] neg_lo:[0,1] neg_hi:[0,1]
 s_branch L_mxb1
L_ch_km2:
 buffer_store_dwordx4 v[88:91], v97, s[36:39], s67 offen sc1
 s_cmp_lt_u32 s56, 63
 s_cbranch_scc1 L_ch_kmb2
 s_branch L_ch_exit
L_lr2:
 s_mov_b32 m0, s42
 s_mov_b32 s7, 524288
L_lr12:
 buffer_load_dwordx4 v[24:27], v97, s[36:39], s71 offen offset:0 sc1
 buffer_load_dwordx4 v[28:31], v97, s[36:39], s71 offen offset:1024 sc1
 buffer_load_dwordx4 v97, s[36:39], s71 offen offset:0 sc1 lds
 buffer_load_dwordx4 v97, s[36:39], s71 offen offset:1024 sc1 lds
 s_sub_u32 s7, s7, 1
 s_cbranch_scc1 L_abort
 s_waitcnt vmcnt(0)
 v_max3_u32 v110, v24, v24, v25
 v_max3_u32 v110, v110, v26, v27
 v_max3_u32 v110, v110, v28, v29
 v_max3_u32 v110, v110, v30, v31
 v_cmp_eq_u32 vcc, -1, v110
 s_cbranch_vccnz L_lr12
 s_mov_b32 m0, s66
 s_branch L_lk2
.p2align 8
L_fetch2:
 s_mov_b32 m0, s42
 s_barrier
 buffer_load_dwordx4 v[24:27], v97, s[36:39], s71 offen offset:0 sc1
 buffer_load_dwordx4 v[28:31], v97, s[36:39], s71 offen offset:1024 sc1
 buffer_load_dwordx4 v97, s[36:39], s71 offen offset:0 sc1 lds
 buffer_load_dwordx4 v97, s[36:39], s71 offen offset:1024 sc1 lds
 s_waitcnt lgkmcnt(0)
 s_barrier
 ds_read_b128 v[0:3], v101 offset:0
 ds_read_b128 v[4:7], v101 offset:1024
 ds_read_b128 v[8:11], v101 offset:2048
 ds_read_b128 v[12:15], v101 offset:3072
 s_add_u32 s65, s65, 524288
 s_xor_b32 s66, s66, 0x3c000
 s_mov_b32 m0, s66
 s_mul_i32 s100, s57, 40
 s_add_u32 s60, s100, s40
 s_waitcnt lgkmcnt(3)
 v_smfmac_f32_16x16x64_bf16 v[64:67], v[0:3], a[0:7], v96
 s_add_u32 s74, s60, 4096
 s_add_u32 s61, s100, s41
 s_mul_i32 s100, s59, 40
 v_smfmac_f32_16x16x64_bf16 v[68:71], v[0:3], a[8:15], v96
 s_add_u32 s62, s100, s41
 s_add_u32 s63, s58, 15728640
 s_add_u32 s64, s57, 15728640
 v_smfmac_f32_16x16x64_bf16 v[72:75], v[0:3], a[128:135], v96
 buffer_load_dwordx4 v97, s[36:39], s65 offen offset:0 sc1 lds
 s_xor_b32 s68, s68, 4096
 s_lshr_b32 s69, s56, 1
 v_smfmac_f32_16x16x64_bf16 v[76:79], v[0:3], a[136:143], v96
 s_waitcnt lgkmcnt(2)
 s_add_u32 s69, s69, 2
 s_cmp_gt_u32 s56, 61
 s_cselect_b32 s69, 0, s69
 v_smfmac_f32_16x16x64_bf16 v[64:67], v[4:7], a[16:23], v96
 v_smfmac_f32_16x16x64_bf16 v[68:71], v[4:7], a[24:31], v96
 v_smfmac_f32_16x16x64_bf16 v[72:75], v[4:7], v[32:39], v96
 ds_read_b128 v[32:35], v97 offset:32768
 buffer_load_dwordx4 v97, s[36:39], s65 offen offset:1024 sc1 lds
 v_smfmac_f32_16x16x64_bf16 v[76:79], v[4:7], v[40:47], v96
 s_waitcnt lgkmcnt(2)
 v_smfmac_f32_16x16x64_bf16 v[64:67], v[8:11], a[32:39], v96
 ds_read_b128 v[36:39], v97 offset:33792
 v_smfmac_f32_16x16x64_bf16 v[68:71], v[8:11], a[40:47], v96
 ds_read_b128 v[40:43], v97 offset:34816
 v_smfmac_f32_16x16x64_bf16 v[72:75], v[8:11], a[144:151], v96
 ds_read_b128 v[44:47], v97 offset:35840
 buffer_load_dwordx4 v97, s[36:39], s65 offen offset:2048 sc1 lds
 v_smfmac_f32_16x16x64_bf16 v[76:79], v[8:11], a[152:159], v96
 s_waitcnt lgkmcnt(4)
 v_smfmac_f32_16x16x64_bf16 v[64:67], v[12:15], a[48:55], v96
 s_waitcnt vmcnt(3)
 v_max3_u32 v110, v24, v24, v25
 v_smfmac_f32_16x16x64_bf16 v[68:71], v[12:15], a[56:63], v96
 v_max3_u32 v110, v110, v26, v27
 v_max3_u32 v110, v110, v28, v29
 v_smfmac_f32_16x16x64_bf16 v[72:75], v[12:15], v[48:55], v96
 buffer_load_dwordx4 v97, s[36:39], s65 offen offset:3072 sc1 lds
 v_max3_u32 v110, v110, v30, v31
 v_cmp_eq_u32 vcc, -1, v110
 v_smfmac_f32_16x16x64_bf16 v[76:79], v[12:15], v[56:63], v96
 v_smfmac_f32_16x16x64_bf16 v[80:83], v[0:3], a[192:199], v96
 s_cbranch_vccnz L_lr2
L_lk2:
 s_barrier
 ds_read_b128 v[16:19], v101 offset:4096
 v_smfmac_f32_16x16x64_bf16 v[84:87], v[0:3], a[200:207], v96
 ds_read_b128 v[20:23], v101 offset:5120
 v_smfmac_f32_16x16x64_bf16 v[80:83], v[4:7], a[208:215], v96
 v_smfmac_f32_16x16x64_bf16 v[84:87], v[4:7], a[216:223], v96
 s_waitcnt lgkmcnt(1)
 v_smfmac_f32_16x16x64_bf16 v[64:67], v[16:19], a[64:71], v96
 ds_read_b128 v[24:27], v101 offset:6144
 v_smfmac_f32_16x16x64_bf16 v[68:71], v[16:19], a[72:79], v96
 buffer_store_dwordx4 v[88:91], v97, s[36:39], s75 offen sc1
 ds_read_b128 v[48:51], v97 offset:49152
 v_smfmac_f32_16x16x64_bf16 v[72:75], v[16:19], a[160:167], v96
 ds_read_b128 v[28:31], v101 offset:7168
 ds_read_b128 v[52:55], v97 offset:50176
 v_mov_b64 v[88:89], -1
 v_smfmac_f32_16x16x64_bf16 v[76:79], v[16:19], a[168:175], v96
 s_waitcnt lgkmcnt(4)
 v_mov_b64 v[90:91], -1
 v_smfmac_f32_16x16x64_bf16 v[64:67], v[20:23], a[80:87], v96
 v_smfmac_f32_16x16x64_bf16 v[68:71], v[20:23], a[88:95], v96
 ds_read_b128 v[56:59], v97 offset:51200
 s_waitcnt lgkmcnt(7)
 v_smfmac_f32_16x16x64_bf16 v[72:75], v[20:23], v[32:39], v96
 ds_read_b128 v[60:63], v97 offset:52224
 v_smfmac_f32_16x16x64_bf16 v[76:79], v[20:23], v[40:47], v96
 s_waitcnt lgkmcnt(5)
 v_smfmac_f32_16x16x64_bf16 v[64:67], v[24:27], a[96:103], v96
 buffer_store_dwordx4 v[88:91], v97, s[36:39], s62 offen offset:0
 v_smfmac_f32_16x16x64_bf16 v[68:71], v[24:27], a[104:111], v96
 ds_read_b128 v[0:3], v99 offset:2048
 v_smfmac_f32_16x16x64_bf16 v[72:75], v[24:27], a[176:183], v96
 v_smfmac_f32_16x16x64_bf16 v[76:79], v[24:27], a[184:191], v96
 ds_read_b128 v[4:7], v99 offset:3072
 s_waitcnt lgkmcnt(5)
 v_smfmac_f32_16x16x64_bf16 v[64:67], v[28:31], a[112:119], v96
 v_smfmac_f32_16x16x64_bf16 v[68:71], v[28:31], a[120:127], v96
 s_waitcnt lgkmcnt(2)
 v_smfmac_f32_16x16x64_bf16 v[72:75], v[28:31], v[48:55], v96
 buffer_store_dwordx4 v[88:91], v97, s[36:39], s62 offen offset:1024
 v_smfmac_f32_16x16x64_bf16 v[76:79], v[28:31], v[56:63], v96
 v_add_f32 v64, v64, v66
 v_add_f32 v65, v65, v67
 v_add_f32 v68, v68, v70
 v_add_f32 v69, v69, v71
 v_cvt_pk_bf16_f32 v48, v64, v68
 v_cvt_pk_bf16_f32 v49, v65, v69
 ds_write2_b32 v104, v48, v49 offset1:16
 v_add_f32 v72, v72, v74
 v_add_f32 v73, v73, v75
 v_add_f32 v76, v76, v78
 v_add_f32 v77, v77, v79
 v_cvt_pk_bf16_f32 v88, v72, v76
 v_cvt_pk_bf16_f32 v89, v73, v77
 ds_write2_b32 v104, v88, v89 offset0:128 offset1:144
 v_smfmac_f32_16x16x64_bf16 v[80:83], v[8:11], a[224:231], v96
 v_smfmac_f32_16x16x64_bf16 v[84:87], v[8:11], a[232:239], v96
 ds_read_b128 v[8:11], v99 offset:6144
 v_smfmac_f32_16x16x64_bf16 v[80:83], v[12:15], a[240:247], v96
 v_smfmac_f32_16x16x64_bf16 v[84:87], v[12:15], a[248:255], v96
 ds_read_b128 v[12:15], v99 offset:7168
 v_smfmac_f32_16x16x64_bf16 v[80:83], v[16:19], v[112:119], v96
 s_waitcnt lgkmcnt(2)
 s_barrier
 v_smfmac_f32_16x16x64_bf16 v[84:87], v[16:19], v[120:127], v96
 ds_read_b128 v[32:35], v105 offset:0
 v_smfmac_f32_16x16x64_bf16 v[80:83], v[20:23], v[128:135], v96
 ds_read_b128 v[36:39], v105 offset:512
 v_smfmac_f32_16x16x64_bf16 v[84:87], v[20:23], v[136:143], v96
 ds_read_b128 v[40:43], v105 offset:1024
 v_smfmac_f32_16x16x64_bf16 v[80:83], v[24:27], v[144:151], v96
 ds_read_b128 v[44:47], v105 offset:1536
 v_smfmac_f32_16x16x64_bf16 v[84:87], v[24:27], v[152:159], v96
 ds_read_b128 v[16:19], v99 offset:10240
 v_smfmac_f32_16x16x64_bf16 v[80:83], v[28:31], v[160:167], v96
 ds_read_b128 v[48:51], v105 offset:2048
 v_smfmac_f32_16x16x64_bf16 v[84:87], v[28:31], v[168:175], v96
 ds_read_b128 v[20:23], v99 offset:11264
 s_waitcnt lgkmcnt(5)
 v_mfma_f32_16x16x32_bf16 v[68:71], v[0:3], v[32:35], 0
 ds_read_b128 v[52:55], v105 offset:2560
 v_mfma_f32_16x16x32_bf16 v[72:75], v[4:7], v[32:35], 0
 ds_read_b128 v[24:27], v99 offset:14336
 v_mfma_f32_16x16x32_bf16 v[64:67], v[36:39], v[32:35], 0
 ds_read_b128 v[56:59], v105 offset:3072
 v_add_f32 v80, v80, v82
 v_add_f32 v81, v81, v83
 s_waitcnt lgkmcnt(6)
 v_mfma_f32_16x16x32_bf16 v[68:71], v[8:11], v[40:43], v[68:71]
 ds_read_b128 v[28:31], v99 offset:15360
 v_add_f32 v84, v84, v86
 v_add_f32 v85, v85, v87
 v_mfma_f32_16x16x32_bf16 v[72:75], v[12:15], v[40:43], v[72:75]
 ds_read_b128 v[60:63], v105 offset:3584
 v_cvt_pk_bf16_f32 v90, v80, v81
 v_cvt_pk_bf16_f32 v91, v84, v85
 s_cmp_ge_u32 s56, 60
 v_mfma_f32_16x16x32_bf16 v[64:67], v[44:47], v[40:43], v[64:67]
 ds_read_b128 v[32:35], v100 offset:0
 s_cbranch_scc1 L_ch_km2
L_ch_kmb2:
 s_waitcnt lgkmcnt(5)
 v_mfma_f32_16x16x32_bf16 v[68:71], v[16:19], v[48:51], v[68:71]
 ds_read_b128 v[36:39], v100 offset:1024
 v_mfma_f32_16x16x32_bf16 v[72:75], v[20:23], v[48:51], v[72:75]
 v_mov_b64 v[40:41], s[76:77]
 v_mov_b64 v[42:43], s[76:77]
 v_mfma_f32_16x16x32_bf16 v[64:67], v[52:55], v[48:51], v[64:67]
 v_mov_b64 v[0:1], 0
 v_mov_b64 v[2:3], 0
 s_waitcnt lgkmcnt(2)
 v_mfma_f32_16x16x32_bf16 v[68:71], v[24:27], v[56:59], v[68:71]
 v_mov_b64 v[4:5], 0
 v_mov_b64 v[6:7], 0
 v_mfma_f32_16x16x32_bf16 v[72:75], v[28:31], v[56:59], v[72:75]
 v_mov_b64 v[8:9], 0
 v_mov_b64 v[10:11], 0
 v_mfma_f32_16x16x32_bf16 v[64:67], v[60:63], v[56:59], v[64:67]
 v_mov_b64 v[12:13], 0
 v_mov_b64 v[14:15], 0
 v_mov_b64 v[16:17], 0
 v_max3_f32 v60, |v68|, |v69|, |v70|
 v_max3_f32 v61, |v71|, |v72|, |v73|
 v_max3_f32 v62, |v74|, |v75|, v60
 s_nop 0
 v_max3_f32 v60, |v64|, |v65|, v61
 v_max_f32 v60, v60, v62
 v_cmp_nge_f32 vcc, s90, v60
 v_pk_mul_f32 v[68:69], v[68:69], s[88:89]
 v_pk_mul_f32 v[70:71], v[70:71], s[88:89]
 v_pk_mul_f32 v[72:73], v[72:73], s[88:89]
 v_pk_mul_f32 v[74:75], v[74:75], s[88:89]
 v_pk_mul_f32 v[64:65], v[64:65], s[88:89]
 s_cbranch_vccnz L_mx2
L_mxb2:
 v_exp_f32 v64, v64
 v_exp_f32 v65, v65
 v_exp_f32 v68, v68
 v_cvt_pk_bf16_f32 v92, v64, v65
 v_cvt_pk_bf16_f32 v95, v64, v65
 v_exp_f32 v69, v69
 v_mfma_f32_16x16x16_bf16 v[56:59], v[40:41], v[92:93], 0
 v_exp_f32 v70, v70
 v_cvt_pk_bf16_f32 v44, v68, v69
 v_exp_f32 v71, v71
 v_mfma_f32_16x16x16_bf16 v[48:51], v[90:91], v[92:93], 0
 v_exp_f32 v72, v72
 v_cvt_pk_bf16_f32 v45, v70, v71
 v_exp_f32 v73, v73
 v_mfma_f32_16x16x16_bf16 v[52:55], v[90:91], v[94:95], 0
 v_exp_f32 v74, v74
 v_cvt_pk_bf16_f32 v46, v72, v73
 v_exp_f32 v75, v75
 s_waitcnt lgkmcnt(0)
 v_cvt_pk_bf16_f32 v47, v74, v75
 v_mov_b64 v[18:19], 0
 v_mov_b64 v[20:21], 0
 v_mfma_f32_16x16x32_bf16 v[56:59], v[40:43], v[44:47], v[56:59]
 v_mov_b64 v[22:23], 0
 v_mov_b64 v[24:25], 0
 v_mfma_f32_16x16x32_bf16 v[48:51], v[32:35], v[44:47], v[48:51]
 v_mov_b64 v[26:27], 0
 v_mov_b64 v[28:29], 0
 v_mfma_f32_16x16x32_bf16 v[52:55], v[36:39], v[44:47], v[52:55]
 v_mov_b64 v[30:31], 0
 ds_read_b128 v[80:83], v98 offset:0
 v_rcp_f32 v56, v56
 ds_read_b128 v[84:87], v98 offset:1024
 v_mul_f32 v48, v48, v56
 v_mul_f32 v49, v49, v56
 v_mul_f32 v50, v50, v56
 v_mul_f32 v51, v51, v56
 v_cvt_pk_bf16_f32 v44, v48, v49
 v_cvt_pk_bf16_f32 v45, v50, v51
 v_mul_f32 v52, v52, v56
 v_mul_f32 v53, v53, v56
 v_mul_f32 v54, v54, v56
 v_mul_f32 v55, v55, v56
 v_cvt_pk_bf16_f32 v46, v52, v53
 v_cvt_pk_bf16_f32 v47, v54, v55
 ds_write_b128 v106, v[44:47]
 ds_read_b128 v[32:35], v98 offset:2048
 ds_read_b128 v[36:39], v98 offset:3072
 s_waitcnt lgkmcnt(2)
 s_barrier
 ds_read_b128 v[64:67], v107
 ds_read_b128 v[68:71], v107 offset:1024
 s_waitcnt lgkmcnt(1)
 v_smfmac_f32_16x16x64_bf16 v[0:3], v[64:67], v[176:183], v96
 s_waitcnt lgkmcnt(0)
 ds_read_b128 v[72:75], v98 offset:4096
 v_smfmac_f32_16x16x64_bf16 v[0:3], v[68:71], v[184:191], v96
 ds_read_b128 v[76:79], v98 offset:5120
 s_add_u32 s71, s58, s73
 v_xor_b32 v99, 0x3c000, v99
 v_smfmac_f32_16x16x64_bf16 v[4:7], v[64:67], v[192:199], v96
 ds_read_b128 v[56:59], v98 offset:6144
 s_add_u32 s72, s58, s44
 v_xor_b32 v100, 0x3c000, v100
 v_smfmac_f32_16x16x64_bf16 v[4:7], v[68:71], v[200:207], v96
 ds_read_b128 v[60:63], v98 offset:7168
 s_mov_b32 s100, s57
 v_add_f32 v0, v0, v2
 v_add_f32 v1, v1, v3
 v_smfmac_f32_16x16x64_bf16 v[8:11], v[64:67], v[208:215], v96
 ds_read_b128 v[40:43], v98 offset:8192
 s_mov_b32 s57, s58
 v_cvt_pk_bf16_f32 v48, v0, v1
 v_smfmac_f32_16x16x64_bf16 v[8:11], v[68:71], v[216:223], v96
 ds_read_b128 v[44:47], v98 offset:9216
 s_mov_b32 s58, s59
 v_add_f32 v4, v4, v6
 v_add_f32 v5, v5, v7
 v_smfmac_f32_16x16x64_bf16 v[12:15], v[64:67], v[224:231], v96
 s_mov_b32 s59, s100
 v_cvt_pk_bf16_f32 v49, v4, v5
 v_smfmac_f32_16x16x64_bf16 v[12:15], v[68:71], v[232:239], v96
 buffer_store_dwordx2 v[48:49], v102, s[36:39], s60 offen offset:0
 s_add_u32 s56, s56, 1
 v_add_f32 v8, v8, v10
 v_add_f32 v9, v9, v11
 v_smfmac_f32_16x16x64_bf16 v[16:19], v[64:67], v[240:247], v96
 s_mov_b32 s75, s67
 v_cvt_pk_bf16_f32 v50, v8, v9
 v_smfmac_f32_16x16x64_bf16 v[16:19], v[68:71], v[248:255], v96
 s_waitcnt lgkmcnt(0)
 s_add_u32 s67, s67, 131072
 v_add_f32 v12, v12, v14
 v_add_f32 v13, v13, v15
 v_smfmac_f32_16x16x64_bf16 v[20:23], v[64:67], v[80:87], v96
 ds_read_b128 v[80:83], v98 offset:10240
 ds_read_b128 v[84:87], v98 offset:11264
 v_cvt_pk_bf16_f32 v51, v12, v13
 v_smfmac_f32_16x16x64_bf16 v[20:23], v[68:71], v[32:39], v96
 buffer_store_dwordx2 v[50:51], v102, s[36:39], s60 offen offset:2048
 v_add_f32 v16, v16, v18
 v_add_f32 v17, v17, v19
 v_smfmac_f32_16x16x64_bf16 v[24:27], v[64:67], v[72:79], v96
 v_cvt_pk_bf16_f32 v52, v16, v17
 v_smfmac_f32_16x16x64_bf16 v[24:27], v[68:71], v[56:63], v96
 v_add_f32 v20, v20, v22
 v_add_f32 v21, v21, v23
 v_smfmac_f32_16x16x64_bf16 v[28:31], v[64:67], v[40:47], v96
 s_waitcnt lgkmcnt(0)
 v_cvt_pk_bf16_f32 v53, v20, v21
 v_smfmac_f32_16x16x64_bf16 v[28:31], v[68:71], v[80:87], v96
 buffer_store_dwordx2 v[52:53], v102, s[36:39], s74 offen offset:0
 v_add_f32 v24, v24, v26
 v_add_f32 v25, v25, v27
 v_cvt_pk_bf16_f32 v54, v24, v25
 s_nop 3
 v_add_f32 v28, v28, v30
 v_add_f32 v29, v29, v31
 v_cvt_pk_bf16_f32 v55, v28, v29
 buffer_store_dwordx2 v[54:55], v102, s[36:39], s74 offen offset:2048
 v_cndmask_b32 v0, 0, v108, s[78:79]
 v_cndmask_b32 v1, 0, v108, s[80:81]
 v_cndmask_b32 v2, 0, v108, s[82:83]
 v_cndmask_b32 v3, 0, v108, s[84:85]
 v_mov_b64 v[24:25], -1
 ds_read_b128 v[32:35], v97 offset:0
 ds_read_b128 v[36:39], v97 offset:1024
 ds_read_b128 v[40:43], v97 offset:2048
 ds_read_b128 v[44:47], v97 offset:3072
 ds_read_b128 v[48:51], v97 offset:16384
 ds_read_b128 v[52:55], v97 offset:17408
 ds_read_b128 v[56:59], v97 offset:18432
 ds_read_b128 v[60:63], v97 offset:19456
 v_mov_b64 v[64:65], 0
 v_mov_b64 v[66:67], 0
 v_mov_b64 v[68:69], 0
 v_mov_b64 v[70:71], 0
 v_mov_b64 v[72:73], 0
 v_mov_b64 v[74:75], 0
 v_mov_b64 v[76:77], 0
 v_mov_b64 v[78:79], 0
 v_mov_b64 v[80:81], 0
 v_mov_b64 v[82:83], 0
 v_mov_b64 v[84:85], 0
 v_mov_b64 v[86:87], 0
 s_nop 15
 s_nop 3
 buffer_load_dwordx4 v[16:19], v97, s[36:39], s61 offen offset:0 sc1
 buffer_load_dwordx4 v[20:23], v97, s[36:39], s61 offen offset:1024 sc1
 s_nop 15
 s_mov_b32 s7, 524288
 s_mov_b64 vcc, -1
L_red2:
 s_mov_b64 exec, vcc
 buffer_load_dwordx4 v[16:19], v97, s[36:39], s61 offen offset:0 sc1
 buffer_load_dwordx4 v[20:23], v97, s[36:39], s61 offen offset:1024 sc1
 s_mov_b64 exec, -1
 s_sub_u32 s7, s7, 1
 s_cbranch_scc1 L_abort
 s_waitcnt vmcnt(2)
 v_max3_u32 v110, v16, v16, v17
 v_max3_u32 v110, v110, v18, v19
 v_mfma_f32_16x16x32_bf16 v[4:7], v[0:3], v[16:19], 0
 v_max3_u32 v110, v110, v20, v21
 v_max3_u32 v110, v110, v22, v23
 v_mfma_f32_16x16x32_bf16 v[4:7], v[0:3], v[20:23], v[4:7]
 v_cmp_eq_u32 vcc, -1, v110
 s_cbranch_vccnz L_red2
 s_nop 0
 v_add_f32_dpp v4, v4, v4 row_ror:4 row_mask:0xf bank_mask:0xf
 v_add_f32_dpp v5, v5, v5 row_ror:4 row_mask:0xf bank_mask:0xf
 v_add_f32_dpp v6, v6, v6 row_ror:4 row_mask:0xf bank_mask:0xf
 v_add_f32_dpp v7, v7, v7 row_ror:4 row_mask:0xf bank_mask:0xf
 v_add_f32_dpp v4, v4, v4 row_ror:8 row_mask:0xf bank_mask:0xf
 v_add_f32_dpp v5, v5, v5 row_ror:8 row_mask:0xf bank_mask:0xf
 v_add_f32_dpp v6, v6, v6 row_ror:8 row_mask:0xf bank_mask:0xf
 v_add_f32_dpp v7, v7, v7 row_ror:8 row_mask:0xf bank_mask:0xf
 v_cvt_pk_bf16_f32 v4, v4, v5
 v_cvt_pk_bf16_f32 v5, v6, v7
 s_mov_b64 exec, 0x000f000f
 buffer_store_dwordx2 v[4:5], v103, s[36:39], s63 offen
 buffer_store_dwordx2 v[24:25], v103, s[36:39], s64 offen
 s_mov_b64 exec, -1
 s_branch L_fetch2
L_mx2:
 v_max3_f32 v60, v68, v69, v70
 v_max3_f32 v61, v71, v72, v73
 v_max3_f32 v62, v74, v75, v60
 v_max3_f32 v60, v64, v65, v61
 v_max_f32 v61, v60, v62
 v_max_f32 v63, v60, v62
 s_nop 1
 v_permlane16_swap_b32 v61, v63
 v_max_f32 v60, v61, v63
 v_max_f32 v62, v61, v63
 s_nop 1
 v_permlane32_swap_b32 v60, v62
 v_max_f32 v60, v60, v62
 v_pk_add_f32 v[64:65], v[64:65], v[60:61] op_sel_hi:[1,0] neg_lo:[0,1] neg_hi:[0,1]
 v_pk_add_f32 v[68:69], v[68:69], v[60:61] op_sel_hi:[1,0] neg_lo:[0,1] neg_hi:[0,1]
 v_pk_add_f32 v[70:71], v[70:71], v[60:61] op_sel_hi:[1,0] neg_lo:[0,1] neg_hi:[0,1]
 v_pk_add_f32 v[72:73], v[72:73], v[60:61] op_sel_hi:[1,0] neg_lo:[0,1] neg_hi:[0,1]
 v_pk_add_f32 v[74:75], v[74:75], v[60:61] op_sel_hi:[1,0] neg_lo:[0,1] neg_hi:[0,1]
 s_branch L_mxb2
L_ch_km3:
 buffer_store_dwordx4 v[88:91], v97, s[36:39], s67 offen sc1
 s_cmp_lt_u32 s56, 63
 s_cbranch_scc1 L_ch_kmb3
 s_branch L_ch_exit
L_lr3:
 s_mov_b32 m0, s42
 s_mov_b32 s7, 524288
L_lr13:
 buffer_load_dwordx4 v[24:27], v97, s[36:39], s71 offen offset:0 sc1
 buffer_load_dwordx4 v[28:31], v97, s[36:39], s71 offen offset:1024 sc1
 buffer_load_dwordx4 v97, s[36:39], s71 offen offset:0 sc1 lds
 buffer_load_dwordx4 v97, s[36:39], s71 offen offset:1024 sc1 lds
 s_sub_u32 s7, s7, 1
 s_cbranch_scc1 L_abort
 s_waitcnt vmcnt(0)
 v_max3_u32 v110, v24, v24, v25
 v_max3_u32 v110, v110, v26, v27
 v_max3_u32 v110, v110, v28, v29
 v_max3_u32 v110, v110, v30, v31
 v_cmp_eq_u32 vcc, -1, v110
 s_cbranch_vccnz L_lr13
 s_mov_b32 m0, s66
 s_branch L_lk3
.p2align 8
L_fetch3:
 s_mov_b32 m0, s42
 s_barrier
 buffer_load_dwordx4 v[24:27], v97, s[36:39], s71 offen offset:0 sc1
 buffer_load_dwordx4 v[28:31], v97, s[36:39], s71 offen offset:1024 sc1
 buffer_load_dwordx4 v97, s[36:39], s71 offen offset:0 sc1 lds
 buffer_load_dwordx4 v97, s[36:39], s71 offen offset:1024 sc1 lds
 s_waitcnt lgkmcnt(0)
 s_barrier
 ds_read_b128 v[0:3], v101 offset:0
 ds_read_b128 v[4:7], v101 offset:1024
 ds_read_b128 v[8:11], v101 offset:2048
 ds_read_b128 v[12:15], v101 offset:3072
 s_add_u32 s65, s65, 524288
 s_xor_b32 s66, s66, 0x3c000
 s_mov_b32 m0, s66
 s_mul_i32 s100, s57, 40
 s_add_u32 s60, s100, s40
 s_waitcnt lgkmcnt(3)
 v_smfmac_f32_16x16x64_bf16 v[64:67], v[0:3], a[0:7], v96
 s_add_u32 s74, s60, 4096
 s_add_u32 s61, s100, s41
 s_mul_i32 s100, s59, 40
 v_smfmac_f32_16x16x64_bf16 v[68:71], v[0:3], a[8:15], v96
 s_add_u32 s62, s100, s41
 s_add_u32 s63, s58, 15728640
 s_add_u32 s64, s57, 15728640
 v_smfmac_f32_16x16x64_bf16 v[72:75], v[0:3], a[128:135], v96
 s_xor_b32 s68, s68, 4096
 s_lshr_b32 s69, s56, 1
 s_add_u32 s69, s69, 2
 v_smfmac_f32_16x16x64_bf16 v[76:79], v[0:3], a[136:143], v96
 buffer_load_dwordx4 v97, s[36:39], s65 offen offset:0 sc1 lds
 s_waitcnt lgkmcnt(2)
 s_cmp_gt_u32 s56, 61
 s_cselect_b32 s69, 0, s69
 v_smfmac_f32_16x16x64_bf16 v[64:67], v[4:7], a[16:23], v96
 v_smfmac_f32_16x16x64_bf16 v[68:71], v[4:7], a[24:31], v96
 v_smfmac_f32_16x16x64_bf16 v[72:75], v[4:7], v[32:39], v96
 ds_read_b128 v[32:35], v97 offset:32768
 v_smfmac_f32_16x16x64_bf16 v[76:79], v[4:7], v[40:47], v96
 buffer_load_dwordx4 v97, s[36:39], s65 offen offset:1024 sc1 lds
 s_waitcnt lgkmcnt(2)
 v_smfmac_f32_16x16x64_bf16 v[64:67], v[8:11], a[32:39], v96
 ds_read_b128 v[36:39], v97 offset:33792
 v_smfmac_f32_16x16x64_bf16 v[68:71], v[8:11], a[40:47], v96
 ds_read_b128 v[40:43], v97 offset:34816
 v_smfmac_f32_16x16x64_bf16 v[72:75], v[8:11], a[144:151], v96
 ds_read_b128 v[44:47], v97 offset:35840
 v_smfmac_f32_16x16x64_bf16 v[76:79], v[8:11], a[152:159], v96
 buffer_load_dwordx4 v97, s[36:39], s65 offen offset:2048 sc1 lds
 s_waitcnt lgkmcnt(4)
 v_smfmac_f32_16x16x64_bf16 v[64:67], v[12:15], a[48:55], v96
 s_waitcnt vmcnt(3)
 v_max3_u32 v110, v24, v24, v25
 v_smfmac_f32_16x16x64_bf16 v[68:71], v[12:15], a[56:63], v96
 v_max3_u32 v110, v110, v26, v27
 v_max3_u32 v110, v110, v28, v29
 v_smfmac_f32_16x16x64_bf16 v[72:75], v[12:15], v[48:55], v96
 v_max3_u32 v110, v110, v30, v31
 v_cmp_eq_u32 vcc, -1, v110
 v_smfmac_f32_16x16x64_bf16 v[76:79], v[12:15], v[56:63], v96
 buffer_load_dwordx4 v97, s[36:39], s65 offen offset:3072 sc1 lds
 v_smfmac_f32_16x16x64_bf16 v[80:83], v[0:3], a[192:199], v96
 s_cbranch_vccnz L_lr3
L_lk3:
 s_barrier
 ds_read_b128 v[16:19], v101 offset:4096
 v_smfmac_f32_16x16x64_bf16 v[84:87], v[0:3], a[200:207], v96
 buffer_load_dword v109, v93, s[36:39], s68 offen sc1
 ds_read_b128 v[20:23], v101 offset:5120
 v_smfmac_f32_16x16x64_bf16 v[80:83], v[4:7], a[208:215], v96
 v_smfmac_f32_16x16x64_bf16 v[84:87], v[4:7], a[216:223], v96
 s_waitcnt lgkmcnt(1)
 v_smfmac_f32_16x16x64_bf16 v[64:67], v[16:19], a[64:71], v96
 ds_read_b128 v[24:27], v101 offset:6144
 v_smfmac_f32_16x16x64_bf16 v[68:71], v[16:19], a[72:79], v96
 ds_read_b128 v[48:51], v97 offset:49152
 v_smfmac_f32_16x16x64_bf16 v[72:75], v[16:19], a[160:167], v96
 ds_read_b128 v[28:31], v101 offset:7168
 ds_read_b128 v[52:55], v97 offset:50176
 v_smfmac_f32_16x16x64_bf16 v[76:79], v[16:19], a[168:175], v96
 buffer_store_dwordx4 v[88:91], v97, s[36:39], s75 offen sc1
 s_waitcnt lgkmcnt(4)
 v_smfmac_f32_16x16x64_bf16 v[64:67], v[20:23], a[80:87], v96
 v_mov_b64 v[88:89], -1
 v_smfmac_f32_16x16x64_bf16 v[68:71], v[20:23], a[88:95], v96
 ds_read_b128 v[56:59], v97 offset:51200
 s_waitcnt lgkmcnt(7)
 v_mov_b64 v[90:91], -1
 v_smfmac_f32_16x16x64_bf16 v[72:75], v[20:23], v[32:39], v96
 ds_read_b128 v[60:63], v97 offset:52224
 v_smfmac_f32_16x16x64_bf16 v[76:79], v[20:23], v[40:47], v96
 s_waitcnt lgkmcnt(5)
 v_smfmac_f32_16x16x64_bf16 v[64:67], v[24:27], a[96:103], v96
 v_smfmac_f32_16x16x64_bf16 v[68:71], v[24:27], a[104:111], v96
 buffer_store_dwordx4 v[88:91], v97, s[36:39], s62 offen offset:0
 ds_read_b128 v[0:3], v99 offset:2048
 v_smfmac_f32_16x16x64_bf16 v[72:75], v[24:27], a[176:183], v96
 v_smfmac_f32_16x16x64_bf16 v[76:79], v[24:27], a[184:191], v96
 ds_read_b128 v[4:7], v99 offset:3072
 s_waitcnt lgkmcnt(5)
 v_smfmac_f32_16x16x64_bf16 v[64:67], v[28:31], a[112:119], v96
 v_smfmac_f32_16x16x64_bf16 v[68:71], v[28:31], a[120:127], v96
 s_waitcnt lgkmcnt(2)
 v_smfmac_f32_16x16x64_bf16 v[72:75], v[28:31], v[48:55], v96
 v_smfmac_f32_16x16x64_bf16 v[76:79], v[28:31], v[56:63], v96
 buffer_store_dwordx4 v[88:91], v97, s[36:39], s62 offen offset:1024
 v_add_f32 v64, v64, v66
 v_add_f32 v65, v65, v67
 v_add_f32 v68, v68, v70
 v_add_f32 v69, v69, v71
 v_cvt_pk_bf16_f32 v48, v64, v68
 v_cvt_pk_bf16_f32 v49, v65, v69
 ds_write2_b32 v104, v48, v49 offset1:16
 v_add_f32 v72, v72, v74
 v_add_f32 v73, v73, v75
 v_add_f32 v76, v76, v78
 v_add_f32 v77, v77, v79
 v_cvt_pk_bf16_f32 v88, v72, v76
 v_cvt_pk_bf16_f32 v89, v73, v77
 ds_write2_b32 v104, v88, v89 offset0:128 offset1:144
 v_smfmac_f32_16x16x64_bf16 v[80:83], v[8:11], a[224:231], v96
 v_smfmac_f32_16x16x64_bf16 v[84:87], v[8:11], a[232:239], v96
 ds_read_b128 v[8:11], v99 offset:6144
 v_smfmac_f32_16x16x64_bf16 v[80:83], v[12:15], a[240:247], v96
 v_smfmac_f32_16x16x64_bf16 v[84:87], v[12:15], a[248:255], v96
 ds_read_b128 v[12:15], v99 offset:7168
 v_smfmac_f32_16x16x64_bf16 v[80:83], v[16:19], v[112:119], v96
 s_waitcnt lgkmcnt(2)
 s_barrier
 v_smfmac_f32_16x16x64_bf16 v[84:87], v[16:19], v[120:127], v96
 ds_read_b128 v[32:35], v105 offset:0
 v_smfmac_f32_16x16x64_bf16 v[80:83], v[20:23], v[128:135], v96
 ds_read_b128 v[36:39], v105 offset:512
 v_smfmac_f32_16x16x64_bf16 v[84:87], v[20:23], v[136:143], v96
 ds_read_b128 v[40:43], v105 offset:1024
 v_smfmac_f32_16x16x64_bf16 v[80:83], v[24:27], v[144:151], v96
 ds_read_b128 v[44:47], v105 offset:1536
 v_smfmac_f32_16x16x64_bf16 v[84:87], v[24:27], v[152:159], v96
 ds_read_b128 v[16:19], v99 offset:10240
 v_smfmac_f32_16x16x64_bf16 v[80:83], v[28:31], v[160:167], v96
 ds_read_b128 v[48:51], v105 offset:2048
 v_smfmac_f32_16x16x64_bf16 v[84:87], v[28:31], v[168:175], v96
 ds_read_b128 v[20:23], v99 offset:11264
 s_waitcnt lgkmcnt(5)
 v_mfma_f32_16x16x32_bf16 v[68:71], v[0:3], v[32:35], 0
 ds_read_b128 v[52:55], v105 offset:2560
 v_mfma_f32_16x16x32_bf16 v[72:75], v[4:7], v[32:35], 0
 ds_read_b128 v[24:27], v99 offset:14336
 v_mfma_f32_16x16x32_bf16 v[64:67], v[36:39], v[32:35], 0
 ds_read_b128 v[56:59], v105 offset:3072
 v_add_f32 v80, v80, v82
 v_add_f32 v81, v81, v83
 s_waitcnt lgkmcnt(6)
 v_mfma_f32_16x16x32_bf16 v[68:71], v[8:11], v[40:43], v[68:71]
 ds_read_b128 v[28:31], v99 offset:15360
 v_add_f32 v84, v84, v86
 v_add_f32 v85, v85, v87
 v_mfma_f32_16x16x32_bf16 v[72:75], v[12:15], v[40:43], v[72:75]
 ds_read_b128 v[60:63], v105 offset:3584
 v_cvt_pk_bf16_f32 v90, v80, v81
 v_cvt_pk_bf16_f32 v91, v84, v85
 s_cmp_ge_u32 s56, 60
 v_mfma_f32_16x16x32_bf16 v[64:67], v[44:47], v[40:43], v[64:67]
 ds_read_b128 v[32:35], v100 offset:0
 s_cbranch_scc1 L_ch_km3
L_ch_kmb3:
 s_waitcnt lgkmcnt(5)
 v_mfma_f32_16x16x32_bf16 v[68:71], v[16:19], v[48:51], v[68:71]
 ds_read_b128 v[36:39], v100 offset:1024
 v_mfma_f32_16x16x32_bf16 v[72:75], v[20:23], v[48:51], v[72:75]
 v_mov_b64 v[40:41], s[76:77]
 v_mov_b64 v[42:43], s[76:77]
 v_mfma_f32_16x16x32_bf16 v[64:67], v[52:55], v[48:51], v[64:67]
 v_mov_b64 v[0:1], 0
 v_mov_b64 v[2:3], 0
 s_waitcnt lgkmcnt(2)
 v_mfma_f32_16x16x32_bf16 v[68:71], v[24:27], v[56:59], v[68:71]
 v_mov_b64 v[4:5], 0
 v_mov_b64 v[6:7], 0
 v_mfma_f32_16x16x32_bf16 v[72:75], v[28:31], v[56:59], v[72:75]
 v_mov_b64 v[8:9], 0
 v_mov_b64 v[10:11], 0
 v_mfma_f32_16x16x32_bf16 v[64:67], v[60:63], v[56:59], v[64:67]
 v_mov_b64 v[12:13], 0
 v_mov_b64 v[14:15], 0
 v_mov_b64 v[16:17], 0
 v_max3_f32 v60, |v68|, |v69|, |v70|
 v_max3_f32 v61, |v71|, |v72|, |v73|
 v_max3_f32 v62, |v74|, |v75|, v60
 s_nop 0
 v_max3_f32 v60, |v64|, |v65|, v61
 v_max_f32 v60, v60, v62
 v_cmp_nge_f32 vcc, s90, v60
 v_pk_mul_f32 v[68:69], v[68:69], s[88:89]
 v_pk_mul_f32 v[70:71], v[70:71], s[88:89]
 v_pk_mul_f32 v[72:73], v[72:73], s[88:89]
 v_pk_mul_f32 v[74:75], v[74:75], s[88:89]
 v_pk_mul_f32 v[64:65], v[64:65], s[88:89]
 s_cbranch_vccnz L_mx3
L_mxb3:
 v_exp_f32 v64, v64
 v_exp_f32 v65, v65
 v_exp_f32 v68, v68
 v_cvt_pk_bf16_f32 v92, v64, v65
 v_cvt_pk_bf16_f32 v95, v64, v65
 v_exp_f32 v69, v69
 v_mfma_f32_16x16x16_bf16 v[56:59], v[40:41], v[92:93], 0
 v_exp_f32 v70, v70
 v_cvt_pk_bf16_f32 v44, v68, v69
 v_exp_f32 v71, v71
 v_mfma_f32_16x16x16_bf16 v[48:51], v[90:91], v[92:93], 0
 v_exp_f32 v72, v72
 v_cvt_pk_bf16_f32 v45, v70, v71
 v_exp_f32 v73, v73
 v_mfma_f32_16x16x16_bf16 v[52:55], v[90:91], v[94:95], 0
 v_exp_f32 v74, v74
 v_cvt_pk_bf16_f32 v46, v72, v73
 v_exp_f32 v75, v75
 s_waitcnt lgkmcnt(0)
 v_cvt_pk_bf16_f32 v47, v74, v75
 v_mov_b64 v[18:19], 0
 v_mov_b64 v[20:21], 0
 v_mfma_f32_16x16x32_bf16 v[56:59], v[40:43], v[44:47], v[56:59]
 v_mov_b64 v[22:23], 0
 v_mov_b64 v[24:25], 0
 v_mfma_f32_16x16x32_bf16 v[48:51], v[32:35], v[44:47], v[48:51]
 v_mov_b64 v[26:27], 0
 v_mov_b64 v[28:29], 0
 v_mfma_f32_16x16x32_bf16 v[52:55], v[36:39], v[44:47], v[52:55]
 v_mov_b64 v[30:31], 0
 ds_read_b128 v[80:83], v98 offset:0
 v_rcp_f32 v56, v56
 ds_read_b128 v[84:87], v98 offset:1024
 v_mul_f32 v48, v48, v56
 v_mul_f32 v49, v49, v56
 v_mul_f32 v50, v50, v56
 v_mul_f32 v51, v51, v56
 v_cvt_pk_bf16_f32 v44, v48, v49
 v_cvt_pk_bf16_f32 v45, v50, v51
 v_mul_f32 v52, v52, v56
 v_mul_f32 v53, v53, v56
 v_mul_f32 v54, v54, v56
 v_mul_f32 v55, v55, v56
 v_cvt_pk_bf16_f32 v46, v52, v53
 v_cvt_pk_bf16_f32 v47, v54, v55
 ds_write_b128 v106, v[44:47]
 ds_read_b128 v[32:35], v98 offset:2048
 ds_read_b128 v[36:39], v98 offset:3072
 s_waitcnt lgkmcnt(2)
 s_barrier
 ds_read_b128 v[64:67], v107
 ds_read_b128 v[68:71], v107 offset:1024
 s_waitcnt lgkmcnt(1)
 v_smfmac_f32_16x16x64_bf16 v[0:3], v[64:67], v[176:183], v96
 s_waitcnt lgkmcnt(0)
 ds_read_b128 v[72:75], v98 offset:4096
 v_smfmac_f32_16x16x64_bf16 v[0:3], v[68:71], v[184:191], v96
 ds_read_b128 v[76:79], v98 offset:5120
 s_add_u32 s71, s58, s73
 v_xor_b32 v99, 0x3c000, v99
 v_smfmac_f32_16x16x64_bf16 v[4:7], v[64:67], v[192:199], v96
 ds_read_b128 v[56:59], v98 offset:6144
 s_add_u32 s72, s58, s44
 v_xor_b32 v100, 0x3c000, v100
 v_smfmac_f32_16x16x64_bf16 v[4:7], v[68:71], v[200:207], v96
 ds_read_b128 v[60:63], v98 offset:7168
 s_mov_b32 s100, s57
 v_add_f32 v0, v0, v2
 v_add_f32 v1, v1, v3
 v_smfmac_f32_16x16x64_bf16 v[8:11], v[64:67], v[208:215], v96
 ds_read_b128 v[40:43], v98 offset:8192
 s_mov_b32 s57, s58
 v_cvt_pk_bf16_f32 v48, v0, v1
 v_smfmac_f32_16x16x64_bf16 v[8:11], v[68:71], v[216:223], v96
 ds_read_b128 v[44:47], v98 offset:9216
 s_mov_b32 s58, s59
 v_add_f32 v4, v4, v6
 v_add_f32 v5, v5, v7
 v_smfmac_f32_16x16x64_bf16 v[12:15], v[64:67], v[224:231], v96
 s_mov_b32 s59, s100
 v_cvt_pk_bf16_f32 v49, v4, v5
 v_smfmac_f32_16x16x64_bf16 v[12:15], v[68:71], v[232:239], v96
 buffer_store_dwordx2 v[48:49], v102, s[36:39], s60 offen offset:0
 s_add_u32 s56, s56, 1
 v_add_f32 v8, v8, v10
 v_add_f32 v9, v9, v11
 v_smfmac_f32_16x16x64_bf16 v[16:19], v[64:67], v[240:247], v96
 s_mov_b32 s75, s67
 v_cvt_pk_bf16_f32 v50, v8, v9
 v_smfmac_f32_16x16x64_bf16 v[16:19], v[68:71], v[248:255], v96
 s_waitcnt lgkmcnt(0)
 s_add_u32 s67, s67, 131072
 v_add_f32 v12, v12, v14
 v_add_f32 v13, v13, v15
 v_smfmac_f32_16x16x64_bf16 v[20:23], v[64:67], v[80:87], v96
 ds_read_b128 v[80:83], v98 offset:10240
 ds_read_b128 v[84:87], v98 offset:11264
 v_cvt_pk_bf16_f32 v51, v12, v13
 v_smfmac_f32_16x16x64_bf16 v[20:23], v[68:71], v[32:39], v96
 buffer_store_dwordx2 v[50:51], v102, s[36:39], s60 offen offset:2048
 v_add_f32 v16, v16, v18
 v_add_f32 v17, v17, v19
 v_smfmac_f32_16x16x64_bf16 v[24:27], v[64:67], v[72:79], v96
 v_cvt_pk_bf16_f32 v52, v16, v17
 v_smfmac_f32_16x16x64_bf16 v[24:27], v[68:71], v[56:63], v96
 v_add_f32 v20, v20, v22
 v_add_f32 v21, v21, v23
 v_smfmac_f32_16x16x64_bf16 v[28:31], v[64:67], v[40:47], v96
 s_waitcnt lgkmcnt(0)
 v_cvt_pk_bf16_f32 v53, v20, v21
 v_smfmac_f32_16x16x64_bf16 v[28:31], v[68:71], v[80:87], v96
 buffer_store_dwordx2 v[52:53], v102, s[36:39], s74 offen offset:0
 v_add_f32 v24, v24, v26
 v_add_f32 v25, v25, v27
 v_cvt_pk_bf16_f32 v54, v24, v25
 s_nop 3
 v_add_f32 v28, v28, v30
 v_add_f32 v29, v29, v31
 v_cvt_pk_bf16_f32 v55, v28, v29
 buffer_store_dwordx2 v[54:55], v102, s[36:39], s74 offen offset:2048
 s_waitcnt vmcnt(4)
 s_mov_b32 s7, 524288
L17:
 v_readfirstlane_b32 s100, v109
 s_cmp_ge_u32 s100, s69
 s_cbranch_scc1 L18
 buffer_load_dword v109, v93, s[36:39], s68 offen sc1
 s_sub_u32 s7, s7, 1
 s_cbranch_scc1 L_abort
 s_waitcnt vmcnt(0)
 s_branch L17
L18:
 v_cndmask_b32 v0, 0, v108, s[78:79]
 v_cndmask_b32 v1, 0, v108, s[80:81]
 v_cndmask_b32 v2, 0, v108, s[82:83]
 v_cndmask_b32 v3, 0, v108, s[84:85]
 v_mov_b64 v[24:25], -1
 ds_read_b128 v[32:35], v97 offset:0
 ds_read_b128 v[36:39], v97 offset:1024
 ds_read_b128 v[40:43], v97 offset:2048
 ds_read_b128 v[44:47], v97 offset:3072
 ds_read_b128 v[48:51], v97 offset:16384
 ds_read_b128 v[52:55], v97 offset:17408
 ds_read_b128 v[56:59], v97 offset:18432
 ds_read_b128 v[60:63], v97 offset:19456
 v_mov_b64 v[64:65], 0
 v_mov_b64 v[66:67], 0
 v_mov_b64 v[68:69], 0
 v_mov_b64 v[70:71], 0
 v_mov_b64 v[72:73], 0
 v_mov_b64 v[74:75], 0
 v_mov_b64 v[76:77], 0
 v_mov_b64 v[78:79], 0
 v_mov_b64 v[80:81], 0
 v_mov_b64 v[82:83], 0
 v_mov_b64 v[84:85], 0
 v_mov_b64 v[86:87], 0
 s_nop 11
 buffer_load_dwordx4 v[16:19], v97, s[36:39], s61 offen offset:0 sc1
 buffer_load_dwordx4 v[20:23], v97, s[36:39], s61 offen offset:1024 sc1
 s_nop 15
 s_mov_b32 s7, 524288
 s_mov_b64 vcc, -1
L_red3:
 s_mov_b64 exec, vcc
 buffer_load_dwordx4 v[16:19], v97, s[36:39], s61 offen offset:0 sc1
 buffer_load_dwordx4 v[20:23], v97, s[36:39], s61 offen offset:1024 sc1
 s_mov_b64 exec, -1
 s_sub_u32 s7, s7, 1
 s_cbranch_scc1 L_abort
 s_waitcnt vmcnt(2)
 v_max3_u32 v110, v16, v16, v17
 v_max3_u32 v110, v110, v18, v19
 v_mfma_f32_16x16x32_bf16 v[4:7], v[0:3], v[16:19], 0
 v_max3_u32 v110, v110, v20, v21
 v_max3_u32 v110, v110, v22, v23
 v_mfma_f32_16x16x32_bf16 v[4:7], v[0:3], v[20:23], v[4:7]
 v_cmp_eq_u32 vcc, -1, v110
 s_cbranch_vccnz L_red3
 s_nop 0
 v_add_f32_dpp v4, v4, v4 row_ror:4 row_mask:0xf bank_mask:0xf
 v_add_f32_dpp v5, v5, v5 row_ror:4 row_mask:0xf bank_mask:0xf
 v_add_f32_dpp v6, v6, v6 row_ror:4 row_mask:0xf bank_mask:0xf
 v_add_f32_dpp v7, v7, v7 row_ror:4 row_mask:0xf bank_mask:0xf
 v_add_f32_dpp v4, v4, v4 row_ror:8 row_mask:0xf bank_mask:0xf
 v_add_f32_dpp v5, v5, v5 row_ror:8 row_mask:0xf bank_mask:0xf
 v_add_f32_dpp v6, v6, v6 row_ror:8 row_mask:0xf bank_mask:0xf
 v_add_f32_dpp v7, v7, v7 row_ror:8 row_mask:0xf bank_mask:0xf
 v_cvt_pk_bf16_f32 v4, v4, v5
 v_cvt_pk_bf16_f32 v5, v6, v7
 s_mov_b64 exec, 0x000f000f
 buffer_store_dwordx2 v[4:5], v103, s[36:39], s63 offen
 buffer_store_dwordx2 v[24:25], v103, s[36:39], s64 offen
 s_mov_b64 exec, -1
 s_branch L_fetch3
L_mx3:
 v_max3_f32 v60, v68, v69, v70
 v_max3_f32 v61, v71, v72, v73
 v_max3_f32 v62, v74, v75, v60
 v_max3_f32 v60, v64, v65, v61
 v_max_f32 v61, v60, v62
 v_max_f32 v63, v60, v62
 s_nop 1
 v_permlane16_swap_b32 v61, v63
 v_max_f32 v60, v61, v63
 v_max_f32 v62, v61, v63
 s_nop 1
 v_permlane32_swap_b32 v60, v62
 v_max_f32 v60, v60, v62
 v_pk_add_f32 v[64:65], v[64:65], v[60:61] op_sel_hi:[1,0] neg_lo:[0,1] neg_hi:[0,1]
 v_pk_add_f32 v[68:69], v[68:69], v[60:61] op_sel_hi:[1,0] neg_lo:[0,1] neg_hi:[0,1]
 v_pk_add_f32 v[70:71], v[70:71], v[60:61] op_sel_hi:[1,0] neg_lo:[0,1] neg_hi:[0,1]
 v_pk_add_f32 v[72:73], v[72:73], v[60:61] op_sel_hi:[1,0] neg_lo:[0,1] neg_hi:[0,1]
 v_pk_add_f32 v[74:75], v[74:75], v[60:61] op_sel_hi:[1,0] neg_lo:[0,1] neg_hi:[0,1]
 s_branch L_mxb3
L_ch_exit:
 s_endpgm
L_kv:
 s_mov_b32 s56, s3
 s_mov_b32 s40, s14
 s_mov_b32 s41, s15
 s_mov_b32 s42, 0x400000
 s_mov_b32 s43, 0x20000
 s_mov_b32 s44, s16
 s_mov_b32 s45, s17
 s_mov_b32 s46, 0x400000
 s_mov_b32 s47, 0x20000
 v_and_b32 v100, 63, v0
 s_lshl_b32 s63, s56, 5
 s_add_u32 s63, s63, s5
 s_lshl_b32 s63, s63, 7
 s_add_u32 s63, s63, 15794176
 v_mov_b32 v108, 0
 s_mov_b64 exec, 1
 buffer_store_dword v108, v108, s[36:39], s63 offen sc1
 s_mov_b64 exec, -1
 v_lshrrev_b32 v106, 4, v100
 s_lshr_b32 s64, s4, 1
 s_lshl_b32 s64, s64, 2
 v_or_b32 v106, s64, v106
 v_bfe_u32 v107, v100, 1, 3
 v_xor_b32 v106, v106, v107
 v_lshlrev_b32 v106, 5, v106
 v_and_b32 v107, 1, v100
 v_lshl_or_b32 v101, v107, 4, v106
 v_lshrrev_b32 v106, 4, v100
 s_lshl_b32 s64, s4, 2
 v_add_u32 v106, s64, v106
 v_lshl_add_u32 v101, v106, 13, v101
 s_lshl_b32 s60, s5, 8
 v_lshrrev_b32 v106, 4, v100
 v_bfe_u32 v107, v100, 2, 2
 v_lshl_add_u32 v102, v106, 3, v107
 v_lshlrev_b32 v102, 8, v102
 v_and_b32 v106, 1, v106
 v_lshl_or_b32 v106, v106, 2, v107
 v_lshl_or_b32 v102, v106, 5, v102
 v_and_b32 v106, 3, v100
 v_lshl_or_b32 v102, v106, 3, v102
 s_lshl_b32 s64, s4, 6
 v_xor_b32 v102, s64, v102
 v_lshlrev_b32 v104, 4, v100
 s_lshl_b32 s65, s4, 10
 s_lshl_b32 s65, s4, 10
 s_add_u32 m0, s65, 0
 s_add_u32 s64, s60, 0
 buffer_load_dwordx4 v101, s[40:43], s64 offen  lds
 s_add_u32 m0, s65, 4096
 s_add_u32 s64, s60, 131072
 buffer_load_dwordx4 v101, s[40:43], s64 offen  lds
 s_add_u32 m0, s65, 8192
 s_add_u32 s64, s60, 262144
 buffer_load_dwordx4 v101, s[40:43], s64 offen  lds
 s_add_u32 m0, s65, 12288
 s_add_u32 s64, s60, 393216
 buffer_load_dwordx4 v101, s[40:43], s64 offen  lds
 s_lshl_b32 s65, s4, 10
 s_add_u32 m0, s65, 16384
 s_add_u32 s64, s60, 0
 buffer_load_dwordx4 v101, s[44:47], s64 offen  lds
 s_add_u32 m0, s65, 20480
 s_add_u32 s64, s60, 131072
 buffer_load_dwordx4 v101, s[44:47], s64 offen  lds
 s_add_u32 m0, s65, 24576
 s_add_u32 s64, s60, 262144
 buffer_load_dwordx4 v101, s[44:47], s64 offen  lds
 s_add_u32 m0, s65, 28672
 s_add_u32 s64, s60, 393216
 buffer_load_dwordx4 v101, s[44:47], s64 offen  lds
 s_lshl_b32 s65, s4, 10
 s_add_u32 m0, s65, 32768
 s_add_u32 s64, s60, 524288
 buffer_load_dwordx4 v101, s[40:43], s64 offen  lds
 s_add_u32 m0, s65, 36864
 s_add_u32 s64, s60, 655360
 buffer_load_dwordx4 v101, s[40:43], s64 offen  lds
 s_add_u32 m0, s65, 40960
 s_add_u32 s64, s60, 786432
 buffer_load_dwordx4 v101, s[40:43], s64 offen  lds
 s_add_u32 m0, s65, 45056
 s_add_u32 s64, s60, 917504
 buffer_load_dwordx4 v101, s[40:43], s64 offen  lds
 s_lshl_b32 s65, s4, 10
 s_add_u32 m0, s65, 49152
 s_add_u32 s64, s60, 524288
 buffer_load_dwordx4 v101, s[44:47], s64 offen  lds
 s_add_u32 m0, s65, 53248
 s_add_u32 s64, s60, 655360
 buffer_load_dwordx4 v101, s[44:47], s64 offen  lds
 s_add_u32 m0, s65, 57344
 s_add_u32 s64, s60, 786432
 buffer_load_dwordx4 v101, s[44:47], s64 offen  lds
 s_add_u32 m0, s65, 61440
 s_add_u32 s64, s60, 917504
 buffer_load_dwordx4 v101, s[44:47], s64 offen  lds
 s_lshl_b32 s65, s4, 10
 s_add_u32 m0, s65, 65536
 s_add_u32 s64, s60, 1048576
 buffer_load_dwordx4 v101, s[40:43], s64 offen  lds
 s_add_u32 m0, s65, 69632
 s_add_u32 s64, s60, 1179648
 buffer_load_dwordx4 v101, s[40:43], s64 offen  lds
 s_add_u32 m0, s65, 73728
 s_add_u32 s64, s60, 1310720
 buffer_load_dwordx4 v101, s[40:43], s64 offen  lds
 s_add_u32 m0, s65, 77824
 s_add_u32 s64, s60, 1441792
 buffer_load_dwordx4 v101, s[40:43], s64 offen  lds
 s_lshl_b32 s65, s4, 10
 s_add_u32 m0, s65, 81920
 s_add_u32 s64, s60, 1048576
 buffer_load_dwordx4 v101, s[44:47], s64 offen  lds
 s_add_u32 m0, s65, 86016
 s_add_u32 s64, s60, 1179648
 buffer_load_dwordx4 v101, s[44:47], s64 offen  lds
 s_add_u32 m0, s65, 90112
 s_add_u32 s64, s60, 1310720
 buffer_load_dwordx4 v101, s[44:47], s64 offen  lds
 s_add_u32 m0, s65, 94208
 s_add_u32 s64, s60, 1441792
 buffer_load_dwordx4 v101, s[44:47], s64 offen  lds
 s_lshl_b32 s65, s4, 10
 s_add_u32 m0, s65, 98304
 s_add_u32 s64, s60, 1572864
 buffer_load_dwordx4 v101, s[40:43], s64 offen  lds
 s_add_u32 m0, s65, 102400
 s_add_u32 s64, s60, 1703936
 buffer_load_dwordx4 v101, s[40:43], s64 offen  lds
 s_add_u32 m0, s65, 106496
 s_add_u32 s64, s60, 1835008
 buffer_load_dwordx4 v101, s[40:43], s64 offen  lds
 s_add_u32 m0, s65, 110592
 s_add_u32 s64, s60, 1966080
 buffer_load_dwordx4 v101, s[40:43], s64 offen  lds
 s_lshl_b32 s65, s4, 10
 s_add_u32 m0, s65, 114688
 s_add_u32 s64, s60, 1572864
 buffer_load_dwordx4 v101, s[44:47], s64 offen  lds
 s_add_u32 m0, s65, 118784
 s_add_u32 s64, s60, 1703936
 buffer_load_dwordx4 v101, s[44:47], s64 offen  lds
 s_add_u32 m0, s65, 122880
 s_add_u32 s64, s60, 1835008
 buffer_load_dwordx4 v101, s[44:47], s64 offen  lds
 s_add_u32 m0, s65, 126976
 s_add_u32 s64, s60, 1966080
 buffer_load_dwordx4 v101, s[44:47], s64 offen  lds
 s_lshl_b32 s65, s4, 10
 s_add_u32 m0, s65, 131072
 s_add_u32 s64, s60, 2097152
 buffer_load_dwordx4 v101, s[40:43], s64 offen  lds
 s_add_u32 m0, s65, 135168
 s_add_u32 s64, s60, 2228224
 buffer_load_dwordx4 v101, s[40:43], s64 offen  lds
 s_add_u32 m0, s65, 139264
 s_add_u32 s64, s60, 2359296
 buffer_load_dwordx4 v101, s[40:43], s64 offen  lds
 s_add_u32 m0, s65, 143360
 s_add_u32 s64, s60, 2490368
 buffer_load_dwordx4 v101, s[40:43], s64 offen  lds
 s_waitcnt vmcnt(32)
 s_barrier
 s_cmp_lg_u32 s4, 0
 s_cbranch_scc1 L19
 v_mov_b32 v106, 192
 v_mov_b32 v107, 1
 s_mov_b64 exec, 1
 global_atomic_add v106, v107, s[32:33] sc1
 s_mov_b64 exec, -1
L19:
 s_lshl_b32 s65, s4, 10
 s_add_u32 m0, s65, 147456
 s_add_u32 s64, s60, 2097152
 buffer_load_dwordx4 v101, s[44:47], s64 offen  lds
 s_add_u32 m0, s65, 151552
 s_add_u32 s64, s60, 2228224
 buffer_load_dwordx4 v101, s[44:47], s64 offen  lds
 s_add_u32 m0, s65, 155648
 s_add_u32 s64, s60, 2359296
 buffer_load_dwordx4 v101, s[44:47], s64 offen  lds
 s_add_u32 m0, s65, 159744
 s_add_u32 s64, s60, 2490368
 buffer_load_dwordx4 v101, s[44:47], s64 offen  lds
 v_add_u32 v106, 0, v102
 v_xor_b32 v107, 32, v106
 ds_read_b64_tr_b16 a[0:1], v106 offset:0
 ds_read_b64_tr_b16 a[2:3], v106 offset:1024
 ds_read_b64_tr_b16 a[4:5], v106 offset:8192
 ds_read_b64_tr_b16 a[6:7], v106 offset:9216
 ds_read_b64_tr_b16 a[64:65], v107 offset:0
 ds_read_b64_tr_b16 a[66:67], v107 offset:1024
 ds_read_b64_tr_b16 a[68:69], v107 offset:8192
 ds_read_b64_tr_b16 a[70:71], v107 offset:9216
 s_waitcnt lgkmcnt(0)
 s_waitcnt vmcnt(32)
 s_barrier
 s_lshl_b32 s65, s4, 10
 s_add_u32 m0, s65, 0
 s_add_u32 s64, s60, 2621440
 buffer_load_dwordx4 v101, s[40:43], s64 offen  lds
 s_add_u32 m0, s65, 4096
 s_add_u32 s64, s60, 2752512
 buffer_load_dwordx4 v101, s[40:43], s64 offen  lds
 s_add_u32 m0, s65, 8192
 s_add_u32 s64, s60, 2883584
 buffer_load_dwordx4 v101, s[40:43], s64 offen  lds
 s_add_u32 m0, s65, 12288
 s_add_u32 s64, s60, 3014656
 buffer_load_dwordx4 v101, s[40:43], s64 offen  lds
 v_add_u32 v106, 16384, v102
 v_xor_b32 v107, 32, v106
 ds_read_b64_tr_b16 a[128:129], v106 offset:0
 ds_read_b64_tr_b16 a[130:131], v106 offset:1024
 ds_read_b64_tr_b16 a[132:133], v106 offset:8192
 ds_read_b64_tr_b16 a[134:135], v106 offset:9216
 ds_read_b64_tr_b16 a[192:193], v107 offset:0
 ds_read_b64_tr_b16 a[194:195], v107 offset:1024
 ds_read_b64_tr_b16 a[196:197], v107 offset:8192
 ds_read_b64_tr_b16 a[198:199], v107 offset:9216
 s_waitcnt lgkmcnt(0)
 s_waitcnt vmcnt(32)
 s_barrier
 s_lshl_b32 s65, s4, 10
 s_add_u32 m0, s65, 16384
 s_add_u32 s64, s60, 2621440
 buffer_load_dwordx4 v101, s[44:47], s64 offen  lds
 s_add_u32 m0, s65, 20480
 s_add_u32 s64, s60, 2752512
 buffer_load_dwordx4 v101, s[44:47], s64 offen  lds
 s_add_u32 m0, s65, 24576
 s_add_u32 s64, s60, 2883584
 buffer_load_dwordx4 v101, s[44:47], s64 offen  lds
 s_add_u32 m0, s65, 28672
 s_add_u32 s64, s60, 3014656
 buffer_load_dwordx4 v101, s[44:47], s64 offen  lds
 v_add_u32 v106, 32768, v102
 v_xor_b32 v107, 32, v106
 ds_read_b64_tr_b16 a[8:9], v106 offset:0
 ds_read_b64_tr_b16 a[10:11], v106 offset:1024
 ds_read_b64_tr_b16 a[12:13], v106 offset:8192
 ds_read_b64_tr_b16 a[14:15], v106 offset:9216
 ds_read_b64_tr_b16 a[72:73], v107 offset:0
 ds_read_b64_tr_b16 a[74:75], v107 offset:1024
 ds_read_b64_tr_b16 a[76:77], v107 offset:8192
 ds_read_b64_tr_b16 a[78:79], v107 offset:9216
 s_waitcnt lgkmcnt(0)
 s_waitcnt vmcnt(32)
 s_barrier
 s_lshl_b32 s65, s4, 10
 s_add_u32 m0, s65, 32768
 s_add_u32 s64, s60, 3145728
 buffer_load_dwordx4 v101, s[40:43], s64 offen  lds
 s_add_u32 m0, s65, 36864
 s_add_u32 s64, s60, 3276800
 buffer_load_dwordx4 v101, s[40:43], s64 offen  lds
 s_add_u32 m0, s65, 40960
 s_add_u32 s64, s60, 3407872
 buffer_load_dwordx4 v101, s[40:43], s64 offen  lds
 s_add_u32 m0, s65, 45056
 s_add_u32 s64, s60, 3538944
 buffer_load_dwordx4 v101, s[40:43], s64 offen  lds
 v_add_u32 v106, 49152, v102
 v_xor_b32 v107, 32, v106
 ds_read_b64_tr_b16 a[136:137], v106 offset:0
 ds_read_b64_tr_b16 a[138:139], v106 offset:1024
 ds_read_b64_tr_b16 a[140:141], v106 offset:8192
 ds_read_b64_tr_b16 a[142:143], v106 offset:9216
 ds_read_b64_tr_b16 a[200:201], v107 offset:0
 ds_read_b64_tr_b16 a[202:203], v107 offset:1024
 ds_read_b64_tr_b16 a[204:205], v107 offset:8192
 ds_read_b64_tr_b16 a[206:207], v107 offset:9216
 s_waitcnt lgkmcnt(0)
 s_waitcnt vmcnt(32)
 s_barrier
 s_lshl_b32 s65, s4, 10
 s_add_u32 m0, s65, 49152
 s_add_u32 s64, s60, 3145728
 buffer_load_dwordx4 v101, s[44:47], s64 offen  lds
 s_add_u32 m0, s65, 53248
 s_add_u32 s64, s60, 3276800
 buffer_load_dwordx4 v101, s[44:47], s64 offen  lds
 s_add_u32 m0, s65, 57344
 s_add_u32 s64, s60, 3407872
 buffer_load_dwordx4 v101, s[44:47], s64 offen  lds
 s_add_u32 m0, s65, 61440
 s_add_u32 s64, s60, 3538944
 buffer_load_dwordx4 v101, s[44:47], s64 offen  lds
 v_add_u32 v106, 65536, v102
 v_xor_b32 v107, 32, v106
 ds_read_b64_tr_b16 a[16:17], v106 offset:0
 ds_read_b64_tr_b16 a[18:19], v106 offset:1024
 ds_read_b64_tr_b16 a[20:21], v106 offset:8192
 ds_read_b64_tr_b16 a[22:23], v106 offset:9216
 ds_read_b64_tr_b16 a[80:81], v107 offset:0
 ds_read_b64_tr_b16 a[82:83], v107 offset:1024
 ds_read_b64_tr_b16 a[84:85], v107 offset:8192
 ds_read_b64_tr_b16 a[86:87], v107 offset:9216
 s_waitcnt lgkmcnt(0)
 s_waitcnt vmcnt(32)
 s_barrier
 s_lshl_b32 s65, s4, 10
 s_add_u32 m0, s65, 65536
 s_add_u32 s64, s60, 3670016
 buffer_load_dwordx4 v101, s[40:43], s64 offen  lds
 s_add_u32 m0, s65, 69632
 s_add_u32 s64, s60, 3801088
 buffer_load_dwordx4 v101, s[40:43], s64 offen  lds
 s_add_u32 m0, s65, 73728
 s_add_u32 s64, s60, 3932160
 buffer_load_dwordx4 v101, s[40:43], s64 offen  lds
 s_add_u32 m0, s65, 77824
 s_add_u32 s64, s60, 4063232
 buffer_load_dwordx4 v101, s[40:43], s64 offen  lds
 v_add_u32 v106, 81920, v102
 v_xor_b32 v107, 32, v106
 ds_read_b64_tr_b16 a[144:145], v106 offset:0
 ds_read_b64_tr_b16 a[146:147], v106 offset:1024
 ds_read_b64_tr_b16 a[148:149], v106 offset:8192
 ds_read_b64_tr_b16 a[150:151], v106 offset:9216
 ds_read_b64_tr_b16 a[208:209], v107 offset:0
 ds_read_b64_tr_b16 a[210:211], v107 offset:1024
 ds_read_b64_tr_b16 a[212:213], v107 offset:8192
 ds_read_b64_tr_b16 a[214:215], v107 offset:9216
 s_waitcnt lgkmcnt(0)
 s_waitcnt vmcnt(32)
 s_barrier
 s_lshl_b32 s65, s4, 10
 s_add_u32 m0, s65, 81920
 s_add_u32 s64, s60, 3670016
 buffer_load_dwordx4 v101, s[44:47], s64 offen  lds
 s_add_u32 m0, s65, 86016
 s_add_u32 s64, s60, 3801088
 buffer_load_dwordx4 v101, s[44:47], s64 offen  lds
 s_add_u32 m0, s65, 90112
 s_add_u32 s64, s60, 3932160
 buffer_load_dwordx4 v101, s[44:47], s64 offen  lds
 s_add_u32 m0, s65, 94208
 s_add_u32 s64, s60, 4063232
 buffer_load_dwordx4 v101, s[44:47], s64 offen  lds
 v_add_u32 v106, 98304, v102
 v_xor_b32 v107, 32, v106
 ds_read_b64_tr_b16 a[24:25], v106 offset:0
 ds_read_b64_tr_b16 a[26:27], v106 offset:1024
 ds_read_b64_tr_b16 a[28:29], v106 offset:8192
 ds_read_b64_tr_b16 a[30:31], v106 offset:9216
 ds_read_b64_tr_b16 a[88:89], v107 offset:0
 ds_read_b64_tr_b16 a[90:91], v107 offset:1024
 ds_read_b64_tr_b16 a[92:93], v107 offset:8192
 ds_read_b64_tr_b16 a[94:95], v107 offset:9216
 s_waitcnt lgkmcnt(0)
 s_waitcnt vmcnt(32)
 s_barrier
 v_add_u32 v106, 114688, v102
 v_xor_b32 v107, 32, v106
 ds_read_b64_tr_b16 a[152:153], v106 offset:0
 ds_read_b64_tr_b16 a[154:155], v106 offset:1024
 ds_read_b64_tr_b16 a[156:157], v106 offset:8192
 ds_read_b64_tr_b16 a[158:159], v106 offset:9216
 ds_read_b64_tr_b16 a[216:217], v107 offset:0
 ds_read_b64_tr_b16 a[218:219], v107 offset:1024
 ds_read_b64_tr_b16 a[220:221], v107 offset:8192
 ds_read_b64_tr_b16 a[222:223], v107 offset:9216
 s_waitcnt lgkmcnt(0)
 s_waitcnt vmcnt(28)
 s_barrier
 v_add_u32 v106, 131072, v102
 v_xor_b32 v107, 32, v106
 ds_read_b64_tr_b16 a[32:33], v106 offset:0
 ds_read_b64_tr_b16 a[34:35], v106 offset:1024
 ds_read_b64_tr_b16 a[36:37], v106 offset:8192
 ds_read_b64_tr_b16 a[38:39], v106 offset:9216
 ds_read_b64_tr_b16 a[96:97], v107 offset:0
 ds_read_b64_tr_b16 a[98:99], v107 offset:1024
 ds_read_b64_tr_b16 a[100:101], v107 offset:8192
 ds_read_b64_tr_b16 a[102:103], v107 offset:9216
 s_waitcnt lgkmcnt(0)
 s_waitcnt vmcnt(24)
 s_barrier
 v_add_u32 v106, 147456, v102
 v_xor_b32 v107, 32, v106
 ds_read_b64_tr_b16 a[160:161], v106 offset:0
 ds_read_b64_tr_b16 a[162:163], v106 offset:1024
 ds_read_b64_tr_b16 a[164:165], v106 offset:8192
 ds_read_b64_tr_b16 a[166:167], v106 offset:9216
 ds_read_b64_tr_b16 a[224:225], v107 offset:0
 ds_read_b64_tr_b16 a[226:227], v107 offset:1024
 ds_read_b64_tr_b16 a[228:229], v107 offset:8192
 ds_read_b64_tr_b16 a[230:231], v107 offset:9216
 s_waitcnt lgkmcnt(0)
 s_waitcnt vmcnt(20)
 s_barrier
 v_add_u32 v106, 0, v102
 v_xor_b32 v107, 32, v106
 ds_read_b64_tr_b16 a[40:41], v106 offset:0
 ds_read_b64_tr_b16 a[42:43], v106 offset:1024
 ds_read_b64_tr_b16 a[44:45], v106 offset:8192
 ds_read_b64_tr_b16 a[46:47], v106 offset:9216
 ds_read_b64_tr_b16 a[104:105], v107 offset:0
 ds_read_b64_tr_b16 a[106:107], v107 offset:1024
 ds_read_b64_tr_b16 a[108:109], v107 offset:8192
 ds_read_b64_tr_b16 a[110:111], v107 offset:9216
 s_waitcnt lgkmcnt(0)
 s_waitcnt vmcnt(16)
 s_barrier
 v_add_u32 v106, 16384, v102
 v_xor_b32 v107, 32, v106
 ds_read_b64_tr_b16 a[168:169], v106 offset:0
 ds_read_b64_tr_b16 a[170:171], v106 offset:1024
 ds_read_b64_tr_b16 a[172:173], v106 offset:8192
 ds_read_b64_tr_b16 a[174:175], v106 offset:9216
 ds_read_b64_tr_b16 a[232:233], v107 offset:0
 ds_read_b64_tr_b16 a[234:235], v107 offset:1024
 ds_read_b64_tr_b16 a[236:237], v107 offset:8192
 ds_read_b64_tr_b16 a[238:239], v107 offset:9216
 s_waitcnt lgkmcnt(0)
 s_waitcnt vmcnt(12)
 s_barrier
 v_add_u32 v106, 32768, v102
 v_xor_b32 v107, 32, v106
 ds_read_b64_tr_b16 a[48:49], v106 offset:0
 ds_read_b64_tr_b16 a[50:51], v106 offset:1024
 ds_read_b64_tr_b16 a[52:53], v106 offset:8192
 ds_read_b64_tr_b16 a[54:55], v106 offset:9216
 ds_read_b64_tr_b16 a[112:113], v107 offset:0
 ds_read_b64_tr_b16 a[114:115], v107 offset:1024
 ds_read_b64_tr_b16 a[116:117], v107 offset:8192
 ds_read_b64_tr_b16 a[118:119], v107 offset:9216
 s_waitcnt lgkmcnt(0)
 s_waitcnt vmcnt(8)
 s_barrier
 v_add_u32 v106, 49152, v102
 v_xor_b32 v107, 32, v106
 ds_read_b64_tr_b16 a[176:177], v106 offset:0
 ds_read_b64_tr_b16 a[178:179], v106 offset:1024
 ds_read_b64_tr_b16 a[180:181], v106 offset:8192
 ds_read_b64_tr_b16 a[182:183], v106 offset:9216
 ds_read_b64_tr_b16 a[240:241], v107 offset:0
 ds_read_b64_tr_b16 a[242:243], v107 offset:1024
 ds_read_b64_tr_b16 a[244:245], v107 offset:8192
 ds_read_b64_tr_b16 a[246:247], v107 offset:9216
 s_waitcnt lgkmcnt(0)
 s_waitcnt vmcnt(4)
 s_barrier
 v_add_u32 v106, 65536, v102
 v_xor_b32 v107, 32, v106
 ds_read_b64_tr_b16 a[56:57], v106 offset:0
 ds_read_b64_tr_b16 a[58:59], v106 offset:1024
 ds_read_b64_tr_b16 a[60:61], v106 offset:8192
 ds_read_b64_tr_b16 a[62:63], v106 offset:9216
 ds_read_b64_tr_b16 a[120:121], v107 offset:0
 ds_read_b64_tr_b16 a[122:123], v107 offset:1024
 ds_read_b64_tr_b16 a[124:125], v107 offset:8192
 ds_read_b64_tr_b16 a[126:127], v107 offset:9216
 s_waitcnt lgkmcnt(0)
 s_waitcnt vmcnt(0)
 s_barrier
 v_add_u32 v106, 81920, v102
 v_xor_b32 v107, 32, v106
 ds_read_b64_tr_b16 a[184:185], v106 offset:0
 ds_read_b64_tr_b16 a[186:187], v106 offset:1024
 ds_read_b64_tr_b16 a[188:189], v106 offset:8192
 ds_read_b64_tr_b16 a[190:191], v106 offset:9216
 ds_read_b64_tr_b16 a[248:249], v107 offset:0
 ds_read_b64_tr_b16 a[250:251], v107 offset:1024
 ds_read_b64_tr_b16 a[252:253], v107 offset:8192
 ds_read_b64_tr_b16 a[254:255], v107 offset:9216
 s_waitcnt lgkmcnt(0)
 s_cmp_lg_u32 s4, 0
 s_cbranch_scc1 L20
 s_mov_b32 s7, 524288
 v_mov_b32 v106, 64
 s_branch L22
L21:
 s_sleep 4
L22:
 global_load_dword v107, v106, s[32:33] sc1
 s_sub_u32 s7, s7, 1
 s_cbranch_scc1 L_abort
 s_waitcnt vmcnt(0)
 v_readfirstlane_b32 s64, v107
 s_cmp_lt_u32 s64, 64
 s_cbranch_scc1 L21
L20:
 s_barrier
 s_mov_b32 s57, 32
 s_mov_b32 s58, 0
 s_mov_b32 s59, s56
 s_mov_b32 s61, 0
 s_lshl_b32 s69, s59, 15
 s_lshl_b32 s65, s4, 13
 s_add_u32 s69, s69, s65
 s_add_u32 m0, s61, s65
 s_add_u32 s69, s69, 0
 buffer_load_dwordx4 v104, s[36:39], s69 offen offset:0 sc1 lds
 buffer_load_dwordx4 v104, s[36:39], s69 offen offset:1024 sc1 lds
 buffer_load_dwordx4 v104, s[36:39], s69 offen offset:2048 sc1 lds
 buffer_load_dwordx4 v104, s[36:39], s69 offen offset:3072 sc1 lds
 s_add_u32 s69, s69, 4096
 s_add_u32 m0, m0, 4096
 s_nop 0
 buffer_load_dwordx4 v104, s[36:39], s69 offen offset:0 sc1 lds
 buffer_load_dwordx4 v104, s[36:39], s69 offen offset:1024 sc1 lds
 buffer_load_dwordx4 v104, s[36:39], s69 offen offset:2048 sc1 lds
 buffer_load_dwordx4 v104, s[36:39], s69 offen offset:3072 sc1 lds
 s_add_u32 s66, s59, 2
 s_mov_b32 s61, 32768
 s_lshl_b32 s69, s66, 15
 s_lshl_b32 s65, s4, 13
 s_add_u32 s69, s69, s65
 s_add_u32 m0, s61, s65
 s_add_u32 s69, s69, 0
 buffer_load_dwordx4 v104, s[36:39], s69 offen offset:0 sc1 lds
 buffer_load_dwordx4 v104, s[36:39], s69 offen offset:1024 sc1 lds
 buffer_load_dwordx4 v104, s[36:39], s69 offen offset:2048 sc1 lds
 buffer_load_dwordx4 v104, s[36:39], s69 offen offset:3072 sc1 lds
 s_add_u32 s69, s69, 4096
 s_add_u32 m0, m0, 4096
 s_nop 0
 buffer_load_dwordx4 v104, s[36:39], s69 offen offset:0 sc1 lds
 buffer_load_dwordx4 v104, s[36:39], s69 offen offset:1024 sc1 lds
 buffer_load_dwordx4 v104, s[36:39], s69 offen offset:2048 sc1 lds
 buffer_load_dwordx4 v104, s[36:39], s69 offen offset:3072 sc1 lds
 v_mov_b64 v[80:81], -1
 v_mov_b64 v[82:83], -1
 s_lshl_b32 s67, s5, 10
 s_and_b32 s64, s4, 1
 s_mul_i32 s64, s64, 2097152
 s_add_u32 s67, s67, s64
 s_add_u32 s67, s67, 2097152
 s_mov_b32 s68, 0
 s_mov_b32 s61, 65536
 s_mov_b32 s70, 268435456
 s_mov_b32 s71, 268435456
 s_mov_b32 s72, 268435456
 s_waitcnt vmcnt(8)
L_kv_loop:
 s_barrier
 v_add_u32 v105, s68, v104
 ds_read_b128 v[32:35], v105 offset:0
 ds_read_b128 v[36:39], v105 offset:16384
 ds_read_b128 v[40:43], v105 offset:1024
 ds_read_b128 v[44:47], v105 offset:17408
 s_add_u32 s66, s59, 4
 s_min_u32 s66, s66, 63
 s_lshl_b32 s69, s66, 15
 s_lshl_b32 s65, s4, 13
 s_add_u32 s69, s69, s65
 s_add_u32 m0, s61, s65
 s_add_u32 s69, s69, 0
 s_waitcnt lgkmcnt(2)
 v_mfma_f32_16x16x32_bf16 v[0:3], a[0:3], v[32:35], 0
 v_mfma_f32_16x16x32_bf16 v[16:19], v[32:35], a[128:131], 0
 ds_read_b128 v[48:51], v105 offset:2048
 ds_read_b128 v[52:55], v105 offset:18432
 v_mfma_f32_16x16x32_bf16 v[8:11], a[64:67], v[32:35], 0
 v_mfma_f32_16x16x32_bf16 v[24:27], v[32:35], a[192:195], 0
 v_mfma_f32_16x16x32_bf16 v[4:7], a[0:3], v[36:39], 0
 v_mfma_f32_16x16x32_bf16 v[20:23], v[36:39], a[128:131], 0
 buffer_store_dwordx4 v[72:75], v104, s[36:39], s70 offen offset:2048 sc1
 v_mfma_f32_16x16x32_bf16 v[12:15], a[64:67], v[36:39], 0
 v_mfma_f32_16x16x32_bf16 v[28:31], v[36:39], a[192:195], 0
 s_waitcnt lgkmcnt(2)
 v_mfma_f32_16x16x32_bf16 v[0:3], a[4:7], v[40:43], v[0:3]
 v_mfma_f32_16x16x32_bf16 v[16:19], v[40:43], a[132:135], v[16:19]
 ds_read_b128 v[32:35], v105 offset:3072
 ds_read_b128 v[36:39], v105 offset:19456
 v_mfma_f32_16x16x32_bf16 v[8:11], a[68:71], v[40:43], v[8:11]
 v_mfma_f32_16x16x32_bf16 v[24:27], v[40:43], a[196:199], v[24:27]
 v_mfma_f32_16x16x32_bf16 v[4:7], a[4:7], v[44:47], v[4:7]
 v_mfma_f32_16x16x32_bf16 v[20:23], v[44:47], a[132:135], v[20:23]
 buffer_store_dwordx4 v[76:79], v104, s[36:39], s70 offen offset:3072 sc1
 v_mfma_f32_16x16x32_bf16 v[12:15], a[68:71], v[44:47], v[12:15]
 v_mfma_f32_16x16x32_bf16 v[28:31], v[44:47], a[196:199], v[28:31]
 s_waitcnt lgkmcnt(2)
 v_mfma_f32_16x16x32_bf16 v[0:3], a[8:11], v[48:51], v[0:3]
 v_mfma_f32_16x16x32_bf16 v[16:19], v[48:51], a[136:139], v[16:19]
 ds_read_b128 v[40:43], v105 offset:4096
 ds_read_b128 v[44:47], v105 offset:20480
 v_mfma_f32_16x16x32_bf16 v[8:11], a[72:75], v[48:51], v[8:11]
 v_mfma_f32_16x16x32_bf16 v[24:27], v[48:51], a[200:203], v[24:27]
 v_mfma_f32_16x16x32_bf16 v[4:7], a[8:11], v[52:55], v[4:7]
 v_mfma_f32_16x16x32_bf16 v[20:23], v[52:55], a[136:139], v[20:23]
 buffer_store_dwordx4 v[64:67], v104, s[36:39], s70 offen offset:0 sc1
 v_mfma_f32_16x16x32_bf16 v[12:15], a[72:75], v[52:55], v[12:15]
 v_mfma_f32_16x16x32_bf16 v[28:31], v[52:55], a[200:203], v[28:31]
 s_waitcnt lgkmcnt(2)
 v_mfma_f32_16x16x32_bf16 v[0:3], a[12:15], v[32:35], v[0:3]
 v_mfma_f32_16x16x32_bf16 v[16:19], v[32:35], a[140:143], v[16:19]
 ds_read_b128 v[48:51], v105 offset:5120
 ds_read_b128 v[52:55], v105 offset:21504
 v_mfma_f32_16x16x32_bf16 v[8:11], a[76:79], v[32:35], v[8:11]
 v_mfma_f32_16x16x32_bf16 v[24:27], v[32:35], a[204:207], v[24:27]
 v_mfma_f32_16x16x32_bf16 v[4:7], a[12:15], v[36:39], v[4:7]
 v_mfma_f32_16x16x32_bf16 v[20:23], v[36:39], a[140:143], v[20:23]
 buffer_store_dwordx4 v[68:71], v104, s[36:39], s70 offen offset:1024 sc1
 v_mfma_f32_16x16x32_bf16 v[12:15], a[76:79], v[36:39], v[12:15]
 v_mfma_f32_16x16x32_bf16 v[28:31], v[36:39], a[204:207], v[28:31]
 s_waitcnt lgkmcnt(2)
 v_mfma_f32_16x16x32_bf16 v[0:3], a[16:19], v[40:43], v[0:3]
 v_mfma_f32_16x16x32_bf16 v[16:19], v[40:43], a[144:147], v[16:19]
 ds_read_b128 v[32:35], v105 offset:6144
 ds_read_b128 v[36:39], v105 offset:22528
 v_mfma_f32_16x16x32_bf16 v[8:11], a[80:83], v[40:43], v[8:11]
 v_mfma_f32_16x16x32_bf16 v[24:27], v[40:43], a[208:211], v[24:27]
 v_mfma_f32_16x16x32_bf16 v[4:7], a[16:19], v[44:47], v[4:7]
 v_mfma_f32_16x16x32_bf16 v[20:23], v[44:47], a[144:147], v[20:23]
 buffer_store_dwordx4 v[80:83], v104, s[36:39], s71 offen sc1
 v_mfma_f32_16x16x32_bf16 v[12:15], a[80:83], v[44:47], v[12:15]
 v_mfma_f32_16x16x32_bf16 v[28:31], v[44:47], a[208:211], v[28:31]
 s_waitcnt lgkmcnt(2)
 v_mfma_f32_16x16x32_bf16 v[0:3], a[20:23], v[48:51], v[0:3]
 v_mfma_f32_16x16x32_bf16 v[16:19], v[48:51], a[148:151], v[16:19]
 ds_read_b128 v[40:43], v105 offset:7168
 ds_read_b128 v[44:47], v105 offset:23552
 v_mfma_f32_16x16x32_bf16 v[8:11], a[84:87], v[48:51], v[8:11]
 v_mfma_f32_16x16x32_bf16 v[24:27], v[48:51], a[212:215], v[24:27]
 v_mfma_f32_16x16x32_bf16 v[4:7], a[20:23], v[52:55], v[4:7]
 v_mfma_f32_16x16x32_bf16 v[20:23], v[52:55], a[148:151], v[20:23]
 buffer_store_dwordx4 v[80:83], v104, s[36:39], s72 offen sc1
 v_mfma_f32_16x16x32_bf16 v[12:15], a[84:87], v[52:55], v[12:15]
 v_mfma_f32_16x16x32_bf16 v[28:31], v[52:55], a[212:215], v[28:31]
 s_waitcnt lgkmcnt(2)
 v_mfma_f32_16x16x32_bf16 v[0:3], a[24:27], v[32:35], v[0:3]
 v_mfma_f32_16x16x32_bf16 v[16:19], v[32:35], a[152:155], v[16:19]
 ds_read_b128 v[48:51], v105 offset:8192
 ds_read_b128 v[52:55], v105 offset:24576
 v_mfma_f32_16x16x32_bf16 v[8:11], a[88:91], v[32:35], v[8:11]
 v_mfma_f32_16x16x32_bf16 v[24:27], v[32:35], a[216:219], v[24:27]
 v_mfma_f32_16x16x32_bf16 v[4:7], a[24:27], v[36:39], v[4:7]
 v_mfma_f32_16x16x32_bf16 v[20:23], v[36:39], a[152:155], v[20:23]
 buffer_load_dwordx4 v104, s[36:39], s69 offen offset:0 sc1 lds
 v_mfma_f32_16x16x32_bf16 v[12:15], a[88:91], v[36:39], v[12:15]
 v_mfma_f32_16x16x32_bf16 v[28:31], v[36:39], a[216:219], v[28:31]
 s_waitcnt lgkmcnt(2)
 v_mfma_f32_16x16x32_bf16 v[0:3], a[28:31], v[40:43], v[0:3]
 v_mfma_f32_16x16x32_bf16 v[16:19], v[40:43], a[156:159], v[16:19]
 ds_read_b128 v[32:35], v105 offset:9216
 ds_read_b128 v[36:39], v105 offset:25600
 v_mfma_f32_16x16x32_bf16 v[8:11], a[92:95], v[40:43], v[8:11]
 v_mfma_f32_16x16x32_bf16 v[24:27], v[40:43], a[220:223], v[24:27]
 v_mfma_f32_16x16x32_bf16 v[4:7], a[28:31], v[44:47], v[4:7]
 v_mfma_f32_16x16x32_bf16 v[20:23], v[44:47], a[156:159], v[20:23]
 buffer_load_dwordx4 v104, s[36:39], s69 offen offset:1024 sc1 lds
 v_mfma_f32_16x16x32_bf16 v[12:15], a[92:95], v[44:47], v[12:15]
 v_mfma_f32_16x16x32_bf16 v[28:31], v[44:47], a[220:223], v[28:31]
 s_waitcnt lgkmcnt(2)
 v_mfma_f32_16x16x32_bf16 v[0:3], a[32:35], v[48:51], v[0:3]
 v_mfma_f32_16x16x32_bf16 v[16:19], v[48:51], a[160:163], v[16:19]
 ds_read_b128 v[40:43], v105 offset:10240
 ds_read_b128 v[44:47], v105 offset:26624
 v_mfma_f32_16x16x32_bf16 v[8:11], a[96:99], v[48:51], v[8:11]
 v_mfma_f32_16x16x32_bf16 v[24:27], v[48:51], a[224:227], v[24:27]
 v_mfma_f32_16x16x32_bf16 v[4:7], a[32:35], v[52:55], v[4:7]
 v_mfma_f32_16x16x32_bf16 v[20:23], v[52:55], a[160:163], v[20:23]
 buffer_load_dwordx4 v104, s[36:39], s69 offen offset:2048 sc1 lds
 v_mfma_f32_16x16x32_bf16 v[12:15], a[96:99], v[52:55], v[12:15]
 v_mfma_f32_16x16x32_bf16 v[28:31], v[52:55], a[224:227], v[28:31]
 s_waitcnt lgkmcnt(2)
 v_mfma_f32_16x16x32_bf16 v[0:3], a[36:39], v[32:35], v[0:3]
 v_mfma_f32_16x16x32_bf16 v[16:19], v[32:35], a[164:167], v[16:19]
 ds_read_b128 v[48:51], v105 offset:11264
 ds_read_b128 v[52:55], v105 offset:27648
 v_mfma_f32_16x16x32_bf16 v[8:11], a[100:103], v[32:35], v[8:11]
 v_mfma_f32_16x16x32_bf16 v[24:27], v[32:35], a[228:231], v[24:27]
 v_mfma_f32_16x16x32_bf16 v[4:7], a[36:39], v[36:39], v[4:7]
 v_mfma_f32_16x16x32_bf16 v[20:23], v[36:39], a[164:167], v[20:23]
 buffer_load_dwordx4 v104, s[36:39], s69 offen offset:3072 sc1 lds
 v_mfma_f32_16x16x32_bf16 v[12:15], a[100:103], v[36:39], v[12:15]
 v_mfma_f32_16x16x32_bf16 v[28:31], v[36:39], a[228:231], v[28:31]
 s_waitcnt lgkmcnt(2)
 v_mfma_f32_16x16x32_bf16 v[0:3], a[40:43], v[40:43], v[0:3]
 v_mfma_f32_16x16x32_bf16 v[16:19], v[40:43], a[168:171], v[16:19]
 ds_read_b128 v[32:35], v105 offset:12288
 ds_read_b128 v[36:39], v105 offset:28672
 v_mfma_f32_16x16x32_bf16 v[8:11], a[104:107], v[40:43], v[8:11]
 v_mfma_f32_16x16x32_bf16 v[24:27], v[40:43], a[232:235], v[24:27]
 v_mfma_f32_16x16x32_bf16 v[4:7], a[40:43], v[44:47], v[4:7]
 v_mfma_f32_16x16x32_bf16 v[20:23], v[44:47], a[168:171], v[20:23]
 s_add_u32 s69, s69, 4096
 s_add_u32 m0, m0, 4096
 s_nop 0
 buffer_load_dwordx4 v104, s[36:39], s69 offen offset:0 sc1 lds
 v_mfma_f32_16x16x32_bf16 v[12:15], a[104:107], v[44:47], v[12:15]
 v_mfma_f32_16x16x32_bf16 v[28:31], v[44:47], a[232:235], v[28:31]
 s_waitcnt lgkmcnt(2)
 v_mfma_f32_16x16x32_bf16 v[0:3], a[44:47], v[48:51], v[0:3]
 v_mfma_f32_16x16x32_bf16 v[16:19], v[48:51], a[172:175], v[16:19]
 ds_read_b128 v[40:43], v105 offset:13312
 ds_read_b128 v[44:47], v105 offset:29696
 v_mfma_f32_16x16x32_bf16 v[8:11], a[108:111], v[48:51], v[8:11]
 v_mfma_f32_16x16x32_bf16 v[24:27], v[48:51], a[236:239], v[24:27]
 v_mfma_f32_16x16x32_bf16 v[4:7], a[44:47], v[52:55], v[4:7]
 v_mfma_f32_16x16x32_bf16 v[20:23], v[52:55], a[172:175], v[20:23]
 buffer_load_dwordx4 v104, s[36:39], s69 offen offset:1024 sc1 lds
 v_mfma_f32_16x16x32_bf16 v[12:15], a[108:111], v[52:55], v[12:15]
 v_mfma_f32_16x16x32_bf16 v[28:31], v[52:55], a[236:239], v[28:31]
 s_waitcnt lgkmcnt(2)
 v_mfma_f32_16x16x32_bf16 v[0:3], a[48:51], v[32:35], v[0:3]
 v_mfma_f32_16x16x32_bf16 v[16:19], v[32:35], a[176:179], v[16:19]
 ds_read_b128 v[48:51], v105 offset:14336
 ds_read_b128 v[52:55], v105 offset:30720
 v_mfma_f32_16x16x32_bf16 v[8:11], a[112:115], v[32:35], v[8:11]
 v_mfma_f32_16x16x32_bf16 v[24:27], v[32:35], a[240:243], v[24:27]
 v_mfma_f32_16x16x32_bf16 v[4:7], a[48:51], v[36:39], v[4:7]
 v_mfma_f32_16x16x32_bf16 v[20:23], v[36:39], a[176:179], v[20:23]
 buffer_load_dwordx4 v104, s[36:39], s69 offen offset:2048 sc1 lds
 v_mfma_f32_16x16x32_bf16 v[12:15], a[112:115], v[36:39], v[12:15]
 v_mfma_f32_16x16x32_bf16 v[28:31], v[36:39], a[240:243], v[28:31]
 s_waitcnt lgkmcnt(2)
 v_mfma_f32_16x16x32_bf16 v[0:3], a[52:55], v[40:43], v[0:3]
 v_mfma_f32_16x16x32_bf16 v[16:19], v[40:43], a[180:183], v[16:19]
 ds_read_b128 v[32:35], v105 offset:15360
 ds_read_b128 v[36:39], v105 offset:31744
 v_mfma_f32_16x16x32_bf16 v[8:11], a[116:119], v[40:43], v[8:11]
 v_mfma_f32_16x16x32_bf16 v[24:27], v[40:43], a[244:247], v[24:27]
 v_mfma_f32_16x16x32_bf16 v[4:7], a[52:55], v[44:47], v[4:7]
 v_mfma_f32_16x16x32_bf16 v[20:23], v[44:47], a[180:183], v[20:23]
 buffer_load_dwordx4 v104, s[36:39], s69 offen offset:3072 sc1 lds
 v_mfma_f32_16x16x32_bf16 v[12:15], a[116:119], v[44:47], v[12:15]
 v_mfma_f32_16x16x32_bf16 v[28:31], v[44:47], a[244:247], v[28:31]
 s_waitcnt vmcnt(8)
 s_barrier
 s_cmp_lg_u32 s4, 0
 s_cbranch_scc1 L23
 v_mov_b32 v106, s58
 s_mov_b64 exec, 1
 buffer_store_dword v106, v108, s[36:39], s63 offen sc1
 s_mov_b64 exec, -1
L23:
 s_waitcnt lgkmcnt(2)
 v_mfma_f32_16x16x32_bf16 v[0:3], a[56:59], v[48:51], v[0:3]
 v_mfma_f32_16x16x32_bf16 v[16:19], v[48:51], a[184:187], v[16:19]
 v_mfma_f32_16x16x32_bf16 v[8:11], a[120:123], v[48:51], v[8:11]
 v_mfma_f32_16x16x32_bf16 v[24:27], v[48:51], a[248:251], v[24:27]
 v_mfma_f32_16x16x32_bf16 v[4:7], a[56:59], v[52:55], v[4:7]
 v_mfma_f32_16x16x32_bf16 v[20:23], v[52:55], a[184:187], v[20:23]
 v_mfma_f32_16x16x32_bf16 v[12:15], a[120:123], v[52:55], v[12:15]
 v_mfma_f32_16x16x32_bf16 v[28:31], v[52:55], a[248:251], v[28:31]
 s_waitcnt lgkmcnt(0)
 v_mfma_f32_16x16x32_bf16 v[0:3], a[60:63], v[32:35], v[0:3]
 v_mfma_f32_16x16x32_bf16 v[16:19], v[32:35], a[188:191], v[16:19]
 v_mfma_f32_16x16x32_bf16 v[8:11], a[124:127], v[32:35], v[8:11]
 v_mfma_f32_16x16x32_bf16 v[24:27], v[32:35], a[252:255], v[24:27]
 v_mfma_f32_16x16x32_bf16 v[4:7], a[60:63], v[36:39], v[4:7]
 v_mfma_f32_16x16x32_bf16 v[20:23], v[36:39], a[188:191], v[20:23]
 v_mfma_f32_16x16x32_bf16 v[12:15], a[124:127], v[36:39], v[12:15]
 v_mfma_f32_16x16x32_bf16 v[28:31], v[36:39], a[252:255], v[28:31]
 s_lshl_b32 s62, s59, 5
 s_add_u32 s62, s62, s5
 s_lshl_b32 s62, s62, 2
 s_add_u32 s62, s62, s4
 s_lshl_b32 s71, s62, 10
 s_add_u32 s71, s71, 6291456
 s_lshl_b32 s72, s59, 15
 s_add_u32 s72, s72, s67
 s_lshl_b32 s70, s62, 12
 s_add_u32 s70, s70, 33554432
 s_add_u32 s68, s68, 32768
 s_cmp_eq_u32 s68, 98304
 s_cselect_b32 s68, 0, s68
 s_add_u32 s61, s61, 32768
 s_cmp_eq_u32 s61, 98304
 s_cselect_b32 s61, 0, s61
 v_cvt_pk_bf16_f32 v72, v0, v8
 v_cvt_pk_bf16_f32 v73, v1, v9
 v_cvt_pk_bf16_f32 v74, v2, v10
 v_cvt_pk_bf16_f32 v75, v3, v11
 v_cvt_pk_bf16_f32 v76, v4, v12
 v_cvt_pk_bf16_f32 v77, v5, v13
 v_cvt_pk_bf16_f32 v78, v6, v14
 v_cvt_pk_bf16_f32 v79, v7, v15
 v_cvt_pk_bf16_f32 v64, v16, v17
 v_cvt_pk_bf16_f32 v65, v18, v19
 v_cvt_pk_bf16_f32 v66, v20, v21
 v_cvt_pk_bf16_f32 v67, v22, v23
 v_cvt_pk_bf16_f32 v68, v24, v25
 v_cvt_pk_bf16_f32 v69, v26, v27
 v_cvt_pk_bf16_f32 v70, v28, v29
 v_cvt_pk_bf16_f32 v71, v30, v31
 s_add_u32 s58, s58, 1
 s_add_u32 s59, s59, 2
 s_cmp_le_u32 s58, 2
 s_cbranch_scc1 L_kv_flush
 s_cmp_lt_u32 s58, s57
 s_cbranch_scc1 L_kv_loop
L_kv_flush:
 buffer_store_dwordx4 v[72:75], v104, s[36:39], s70 offen offset:2048 sc1
 buffer_store_dwordx4 v[76:79], v104, s[36:39], s70 offen offset:3072 sc1
 buffer_store_dwordx4 v[64:67], v104, s[36:39], s70 offen offset:0 sc1
 buffer_store_dwordx4 v[68:71], v104, s[36:39], s70 offen offset:1024 sc1
 buffer_store_dwordx4 v[80:83], v104, s[36:39], s71 offen sc1
 buffer_store_dwordx4 v[80:83], v104, s[36:39], s72 offen sc1
 s_mov_b32 s70, 268435456
 s_mov_b32 s71, 268435456
 s_mov_b32 s72, 268435456
 s_waitcnt vmcnt(0)
 s_barrier
 s_cmp_lg_u32 s4, 0
 s_cbranch_scc1 L24
 v_mov_b32 v106, s58
 s_mov_b64 exec, 1
 buffer_store_dword v106, v108, s[36:39], s63 offen sc1
 s_mov_b64 exec, -1
L24:
 s_cmp_lt_u32 s58, s57
 s_cbranch_scc1 L_kv_loop
 s_endpgm
L_qo:
 s_mov_b32 s57, s3
L_qo2:
 s_mov_b32 s56, s3
 s_mov_b32 s40, s12
 s_mov_b32 s41, s13
 s_mov_b32 s42, 0x400000
 s_mov_b32 s43, 0x20000
 s_mov_b32 s44, s18
 s_mov_b32 s45, s19
 s_mov_b32 s46, 0x400000
 s_mov_b32 s47, 0x20000
 s_mov_b32 s52, s8
 s_mov_b32 s53, s9
 s_mov_b32 s54, 0x200000
 s_mov_b32 s55, 0x20000
 v_and_b32 v200, 63, v0
 v_lshlrev_b32 v205, 4, v200
 s_lshl_b32 s70, s4, 12
 v_add_u32 v206, s70, v205
 v_mov_b32 v217, 0
 s_lshl_b32 s61, s56, 21
 s_lshl_b32 s70, s5, 15
 s_add_u32 s61, s61, s70
 s_add_u32 s61, s61, 16777216
 v_lshrrev_b32 v218, 4, v200
 v_and_b32 v219, 15, v200
 v_lshlrev_b32 v212, 4, v219
 v_lshl_or_b32 v212, v218, 10, v212
 s_lshl_b32 s70, s4, 8
 v_add_u32 v212, s70, v212
 v_and_b32 v213, 3, v200
 v_lshlrev_b32 v213, 3, v213
 v_bfe_u32 v218, v200, 4, 1
 v_lshl_or_b32 v213, v218, 5, v213
 v_bfe_u32 v218, v200, 2, 2
 v_lshl_or_b32 v213, v218, 6, v213
 v_lshrrev_b32 v218, 5, v200
 v_lshl_or_b32 v213, v218, 8, v213
 v_and_b32 v218, 1, v200
 v_lshlrev_b32 v218, 4, v218
 v_mov_b32 v224, 0x3f80
 v_lshlrev_b32 v218, v218, v224
 v_lshrrev_b32 v219, 1, v219
 s_and_b32 s70, s4, 1
 s_lshl_b32 s70, s70, 2
 v_subrev_u32 v219, s70, v219
 s_bitcmp1_b32 s4, 0
 s_cselect_b32 s90, 0, -1
 s_cselect_b32 s91, -1, 0
 v_cmp_eq_u32 vcc, 0, v219
 s_nop 1
 v_cndmask_b32 v224, 0, v218, vcc
 v_cmp_eq_u32 vcc, 1, v219
 s_nop 1
 v_cndmask_b32 v225, 0, v218, vcc
 v_cmp_eq_u32 vcc, 2, v219
 s_nop 1
 v_cndmask_b32 v226, 0, v218, vcc
 v_cmp_eq_u32 vcc, 3, v219
 s_nop 1
 v_cndmask_b32 v227, 0, v218, vcc
 v_mov_b64 v[228:229], -1
 v_mov_b64 v[230:231], -1
 s_cmp_eq_u32 s56, 3
 s_cbranch_scc1 L_qo_w
 s_add_u32 s62, s61, 0
 buffer_store_dwordx4 v[228:231], v212, s[36:39], s62 offen
 s_add_u32 s70, s62, 4096
 buffer_store_dwordx4 v[228:231], v212, s[36:39], s70 offen
 s_add_u32 s70, s62, 8192
 buffer_store_dwordx4 v[228:231], v212, s[36:39], s70 offen
 s_add_u32 s70, s62, 12288
 buffer_store_dwordx4 v[228:231], v212, s[36:39], s70 offen
 s_add_u32 s70, s62, 16384
 buffer_store_dwordx4 v[228:231], v212, s[36:39], s70 offen
 s_add_u32 s70, s62, 20480
 buffer_store_dwordx4 v[228:231], v212, s[36:39], s70 offen
 s_add_u32 s70, s62, 24576
 buffer_store_dwordx4 v[228:231], v212, s[36:39], s70 offen
 s_add_u32 s70, s62, 28672
 buffer_store_dwordx4 v[228:231], v212, s[36:39], s70 offen
 s_add_u32 s62, s61, 1048576
 buffer_store_dwordx4 v[228:231], v212, s[36:39], s62 offen
 s_add_u32 s70, s62, 4096
 buffer_store_dwordx4 v[228:231], v212, s[36:39], s70 offen
 s_add_u32 s70, s62, 8192
 buffer_store_dwordx4 v[228:231], v212, s[36:39], s70 offen
 s_add_u32 s70, s62, 12288
 buffer_store_dwordx4 v[228:231], v212, s[36:39], s70 offen
 s_add_u32 s70, s62, 16384
 buffer_store_dwordx4 v[228:231], v212, s[36:39], s70 offen
 s_add_u32 s70, s62, 20480
 buffer_store_dwordx4 v[228:231], v212, s[36:39], s70 offen
 s_add_u32 s70, s62, 24576
 buffer_store_dwordx4 v[228:231], v212, s[36:39], s70 offen
 s_add_u32 s70, s62, 28672
 buffer_store_dwordx4 v[228:231], v212, s[36:39], s70 offen
 s_waitcnt vmcnt(0)
 s_barrier
 s_cmp_lg_u32 s4, 0
 s_cbranch_scc1 L25
 v_mov_b32 v218, 192
 v_mov_b32 v219, 1
 s_mov_b64 exec, 1
 global_atomic_add v218, v219, s[32:33] sc1
 s_mov_b64 exec, -1
L25:
 s_cmp_lg_u32 s4, 0
 s_cbranch_scc1 L26
 s_mov_b32 s7, 524288
 v_mov_b32 v218, 64
 s_branch L28
L27:
 s_sleep 4
L28:
 global_load_dword v219, v218, s[32:33] sc1
 s_sub_u32 s7, s7, 1
 s_cbranch_scc1 L_abort
 s_waitcnt vmcnt(0)
 v_readfirstlane_b32 s70, v219
 s_cmp_lt_u32 s70, 64
 s_cbranch_scc1 L27
L26:
 s_barrier
L_qo_w:
 v_lshrrev_b32 v218, 4, v200
 s_lshr_b32 s70, s4, 1
 s_lshl_b32 s70, s70, 2
 v_or_b32 v218, s70, v218
 v_bfe_u32 v219, v200, 1, 3
 v_xor_b32 v218, v218, v219
 v_lshlrev_b32 v218, 5, v218
 v_and_b32 v219, 1, v200
 v_lshl_or_b32 v220, v219, 4, v218
 v_lshrrev_b32 v218, 4, v200
 s_lshl_b32 s70, s4, 2
 v_add_u32 v218, s70, v218
 v_lshl_add_u32 v201, v218, 13, v220
 s_lshl_b32 s60, s5, 8
 s_lshl_b32 s62, s5, 17
 s_and_b32 s70, s4, 1
 s_lshl_b32 s70, s70, 4
 s_lshr_b32 s71, s4, 1
 s_lshl_b32 s71, s71, 2
 s_add_u32 s70, s70, s71
 v_lshrrev_b32 v218, 4, v200
 v_add_u32 v218, s70, v218
 v_lshl_add_u32 v202, v218, 10, v220
 v_lshrrev_b32 v218, 4, v200
 v_bfe_u32 v219, v200, 2, 2
 v_lshl_add_u32 v203, v218, 3, v219
 v_lshlrev_b32 v203, 8, v203
 v_and_b32 v218, 1, v218
 v_lshl_or_b32 v218, v218, 2, v219
 v_lshl_or_b32 v203, v218, 5, v203
 v_and_b32 v218, 3, v200
 v_lshl_or_b32 v203, v218, 3, v203
 s_lshl_b32 s70, s4, 6
 v_xor_b32 v204, s70, v203
 s_lshl_b32 s71, s4, 10
 s_lshl_b32 s71, s4, 10
 s_add_u32 m0, s71, 0
 s_add_u32 s70, s60, 0
 buffer_load_dwordx4 v201, s[40:43], s70 offen  lds
 s_add_u32 m0, s71, 4096
 s_add_u32 s70, s60, 131072
 buffer_load_dwordx4 v201, s[40:43], s70 offen  lds
 s_add_u32 m0, s71, 8192
 s_add_u32 s70, s60, 262144
 buffer_load_dwordx4 v201, s[40:43], s70 offen  lds
 s_add_u32 m0, s71, 12288
 s_add_u32 s70, s60, 393216
 buffer_load_dwordx4 v201, s[40:43], s70 offen  lds
 s_waitcnt vmcnt(0)
 s_barrier
 s_lshl_b32 s71, s4, 10
 s_add_u32 m0, s71, 16384
 s_add_u32 s70, s60, 524288
 buffer_load_dwordx4 v201, s[40:43], s70 offen  lds
 s_add_u32 m0, s71, 20480
 s_add_u32 s70, s60, 655360
 buffer_load_dwordx4 v201, s[40:43], s70 offen  lds
 s_add_u32 m0, s71, 24576
 s_add_u32 s70, s60, 786432
 buffer_load_dwordx4 v201, s[40:43], s70 offen  lds
 s_add_u32 m0, s71, 28672
 s_add_u32 s70, s60, 917504
 buffer_load_dwordx4 v201, s[40:43], s70 offen  lds
 v_add_u32 v218, 0, v204
 v_xor_b32 v219, 32, v218
 ds_read_b64_tr_b16 a[0:1], v218 offset:0
 ds_read_b64_tr_b16 a[2:3], v218 offset:1024
 ds_read_b64_tr_b16 a[4:5], v218 offset:8192
 ds_read_b64_tr_b16 a[6:7], v218 offset:9216
 ds_read_b64_tr_b16 a[64:65], v219 offset:0
 ds_read_b64_tr_b16 a[66:67], v219 offset:1024
 ds_read_b64_tr_b16 a[68:69], v219 offset:8192
 ds_read_b64_tr_b16 a[70:71], v219 offset:9216
 s_waitcnt lgkmcnt(0)
 s_waitcnt vmcnt(0)
 s_barrier
 s_lshl_b32 s71, s4, 10
 s_add_u32 m0, s71, 32768
 s_add_u32 s70, s60, 1048576
 buffer_load_dwordx4 v201, s[40:43], s70 offen  lds
 s_add_u32 m0, s71, 36864
 s_add_u32 s70, s60, 1179648
 buffer_load_dwordx4 v201, s[40:43], s70 offen  lds
 s_add_u32 m0, s71, 40960
 s_add_u32 s70, s60, 1310720
 buffer_load_dwordx4 v201, s[40:43], s70 offen  lds
 s_add_u32 m0, s71, 45056
 s_add_u32 s70, s60, 1441792
 buffer_load_dwordx4 v201, s[40:43], s70 offen  lds
 v_add_u32 v218, 16384, v204
 v_xor_b32 v219, 32, v218
 ds_read_b64_tr_b16 a[8:9], v218 offset:0
 ds_read_b64_tr_b16 a[10:11], v218 offset:1024
 ds_read_b64_tr_b16 a[12:13], v218 offset:8192
 ds_read_b64_tr_b16 a[14:15], v218 offset:9216
 ds_read_b64_tr_b16 a[72:73], v219 offset:0
 ds_read_b64_tr_b16 a[74:75], v219 offset:1024
 ds_read_b64_tr_b16 a[76:77], v219 offset:8192
 ds_read_b64_tr_b16 a[78:79], v219 offset:9216
 s_waitcnt lgkmcnt(0)
 s_waitcnt vmcnt(0)
 s_barrier
 s_lshl_b32 s71, s4, 10
 s_add_u32 m0, s71, 49152
 s_add_u32 s70, s60, 1572864
 buffer_load_dwordx4 v201, s[40:43], s70 offen  lds
 s_add_u32 m0, s71, 53248
 s_add_u32 s70, s60, 1703936
 buffer_load_dwordx4 v201, s[40:43], s70 offen  lds
 s_add_u32 m0, s71, 57344
 s_add_u32 s70, s60, 1835008
 buffer_load_dwordx4 v201, s[40:43], s70 offen  lds
 s_add_u32 m0, s71, 61440
 s_add_u32 s70, s60, 1966080
 buffer_load_dwordx4 v201, s[40:43], s70 offen  lds
 v_add_u32 v218, 32768, v204
 v_xor_b32 v219, 32, v218
 ds_read_b64_tr_b16 a[16:17], v218 offset:0
 ds_read_b64_tr_b16 a[18:19], v218 offset:1024
 ds_read_b64_tr_b16 a[20:21], v218 offset:8192
 ds_read_b64_tr_b16 a[22:23], v218 offset:9216
 ds_read_b64_tr_b16 a[80:81], v219 offset:0
 ds_read_b64_tr_b16 a[82:83], v219 offset:1024
 ds_read_b64_tr_b16 a[84:85], v219 offset:8192
 ds_read_b64_tr_b16 a[86:87], v219 offset:9216
 s_waitcnt lgkmcnt(0)
 s_waitcnt vmcnt(0)
 s_barrier
 s_lshl_b32 s71, s4, 10
 s_add_u32 m0, s71, 65536
 s_add_u32 s70, s60, 2097152
 buffer_load_dwordx4 v201, s[40:43], s70 offen  lds
 s_add_u32 m0, s71, 69632
 s_add_u32 s70, s60, 2228224
 buffer_load_dwordx4 v201, s[40:43], s70 offen  lds
 s_add_u32 m0, s71, 73728
 s_add_u32 s70, s60, 2359296
 buffer_load_dwordx4 v201, s[40:43], s70 offen  lds
 s_add_u32 m0, s71, 77824
 s_add_u32 s70, s60, 2490368
 buffer_load_dwordx4 v201, s[40:43], s70 offen  lds
 v_add_u32 v218, 49152, v204
 v_xor_b32 v219, 32, v218
 ds_read_b64_tr_b16 a[24:25], v218 offset:0
 ds_read_b64_tr_b16 a[26:27], v218 offset:1024
 ds_read_b64_tr_b16 a[28:29], v218 offset:8192
 ds_read_b64_tr_b16 a[30:31], v218 offset:9216
 ds_read_b64_tr_b16 a[88:89], v219 offset:0
 ds_read_b64_tr_b16 a[90:91], v219 offset:1024
 ds_read_b64_tr_b16 a[92:93], v219 offset:8192
 ds_read_b64_tr_b16 a[94:95], v219 offset:9216
 s_waitcnt lgkmcnt(0)
 s_waitcnt vmcnt(0)
 s_barrier
 s_lshl_b32 s71, s4, 10
 s_add_u32 m0, s71, 81920
 s_add_u32 s70, s60, 2621440
 buffer_load_dwordx4 v201, s[40:43], s70 offen  lds
 s_add_u32 m0, s71, 86016
 s_add_u32 s70, s60, 2752512
 buffer_load_dwordx4 v201, s[40:43], s70 offen  lds
 s_add_u32 m0, s71, 90112
 s_add_u32 s70, s60, 2883584
 buffer_load_dwordx4 v201, s[40:43], s70 offen  lds
 s_add_u32 m0, s71, 94208
 s_add_u32 s70, s60, 3014656
 buffer_load_dwordx4 v201, s[40:43], s70 offen  lds
 v_add_u32 v218, 65536, v204
 v_xor_b32 v219, 32, v218
 ds_read_b64_tr_b16 a[32:33], v218 offset:0
 ds_read_b64_tr_b16 a[34:35], v218 offset:1024
 ds_read_b64_tr_b16 a[36:37], v218 offset:8192
 ds_read_b64_tr_b16 a[38:39], v218 offset:9216
 ds_read_b64_tr_b16 a[96:97], v219 offset:0
 ds_read_b64_tr_b16 a[98:99], v219 offset:1024
 ds_read_b64_tr_b16 a[100:101], v219 offset:8192
 ds_read_b64_tr_b16 a[102:103], v219 offset:9216
 s_waitcnt lgkmcnt(0)
 s_waitcnt vmcnt(0)
 s_barrier
 s_lshl_b32 s71, s4, 10
 s_add_u32 m0, s71, 98304
 s_add_u32 s70, s60, 3145728
 buffer_load_dwordx4 v201, s[40:43], s70 offen  lds
 s_add_u32 m0, s71, 102400
 s_add_u32 s70, s60, 3276800
 buffer_load_dwordx4 v201, s[40:43], s70 offen  lds
 s_add_u32 m0, s71, 106496
 s_add_u32 s70, s60, 3407872
 buffer_load_dwordx4 v201, s[40:43], s70 offen  lds
 s_add_u32 m0, s71, 110592
 s_add_u32 s70, s60, 3538944
 buffer_load_dwordx4 v201, s[40:43], s70 offen  lds
 v_add_u32 v218, 81920, v204
 v_xor_b32 v219, 32, v218
 ds_read_b64_tr_b16 a[40:41], v218 offset:0
 ds_read_b64_tr_b16 a[42:43], v218 offset:1024
 ds_read_b64_tr_b16 a[44:45], v218 offset:8192
 ds_read_b64_tr_b16 a[46:47], v218 offset:9216
 ds_read_b64_tr_b16 a[104:105], v219 offset:0
 ds_read_b64_tr_b16 a[106:107], v219 offset:1024
 ds_read_b64_tr_b16 a[108:109], v219 offset:8192
 ds_read_b64_tr_b16 a[110:111], v219 offset:9216
 s_waitcnt lgkmcnt(0)
 s_waitcnt vmcnt(0)
 s_barrier
 s_lshl_b32 s71, s4, 10
 s_add_u32 m0, s71, 114688
 s_add_u32 s70, s60, 3670016
 buffer_load_dwordx4 v201, s[40:43], s70 offen  lds
 s_add_u32 m0, s71, 118784
 s_add_u32 s70, s60, 3801088
 buffer_load_dwordx4 v201, s[40:43], s70 offen  lds
 s_add_u32 m0, s71, 122880
 s_add_u32 s70, s60, 3932160
 buffer_load_dwordx4 v201, s[40:43], s70 offen  lds
 s_add_u32 m0, s71, 126976
 s_add_u32 s70, s60, 4063232
 buffer_load_dwordx4 v201, s[40:43], s70 offen  lds
 v_add_u32 v218, 98304, v204
 v_xor_b32 v219, 32, v218
 ds_read_b64_tr_b16 a[48:49], v218 offset:0
 ds_read_b64_tr_b16 a[50:51], v218 offset:1024
 ds_read_b64_tr_b16 a[52:53], v218 offset:8192
 ds_read_b64_tr_b16 a[54:55], v218 offset:9216
 ds_read_b64_tr_b16 a[112:113], v219 offset:0
 ds_read_b64_tr_b16 a[114:115], v219 offset:1024
 ds_read_b64_tr_b16 a[116:117], v219 offset:8192
 ds_read_b64_tr_b16 a[118:119], v219 offset:9216
 s_waitcnt lgkmcnt(0)
 s_waitcnt vmcnt(0)
 s_barrier
 s_lshl_b32 s71, s4, 10
 s_add_u32 m0, s71, 131072
 s_add_u32 s70, s62, 0
 buffer_load_dwordx4 v202, s[44:47], s70 offen  lds
 s_add_u32 m0, s71, 135168
 s_add_u32 s70, s62, 8192
 buffer_load_dwordx4 v202, s[44:47], s70 offen  lds
 s_add_u32 m0, s71, 139264
 s_add_u32 s70, s62, 32768
 buffer_load_dwordx4 v202, s[44:47], s70 offen  lds
 s_add_u32 m0, s71, 143360
 s_add_u32 s70, s62, 40960
 buffer_load_dwordx4 v202, s[44:47], s70 offen  lds
 v_add_u32 v218, 114688, v204
 v_xor_b32 v219, 32, v218
 ds_read_b64_tr_b16 a[56:57], v218 offset:0
 ds_read_b64_tr_b16 a[58:59], v218 offset:1024
 ds_read_b64_tr_b16 a[60:61], v218 offset:8192
 ds_read_b64_tr_b16 a[62:63], v218 offset:9216
 ds_read_b64_tr_b16 a[120:121], v219 offset:0
 ds_read_b64_tr_b16 a[122:123], v219 offset:1024
 ds_read_b64_tr_b16 a[124:125], v219 offset:8192
 ds_read_b64_tr_b16 a[126:127], v219 offset:9216
 s_waitcnt lgkmcnt(0)
 s_waitcnt vmcnt(0)
 s_barrier
 s_lshl_b32 s71, s4, 10
 s_add_u32 m0, s71, 147456
 s_add_u32 s70, s62, 256
 buffer_load_dwordx4 v202, s[44:47], s70 offen  lds
 s_add_u32 m0, s71, 151552
 s_add_u32 s70, s62, 8448
 buffer_load_dwordx4 v202, s[44:47], s70 offen  lds
 s_add_u32 m0, s71, 155648
 s_add_u32 s70, s62, 33024
 buffer_load_dwordx4 v202, s[44:47], s70 offen  lds
 s_add_u32 m0, s71, 159744
 s_add_u32 s70, s62, 41216
 buffer_load_dwordx4 v202, s[44:47], s70 offen  lds
 s_cmp_lg_u32 s4, 0
 s_cbranch_scc1 L29
 v_add_u32 v218, 131072, v203
 v_xor_b32 v219, 0, v218
 ds_read_b64_tr_b16 a[128:129], v219 offset:0
 ds_read_b64_tr_b16 a[130:131], v219 offset:1024
 ds_read_b64_tr_b16 a[132:133], v219 offset:8192
 ds_read_b64_tr_b16 a[134:135], v219 offset:9216
 v_xor_b32 v219, 32, v218
 ds_read_b64_tr_b16 a[144:145], v219 offset:0
 ds_read_b64_tr_b16 a[146:147], v219 offset:1024
 ds_read_b64_tr_b16 a[148:149], v219 offset:8192
 ds_read_b64_tr_b16 a[150:151], v219 offset:9216
 v_xor_b32 v219, 64, v218
 ds_read_b64_tr_b16 a[160:161], v219 offset:0
 ds_read_b64_tr_b16 a[162:163], v219 offset:1024
 ds_read_b64_tr_b16 a[164:165], v219 offset:8192
 ds_read_b64_tr_b16 a[166:167], v219 offset:9216
 v_xor_b32 v219, 96, v218
 ds_read_b64_tr_b16 a[176:177], v219 offset:0
 ds_read_b64_tr_b16 a[178:179], v219 offset:1024
 ds_read_b64_tr_b16 a[180:181], v219 offset:8192
 ds_read_b64_tr_b16 a[182:183], v219 offset:9216
 v_xor_b32 v219, 128, v218
 ds_read_b64_tr_b16 a[192:193], v219 offset:0
 ds_read_b64_tr_b16 a[194:195], v219 offset:1024
 ds_read_b64_tr_b16 a[196:197], v219 offset:8192
 ds_read_b64_tr_b16 a[198:199], v219 offset:9216
 v_xor_b32 v219, 160, v218
 ds_read_b64_tr_b16 a[208:209], v219 offset:0
 ds_read_b64_tr_b16 a[210:211], v219 offset:1024
 ds_read_b64_tr_b16 a[212:213], v219 offset:8192
 ds_read_b64_tr_b16 a[214:215], v219 offset:9216
 v_xor_b32 v219, 192, v218
 ds_read_b64_tr_b16 a[224:225], v219 offset:0
 ds_read_b64_tr_b16 a[226:227], v219 offset:1024
 ds_read_b64_tr_b16 a[228:229], v219 offset:8192
 ds_read_b64_tr_b16 a[230:231], v219 offset:9216
 v_xor_b32 v219, 224, v218
 ds_read_b64_tr_b16 a[240:241], v219 offset:0
 ds_read_b64_tr_b16 a[242:243], v219 offset:1024
 ds_read_b64_tr_b16 a[244:245], v219 offset:8192
 ds_read_b64_tr_b16 a[246:247], v219 offset:9216
L29:
 s_waitcnt lgkmcnt(0)
 s_waitcnt vmcnt(0)
 s_barrier
 s_lshl_b32 s71, s4, 10
 s_add_u32 m0, s71, 0
 s_add_u32 s70, s62, 512
 buffer_load_dwordx4 v202, s[44:47], s70 offen  lds
 s_add_u32 m0, s71, 4096
 s_add_u32 s70, s62, 8704
 buffer_load_dwordx4 v202, s[44:47], s70 offen  lds
 s_add_u32 m0, s71, 8192
 s_add_u32 s70, s62, 33280
 buffer_load_dwordx4 v202, s[44:47], s70 offen  lds
 s_add_u32 m0, s71, 12288
 s_add_u32 s70, s62, 41472
 buffer_load_dwordx4 v202, s[44:47], s70 offen  lds
 s_cmp_lg_u32 s4, 1
 s_cbranch_scc1 L30
 v_add_u32 v218, 147456, v203
 v_xor_b32 v219, 0, v218
 ds_read_b64_tr_b16 a[128:129], v219 offset:0
 ds_read_b64_tr_b16 a[130:131], v219 offset:1024
 ds_read_b64_tr_b16 a[132:133], v219 offset:8192
 ds_read_b64_tr_b16 a[134:135], v219 offset:9216
 v_xor_b32 v219, 32, v218
 ds_read_b64_tr_b16 a[144:145], v219 offset:0
 ds_read_b64_tr_b16 a[146:147], v219 offset:1024
 ds_read_b64_tr_b16 a[148:149], v219 offset:8192
 ds_read_b64_tr_b16 a[150:151], v219 offset:9216
 v_xor_b32 v219, 64, v218
 ds_read_b64_tr_b16 a[160:161], v219 offset:0
 ds_read_b64_tr_b16 a[162:163], v219 offset:1024
 ds_read_b64_tr_b16 a[164:165], v219 offset:8192
 ds_read_b64_tr_b16 a[166:167], v219 offset:9216
 v_xor_b32 v219, 96, v218
 ds_read_b64_tr_b16 a[176:177], v219 offset:0
 ds_read_b64_tr_b16 a[178:179], v219 offset:1024
 ds_read_b64_tr_b16 a[180:181], v219 offset:8192
 ds_read_b64_tr_b16 a[182:183], v219 offset:9216
 v_xor_b32 v219, 128, v218
 ds_read_b64_tr_b16 a[192:193], v219 offset:0
 ds_read_b64_tr_b16 a[194:195], v219 offset:1024
 ds_read_b64_tr_b16 a[196:197], v219 offset:8192
 ds_read_b64_tr_b16 a[198:199], v219 offset:9216
 v_xor_b32 v219, 160, v218
 ds_read_b64_tr_b16 a[208:209], v219 offset:0
 ds_read_b64_tr_b16 a[210:211], v219 offset:1024
 ds_read_b64_tr_b16 a[212:213], v219 offset:8192
 ds_read_b64_tr_b16 a[214:215], v219 offset:9216
 v_xor_b32 v219, 192, v218
 ds_read_b64_tr_b16 a[224:225], v219 offset:0
 ds_read_b64_tr_b16 a[226:227], v219 offset:1024
 ds_read_b64_tr_b16 a[228:229], v219 offset:8192
 ds_read_b64_tr_b16 a[230:231], v219 offset:9216
 v_xor_b32 v219, 224, v218
 ds_read_b64_tr_b16 a[240:241], v219 offset:0
 ds_read_b64_tr_b16 a[242:243], v219 offset:1024
 ds_read_b64_tr_b16 a[244:245], v219 offset:8192
 ds_read_b64_tr_b16 a[246:247], v219 offset:9216
L30:
 s_waitcnt lgkmcnt(0)
 s_waitcnt vmcnt(0)
 s_barrier
 s_lshl_b32 s71, s4, 10
 s_add_u32 m0, s71, 16384
 s_add_u32 s70, s62, 768
 buffer_load_dwordx4 v202, s[44:47], s70 offen  lds
 s_add_u32 m0, s71, 20480
 s_add_u32 s70, s62, 8960
 buffer_load_dwordx4 v202, s[44:47], s70 offen  lds
 s_add_u32 m0, s71, 24576
 s_add_u32 s70, s62, 33536
 buffer_load_dwordx4 v202, s[44:47], s70 offen  lds
 s_add_u32 m0, s71, 28672
 s_add_u32 s70, s62, 41728
 buffer_load_dwordx4 v202, s[44:47], s70 offen  lds
 s_cmp_lg_u32 s4, 2
 s_cbranch_scc1 L31
 v_add_u32 v218, 0, v203
 v_xor_b32 v219, 0, v218
 ds_read_b64_tr_b16 a[128:129], v219 offset:0
 ds_read_b64_tr_b16 a[130:131], v219 offset:1024
 ds_read_b64_tr_b16 a[132:133], v219 offset:8192
 ds_read_b64_tr_b16 a[134:135], v219 offset:9216
 v_xor_b32 v219, 32, v218
 ds_read_b64_tr_b16 a[144:145], v219 offset:0
 ds_read_b64_tr_b16 a[146:147], v219 offset:1024
 ds_read_b64_tr_b16 a[148:149], v219 offset:8192
 ds_read_b64_tr_b16 a[150:151], v219 offset:9216
 v_xor_b32 v219, 64, v218
 ds_read_b64_tr_b16 a[160:161], v219 offset:0
 ds_read_b64_tr_b16 a[162:163], v219 offset:1024
 ds_read_b64_tr_b16 a[164:165], v219 offset:8192
 ds_read_b64_tr_b16 a[166:167], v219 offset:9216
 v_xor_b32 v219, 96, v218
 ds_read_b64_tr_b16 a[176:177], v219 offset:0
 ds_read_b64_tr_b16 a[178:179], v219 offset:1024
 ds_read_b64_tr_b16 a[180:181], v219 offset:8192
 ds_read_b64_tr_b16 a[182:183], v219 offset:9216
 v_xor_b32 v219, 128, v218
 ds_read_b64_tr_b16 a[192:193], v219 offset:0
 ds_read_b64_tr_b16 a[194:195], v219 offset:1024
 ds_read_b64_tr_b16 a[196:197], v219 offset:8192
 ds_read_b64_tr_b16 a[198:199], v219 offset:9216
 v_xor_b32 v219, 160, v218
 ds_read_b64_tr_b16 a[208:209], v219 offset:0
 ds_read_b64_tr_b16 a[210:211], v219 offset:1024
 ds_read_b64_tr_b16 a[212:213], v219 offset:8192
 ds_read_b64_tr_b16 a[214:215], v219 offset:9216
 v_xor_b32 v219, 192, v218
 ds_read_b64_tr_b16 a[224:225], v219 offset:0
 ds_read_b64_tr_b16 a[226:227], v219 offset:1024
 ds_read_b64_tr_b16 a[228:229], v219 offset:8192
 ds_read_b64_tr_b16 a[230:231], v219 offset:9216
 v_xor_b32 v219, 224, v218
 ds_read_b64_tr_b16 a[240:241], v219 offset:0
 ds_read_b64_tr_b16 a[242:243], v219 offset:1024
 ds_read_b64_tr_b16 a[244:245], v219 offset:8192
 ds_read_b64_tr_b16 a[246:247], v219 offset:9216
L31:
 s_waitcnt lgkmcnt(0)
 s_waitcnt vmcnt(0)
 s_barrier
 s_lshl_b32 s71, s4, 10
 s_add_u32 m0, s71, 32768
 s_add_u32 s70, s62, 65536
 buffer_load_dwordx4 v202, s[44:47], s70 offen  lds
 s_add_u32 m0, s71, 36864
 s_add_u32 s70, s62, 73728
 buffer_load_dwordx4 v202, s[44:47], s70 offen  lds
 s_add_u32 m0, s71, 40960
 s_add_u32 s70, s62, 98304
 buffer_load_dwordx4 v202, s[44:47], s70 offen  lds
 s_add_u32 m0, s71, 45056
 s_add_u32 s70, s62, 106496
 buffer_load_dwordx4 v202, s[44:47], s70 offen  lds
 s_cmp_lg_u32 s4, 3
 s_cbranch_scc1 L32
 v_add_u32 v218, 16384, v203
 v_xor_b32 v219, 0, v218
 ds_read_b64_tr_b16 a[128:129], v219 offset:0
 ds_read_b64_tr_b16 a[130:131], v219 offset:1024
 ds_read_b64_tr_b16 a[132:133], v219 offset:8192
 ds_read_b64_tr_b16 a[134:135], v219 offset:9216
 v_xor_b32 v219, 32, v218
 ds_read_b64_tr_b16 a[144:145], v219 offset:0
 ds_read_b64_tr_b16 a[146:147], v219 offset:1024
 ds_read_b64_tr_b16 a[148:149], v219 offset:8192
 ds_read_b64_tr_b16 a[150:151], v219 offset:9216
 v_xor_b32 v219, 64, v218
 ds_read_b64_tr_b16 a[160:161], v219 offset:0
 ds_read_b64_tr_b16 a[162:163], v219 offset:1024
 ds_read_b64_tr_b16 a[164:165], v219 offset:8192
 ds_read_b64_tr_b16 a[166:167], v219 offset:9216
 v_xor_b32 v219, 96, v218
 ds_read_b64_tr_b16 a[176:177], v219 offset:0
 ds_read_b64_tr_b16 a[178:179], v219 offset:1024
 ds_read_b64_tr_b16 a[180:181], v219 offset:8192
 ds_read_b64_tr_b16 a[182:183], v219 offset:9216
 v_xor_b32 v219, 128, v218
 ds_read_b64_tr_b16 a[192:193], v219 offset:0
 ds_read_b64_tr_b16 a[194:195], v219 offset:1024
 ds_read_b64_tr_b16 a[196:197], v219 offset:8192
 ds_read_b64_tr_b16 a[198:199], v219 offset:9216
 v_xor_b32 v219, 160, v218
 ds_read_b64_tr_b16 a[208:209], v219 offset:0
 ds_read_b64_tr_b16 a[210:211], v219 offset:1024
 ds_read_b64_tr_b16 a[212:213], v219 offset:8192
 ds_read_b64_tr_b16 a[214:215], v219 offset:9216
 v_xor_b32 v219, 192, v218
 ds_read_b64_tr_b16 a[224:225], v219 offset:0
 ds_read_b64_tr_b16 a[226:227], v219 offset:1024
 ds_read_b64_tr_b16 a[228:229], v219 offset:8192
 ds_read_b64_tr_b16 a[230:231], v219 offset:9216
 v_xor_b32 v219, 224, v218
 ds_read_b64_tr_b16 a[240:241], v219 offset:0
 ds_read_b64_tr_b16 a[242:243], v219 offset:1024
 ds_read_b64_tr_b16 a[244:245], v219 offset:8192
 ds_read_b64_tr_b16 a[246:247], v219 offset:9216
L32:
 s_waitcnt lgkmcnt(0)
 s_waitcnt vmcnt(0)
 s_barrier
 s_lshl_b32 s71, s4, 10
 s_add_u32 m0, s71, 49152
 s_add_u32 s70, s62, 65792
 buffer_load_dwordx4 v202, s[44:47], s70 offen  lds
 s_add_u32 m0, s71, 53248
 s_add_u32 s70, s62, 73984
 buffer_load_dwordx4 v202, s[44:47], s70 offen  lds
 s_add_u32 m0, s71, 57344
 s_add_u32 s70, s62, 98560
 buffer_load_dwordx4 v202, s[44:47], s70 offen  lds
 s_add_u32 m0, s71, 61440
 s_add_u32 s70, s62, 106752
 buffer_load_dwordx4 v202, s[44:47], s70 offen  lds
 s_cmp_lg_u32 s4, 0
 s_cbranch_scc1 L33
 v_add_u32 v218, 32768, v203
 v_xor_b32 v219, 0, v218
 ds_read_b64_tr_b16 a[136:137], v219 offset:0
 ds_read_b64_tr_b16 a[138:139], v219 offset:1024
 ds_read_b64_tr_b16 a[140:141], v219 offset:8192
 ds_read_b64_tr_b16 a[142:143], v219 offset:9216
 v_xor_b32 v219, 32, v218
 ds_read_b64_tr_b16 a[152:153], v219 offset:0
 ds_read_b64_tr_b16 a[154:155], v219 offset:1024
 ds_read_b64_tr_b16 a[156:157], v219 offset:8192
 ds_read_b64_tr_b16 a[158:159], v219 offset:9216
 v_xor_b32 v219, 64, v218
 ds_read_b64_tr_b16 a[168:169], v219 offset:0
 ds_read_b64_tr_b16 a[170:171], v219 offset:1024
 ds_read_b64_tr_b16 a[172:173], v219 offset:8192
 ds_read_b64_tr_b16 a[174:175], v219 offset:9216
 v_xor_b32 v219, 96, v218
 ds_read_b64_tr_b16 a[184:185], v219 offset:0
 ds_read_b64_tr_b16 a[186:187], v219 offset:1024
 ds_read_b64_tr_b16 a[188:189], v219 offset:8192
 ds_read_b64_tr_b16 a[190:191], v219 offset:9216
 v_xor_b32 v219, 128, v218
 ds_read_b64_tr_b16 a[200:201], v219 offset:0
 ds_read_b64_tr_b16 a[202:203], v219 offset:1024
 ds_read_b64_tr_b16 a[204:205], v219 offset:8192
 ds_read_b64_tr_b16 a[206:207], v219 offset:9216
 v_xor_b32 v219, 160, v218
 ds_read_b64_tr_b16 a[216:217], v219 offset:0
 ds_read_b64_tr_b16 a[218:219], v219 offset:1024
 ds_read_b64_tr_b16 a[220:221], v219 offset:8192
 ds_read_b64_tr_b16 a[222:223], v219 offset:9216
 v_xor_b32 v219, 192, v218
 ds_read_b64_tr_b16 a[232:233], v219 offset:0
 ds_read_b64_tr_b16 a[234:235], v219 offset:1024
 ds_read_b64_tr_b16 a[236:237], v219 offset:8192
 ds_read_b64_tr_b16 a[238:239], v219 offset:9216
 v_xor_b32 v219, 224, v218
 ds_read_b64_tr_b16 a[248:249], v219 offset:0
 ds_read_b64_tr_b16 a[250:251], v219 offset:1024
 ds_read_b64_tr_b16 a[252:253], v219 offset:8192
 ds_read_b64_tr_b16 a[254:255], v219 offset:9216
L33:
 s_waitcnt lgkmcnt(0)
 s_waitcnt vmcnt(0)
 s_barrier
 s_lshl_b32 s71, s4, 10
 s_add_u32 m0, s71, 65536
 s_add_u32 s70, s62, 66048
 buffer_load_dwordx4 v202, s[44:47], s70 offen  lds
 s_add_u32 m0, s71, 69632
 s_add_u32 s70, s62, 74240
 buffer_load_dwordx4 v202, s[44:47], s70 offen  lds
 s_add_u32 m0, s71, 73728
 s_add_u32 s70, s62, 98816
 buffer_load_dwordx4 v202, s[44:47], s70 offen  lds
 s_add_u32 m0, s71, 77824
 s_add_u32 s70, s62, 107008
 buffer_load_dwordx4 v202, s[44:47], s70 offen  lds
 s_cmp_lg_u32 s4, 1
 s_cbranch_scc1 L34
 v_add_u32 v218, 49152, v203
 v_xor_b32 v219, 0, v218
 ds_read_b64_tr_b16 a[136:137], v219 offset:0
 ds_read_b64_tr_b16 a[138:139], v219 offset:1024
 ds_read_b64_tr_b16 a[140:141], v219 offset:8192
 ds_read_b64_tr_b16 a[142:143], v219 offset:9216
 v_xor_b32 v219, 32, v218
 ds_read_b64_tr_b16 a[152:153], v219 offset:0
 ds_read_b64_tr_b16 a[154:155], v219 offset:1024
 ds_read_b64_tr_b16 a[156:157], v219 offset:8192
 ds_read_b64_tr_b16 a[158:159], v219 offset:9216
 v_xor_b32 v219, 64, v218
 ds_read_b64_tr_b16 a[168:169], v219 offset:0
 ds_read_b64_tr_b16 a[170:171], v219 offset:1024
 ds_read_b64_tr_b16 a[172:173], v219 offset:8192
 ds_read_b64_tr_b16 a[174:175], v219 offset:9216
 v_xor_b32 v219, 96, v218
 ds_read_b64_tr_b16 a[184:185], v219 offset:0
 ds_read_b64_tr_b16 a[186:187], v219 offset:1024
 ds_read_b64_tr_b16 a[188:189], v219 offset:8192
 ds_read_b64_tr_b16 a[190:191], v219 offset:9216
 v_xor_b32 v219, 128, v218
 ds_read_b64_tr_b16 a[200:201], v219 offset:0
 ds_read_b64_tr_b16 a[202:203], v219 offset:1024
 ds_read_b64_tr_b16 a[204:205], v219 offset:8192
 ds_read_b64_tr_b16 a[206:207], v219 offset:9216
 v_xor_b32 v219, 160, v218
 ds_read_b64_tr_b16 a[216:217], v219 offset:0
 ds_read_b64_tr_b16 a[218:219], v219 offset:1024
 ds_read_b64_tr_b16 a[220:221], v219 offset:8192
 ds_read_b64_tr_b16 a[222:223], v219 offset:9216
 v_xor_b32 v219, 192, v218
 ds_read_b64_tr_b16 a[232:233], v219 offset:0
 ds_read_b64_tr_b16 a[234:235], v219 offset:1024
 ds_read_b64_tr_b16 a[236:237], v219 offset:8192
 ds_read_b64_tr_b16 a[238:239], v219 offset:9216
 v_xor_b32 v219, 224, v218
 ds_read_b64_tr_b16 a[248:249], v219 offset:0
 ds_read_b64_tr_b16 a[250:251], v219 offset:1024
 ds_read_b64_tr_b16 a[252:253], v219 offset:8192
 ds_read_b64_tr_b16 a[254:255], v219 offset:9216
L34:
 s_waitcnt lgkmcnt(0)
 s_waitcnt vmcnt(0)
 s_barrier
 s_lshl_b32 s71, s4, 10
 s_add_u32 m0, s71, 81920
 s_add_u32 s70, s62, 66304
 buffer_load_dwordx4 v202, s[44:47], s70 offen  lds
 s_add_u32 m0, s71, 86016
 s_add_u32 s70, s62, 74496
 buffer_load_dwordx4 v202, s[44:47], s70 offen  lds
 s_add_u32 m0, s71, 90112
 s_add_u32 s70, s62, 99072
 buffer_load_dwordx4 v202, s[44:47], s70 offen  lds
 s_add_u32 m0, s71, 94208
 s_add_u32 s70, s62, 107264
 buffer_load_dwordx4 v202, s[44:47], s70 offen  lds
 s_cmp_lg_u32 s4, 2
 s_cbranch_scc1 L35
 v_add_u32 v218, 65536, v203
 v_xor_b32 v219, 0, v218
 ds_read_b64_tr_b16 a[136:137], v219 offset:0
 ds_read_b64_tr_b16 a[138:139], v219 offset:1024
 ds_read_b64_tr_b16 a[140:141], v219 offset:8192
 ds_read_b64_tr_b16 a[142:143], v219 offset:9216
 v_xor_b32 v219, 32, v218
 ds_read_b64_tr_b16 a[152:153], v219 offset:0
 ds_read_b64_tr_b16 a[154:155], v219 offset:1024
 ds_read_b64_tr_b16 a[156:157], v219 offset:8192
 ds_read_b64_tr_b16 a[158:159], v219 offset:9216
 v_xor_b32 v219, 64, v218
 ds_read_b64_tr_b16 a[168:169], v219 offset:0
 ds_read_b64_tr_b16 a[170:171], v219 offset:1024
 ds_read_b64_tr_b16 a[172:173], v219 offset:8192
 ds_read_b64_tr_b16 a[174:175], v219 offset:9216
 v_xor_b32 v219, 96, v218
 ds_read_b64_tr_b16 a[184:185], v219 offset:0
 ds_read_b64_tr_b16 a[186:187], v219 offset:1024
 ds_read_b64_tr_b16 a[188:189], v219 offset:8192
 ds_read_b64_tr_b16 a[190:191], v219 offset:9216
 v_xor_b32 v219, 128, v218
 ds_read_b64_tr_b16 a[200:201], v219 offset:0
 ds_read_b64_tr_b16 a[202:203], v219 offset:1024
 ds_read_b64_tr_b16 a[204:205], v219 offset:8192
 ds_read_b64_tr_b16 a[206:207], v219 offset:9216
 v_xor_b32 v219, 160, v218
 ds_read_b64_tr_b16 a[216:217], v219 offset:0
 ds_read_b64_tr_b16 a[218:219], v219 offset:1024
 ds_read_b64_tr_b16 a[220:221], v219 offset:8192
 ds_read_b64_tr_b16 a[222:223], v219 offset:9216
 v_xor_b32 v219, 192, v218
 ds_read_b64_tr_b16 a[232:233], v219 offset:0
 ds_read_b64_tr_b16 a[234:235], v219 offset:1024
 ds_read_b64_tr_b16 a[236:237], v219 offset:8192
 ds_read_b64_tr_b16 a[238:239], v219 offset:9216
 v_xor_b32 v219, 224, v218
 ds_read_b64_tr_b16 a[248:249], v219 offset:0
 ds_read_b64_tr_b16 a[250:251], v219 offset:1024
 ds_read_b64_tr_b16 a[252:253], v219 offset:8192
 ds_read_b64_tr_b16 a[254:255], v219 offset:9216
L35:
 s_waitcnt lgkmcnt(0)
 s_waitcnt vmcnt(0)
 s_barrier
 s_cmp_lg_u32 s4, 3
 s_cbranch_scc1 L36
 v_add_u32 v218, 81920, v203
 v_xor_b32 v219, 0, v218
 ds_read_b64_tr_b16 a[136:137], v219 offset:0
 ds_read_b64_tr_b16 a[138:139], v219 offset:1024
 ds_read_b64_tr_b16 a[140:141], v219 offset:8192
 ds_read_b64_tr_b16 a[142:143], v219 offset:9216
 v_xor_b32 v219, 32, v218
 ds_read_b64_tr_b16 a[152:153], v219 offset:0
 ds_read_b64_tr_b16 a[154:155], v219 offset:1024
 ds_read_b64_tr_b16 a[156:157], v219 offset:8192
 ds_read_b64_tr_b16 a[158:159], v219 offset:9216
 v_xor_b32 v219, 64, v218
 ds_read_b64_tr_b16 a[168:169], v219 offset:0
 ds_read_b64_tr_b16 a[170:171], v219 offset:1024
 ds_read_b64_tr_b16 a[172:173], v219 offset:8192
 ds_read_b64_tr_b16 a[174:175], v219 offset:9216
 v_xor_b32 v219, 96, v218
 ds_read_b64_tr_b16 a[184:185], v219 offset:0
 ds_read_b64_tr_b16 a[186:187], v219 offset:1024
 ds_read_b64_tr_b16 a[188:189], v219 offset:8192
 ds_read_b64_tr_b16 a[190:191], v219 offset:9216
 v_xor_b32 v219, 128, v218
 ds_read_b64_tr_b16 a[200:201], v219 offset:0
 ds_read_b64_tr_b16 a[202:203], v219 offset:1024
 ds_read_b64_tr_b16 a[204:205], v219 offset:8192
 ds_read_b64_tr_b16 a[206:207], v219 offset:9216
 v_xor_b32 v219, 160, v218
 ds_read_b64_tr_b16 a[216:217], v219 offset:0
 ds_read_b64_tr_b16 a[218:219], v219 offset:1024
 ds_read_b64_tr_b16 a[220:221], v219 offset:8192
 ds_read_b64_tr_b16 a[222:223], v219 offset:9216
 v_xor_b32 v219, 192, v218
 ds_read_b64_tr_b16 a[232:233], v219 offset:0
 ds_read_b64_tr_b16 a[234:235], v219 offset:1024
 ds_read_b64_tr_b16 a[236:237], v219 offset:8192
 ds_read_b64_tr_b16 a[238:239], v219 offset:9216
 v_xor_b32 v219, 224, v218
 ds_read_b64_tr_b16 a[248:249], v219 offset:0
 ds_read_b64_tr_b16 a[250:251], v219 offset:1024
 ds_read_b64_tr_b16 a[252:253], v219 offset:8192
 ds_read_b64_tr_b16 a[254:255], v219 offset:9216
L36:
 s_waitcnt lgkmcnt(0)
 v_and_b32 v218, 15, v200
 v_lshrrev_b32 v219, 4, v200
 v_and_b32 v214, 31, v200
 v_lshlrev_b32 v214, 2, v214
 s_lshl_b32 s70, s4, 9
 v_lshlrev_b32 v220, 2, v218
 v_lshl_or_b32 v220, v219, 7, v220
 v_add_u32 v220, s70, v220
 v_add_u32 v207, 106496, v220
 v_lshl_add_u32 v208, v200, 3, s70
 v_add_u32 v208, 108544, v208
 v_lshrrev_b32 v220, 2, v218
 v_lshlrev_b32 v220, 7, v220
 v_and_b32 v209, 1, v218
 v_lshl_or_b32 v220, v209, 6, v220
 v_lshl_or_b32 v220, v219, 4, v220
 v_add_u32 v209, 106496, v220
 s_lshr_b32 s71, s4, 1
 s_lshl_b32 s70, s71, 10
 s_add_u32 s70, s70, 108544
 v_lshl_add_u32 v210, v200, 3, s70
 s_lshl_b32 s70, s71, 13
 s_add_u32 s70, s70, 32768
 v_add_u32 v216, s70, v205
 s_and_b32 s71, s4, 1
 s_lshl_b32 s70, s71, 12
 v_add_u32 v249, s70, v205
 v_add_u32 v215, 98304, v249
 s_lshr_b32 s70, s4, 1
 s_lshl_b32 s70, s70, 11
 v_add_u32 v249, s70, v249
 s_lshl_b32 s70, s4, 10
 s_add_u32 s70, s70, 98304
 v_add_u32 v251, s70, v205
 v_add_u32 v252, 110592, v205
 s_lshl_b32 s70, s4, 8
 v_lshlrev_b32 v220, 4, v219
 v_lshl_or_b32 v220, v218, 15, v220
 v_add_u32 v211, s70, v220
 s_lshl_b32 s71, s71, 4
 v_add_u32 v218, s71, v218
 v_lshlrev_b32 v219, 2, v219
 v_sub_u32 v218, v218, v219
 s_mov_b32 s68, 0x3e0293ee
 v_mov_b32 v237, 0
 v_mov_b32 v238, 0
 v_cmp_le_i32 s[74:75], 0, v218
 v_cmp_le_i32 s[76:77], 1, v218
 v_cmp_le_i32 s[78:79], 2, v218
 v_cmp_le_i32 s[80:81], 3, v218
 v_cmp_le_i32 s[82:83], 16, v218
 v_cmp_le_i32 s[84:85], 17, v218
 v_cmp_le_i32 s[86:87], 18, v218
 v_cmp_le_i32 s[88:89], 19, v218
 v_mov_b32 v232, 0x3f803f80
 v_mov_b32 v233, 0x3f803f80
 v_mov_b32 v234, 0x3f803f80
 v_mov_b32 v235, 0x3f803f80
 s_cmp_lg_u32 s4, 0
 s_cbranch_scc1 L37
 s_mov_b32 s7, 524288
 v_mov_b32 v218, 192
 s_branch L39
L38:
 s_sleep 4
L39:
 global_load_dword v219, v218, s[32:33] sc1
 s_sub_u32 s7, s7, 1
 s_cbranch_scc1 L_abort
 s_waitcnt vmcnt(0)
 v_readfirstlane_b32 s70, v219
 s_cmp_lt_u32 s70, 256
 s_cbranch_scc1 L38
L37:
 s_barrier
 s_mov_b32 s58, 0
 s_mov_b32 s59, s57
 s_mov_b32 s92, 0
 s_mov_b32 s94, 268435456
 v_mov_b32 v253, 0
 s_and_b32 s67, s59, 1
 s_lshl_b32 s67, s67, 5
 s_add_u32 s67, s67, s5
 s_lshr_b32 s66, s59, 1
 s_lshl_b32 s67, s67, 7
 s_add_u32 s67, s67, 15794176
 s_mov_b32 s7, 524288
L40:
 v_readfirstlane_b32 s70, v253
 s_cmp_gt_u32 s70, s66
 s_cbranch_scc1 L41
 buffer_load_dword v253, v217, s[36:39], s67 offen sc1
 s_sub_u32 s7, s7, 1
 s_cbranch_scc1 L_abort
 s_waitcnt vmcnt(0)
 s_branch L40
L41:
 s_lshl_b32 s70, s59, 15
 s_lshl_b32 s71, s4, 13
 s_add_u32 s70, s70, s71
 s_add_u32 m0, s71, s92
 s_add_u32 s70, s70, 0
 buffer_load_dwordx4 v205, s[36:39], s70 offen offset:0 sc1 lds
 buffer_load_dwordx4 v205, s[36:39], s70 offen offset:1024 sc1 lds
 buffer_load_dwordx4 v205, s[36:39], s70 offen offset:2048 sc1 lds
 buffer_load_dwordx4 v205, s[36:39], s70 offen offset:3072 sc1 lds
 s_add_u32 s70, s70, 4096
 s_add_u32 m0, m0, 4096
 s_nop 0
 buffer_load_dwordx4 v205, s[36:39], s70 offen offset:0 sc1 lds
 buffer_load_dwordx4 v205, s[36:39], s70 offen offset:1024 sc1 lds
 buffer_load_dwordx4 v205, s[36:39], s70 offen offset:2048 sc1 lds
 buffer_load_dwordx4 v205, s[36:39], s70 offen offset:3072 sc1 lds
 s_lshl_b32 s70, s59, 5
 s_add_u32 s70, s70, s5
 s_lshl_b32 s70, s70, 14
 s_add_u32 s70, s70, 33554432
 s_lshl_b32 s71, s4, 12
 s_add_u32 s71, s71, s92
 s_add_u32 m0, s71, 32768
 s_nop 0
 buffer_load_dwordx4 v206, s[36:39], s70 offen offset:0 sc1 lds
 buffer_load_dwordx4 v206, s[36:39], s70 offen offset:1024 sc1 lds
 buffer_load_dwordx4 v206, s[36:39], s70 offen offset:2048 sc1 lds
 buffer_load_dwordx4 v206, s[36:39], s70 offen offset:3072 sc1 lds
 s_waitcnt vmcnt(0)
 s_barrier
L_qo_loop:
 v_add_u32 v248, s92, v205
 v_add_u32 v250, s92, v216
 s_cmp_ge_u32 s59, 99
 s_addc_u32 s93, s59, 3
 s_and_b32 s67, s93, 1
 s_lshl_b32 s67, s67, 5
 s_add_u32 s67, s67, s5
 s_lshr_b32 s66, s93, 1
 s_lshl_b32 s67, s67, 7
 s_add_u32 s67, s67, 15794176
 s_lshl_b32 s65, s59, 5
 s_add_u32 s65, s65, s5
 s_lshl_b32 s65, s65, 2
 s_add_u32 s65, s65, s4
 s_lshl_b32 s65, s65, 10
 s_add_u32 s65, s65, 6291456
 ds_read_b128 v[16:19], v248 offset:0
 ds_read_b128 v[20:23], v248 offset:16384
 ds_read_b128 v[24:27], v248 offset:1024
 ds_read_b128 v[28:31], v248 offset:17408
 s_waitcnt lgkmcnt(2)
 v_mfma_f32_16x16x32_bf16 v[0:3], a[0:3], v[16:19], 0
 ds_read_b128 v[32:35], v248 offset:2048
 ds_read_b128 v[36:39], v248 offset:18432
 v_mfma_f32_16x16x32_bf16 v[8:11], a[64:67], v[16:19], 0
 v_mfma_f32_16x16x32_bf16 v[4:7], a[0:3], v[20:23], 0
 buffer_load_dword v253, v217, s[36:39], s67 offen sc1
 v_mfma_f32_16x16x32_bf16 v[12:15], a[64:67], v[20:23], 0
 s_waitcnt lgkmcnt(2)
 v_mfma_f32_16x16x32_bf16 v[0:3], a[4:7], v[24:27], v[0:3]
 ds_read_b128 v[16:19], v248 offset:3072
 ds_read_b128 v[20:23], v248 offset:19456
 v_mfma_f32_16x16x32_bf16 v[8:11], a[68:71], v[24:27], v[8:11]
 v_mfma_f32_16x16x32_bf16 v[4:7], a[4:7], v[28:31], v[4:7]
 buffer_store_dwordx4 v[228:231], v212, s[36:39], s94 offen
 v_mfma_f32_16x16x32_bf16 v[12:15], a[68:71], v[28:31], v[12:15]
 s_waitcnt lgkmcnt(2)
 v_mfma_f32_16x16x32_bf16 v[0:3], a[8:11], v[32:35], v[0:3]
 ds_read_b128 v[24:27], v248 offset:4096
 ds_read_b128 v[28:31], v248 offset:20480
 v_mfma_f32_16x16x32_bf16 v[8:11], a[72:75], v[32:35], v[8:11]
 v_mfma_f32_16x16x32_bf16 v[4:7], a[8:11], v[36:39], v[4:7]
 v_mfma_f32_16x16x32_bf16 v[12:15], a[72:75], v[36:39], v[12:15]
 s_waitcnt lgkmcnt(2)
 v_mfma_f32_16x16x32_bf16 v[0:3], a[12:15], v[16:19], v[0:3]
 ds_read_b128 v[32:35], v248 offset:5120
 ds_read_b128 v[36:39], v248 offset:21504
 v_mfma_f32_16x16x32_bf16 v[8:11], a[76:79], v[16:19], v[8:11]
 v_mfma_f32_16x16x32_bf16 v[4:7], a[12:15], v[20:23], v[4:7]
 s_add_u32 s70, s94, 4096
 buffer_store_dwordx4 v[228:231], v212, s[36:39], s70 offen
 v_mfma_f32_16x16x32_bf16 v[12:15], a[76:79], v[20:23], v[12:15]
 s_waitcnt lgkmcnt(2)
 v_mfma_f32_16x16x32_bf16 v[0:3], a[16:19], v[24:27], v[0:3]
 ds_read_b128 v[16:19], v248 offset:6144
 ds_read_b128 v[20:23], v248 offset:22528
 v_mfma_f32_16x16x32_bf16 v[8:11], a[80:83], v[24:27], v[8:11]
 v_mfma_f32_16x16x32_bf16 v[4:7], a[16:19], v[28:31], v[4:7]
 s_add_u32 s70, s94, 8192
 buffer_store_dwordx4 v[228:231], v212, s[36:39], s70 offen
 v_mfma_f32_16x16x32_bf16 v[12:15], a[80:83], v[28:31], v[12:15]
 s_waitcnt lgkmcnt(2)
 v_mfma_f32_16x16x32_bf16 v[0:3], a[20:23], v[32:35], v[0:3]
 ds_read_b128 v[24:27], v248 offset:7168
 ds_read_b128 v[28:31], v248 offset:23552
 v_mfma_f32_16x16x32_bf16 v[8:11], a[84:87], v[32:35], v[8:11]
 v_mfma_f32_16x16x32_bf16 v[4:7], a[20:23], v[36:39], v[4:7]
 v_mfma_f32_16x16x32_bf16 v[12:15], a[84:87], v[36:39], v[12:15]
 s_waitcnt lgkmcnt(2)
 v_mfma_f32_16x16x32_bf16 v[0:3], a[24:27], v[16:19], v[0:3]
 ds_read_b128 v[32:35], v248 offset:8192
 ds_read_b128 v[36:39], v248 offset:24576
 v_mfma_f32_16x16x32_bf16 v[8:11], a[88:91], v[16:19], v[8:11]
 v_mfma_f32_16x16x32_bf16 v[4:7], a[24:27], v[20:23], v[4:7]
 s_add_u32 s70, s94, 12288
 buffer_store_dwordx4 v[228:231], v212, s[36:39], s70 offen
 v_mfma_f32_16x16x32_bf16 v[12:15], a[88:91], v[20:23], v[12:15]
 s_waitcnt lgkmcnt(2)
 v_mfma_f32_16x16x32_bf16 v[0:3], a[28:31], v[24:27], v[0:3]
 ds_read_b128 v[16:19], v248 offset:9216
 ds_read_b128 v[20:23], v248 offset:25600
 v_mfma_f32_16x16x32_bf16 v[8:11], a[92:95], v[24:27], v[8:11]
 v_mfma_f32_16x16x32_bf16 v[4:7], a[28:31], v[28:31], v[4:7]
 s_add_u32 s70, s94, 16384
 buffer_store_dwordx4 v[228:231], v212, s[36:39], s70 offen
 v_mfma_f32_16x16x32_bf16 v[12:15], a[92:95], v[28:31], v[12:15]
 s_waitcnt lgkmcnt(2)
 v_mfma_f32_16x16x32_bf16 v[0:3], a[32:35], v[32:35], v[0:3]
 ds_read_b128 v[24:27], v248 offset:10240
 ds_read_b128 v[28:31], v248 offset:26624
 v_mfma_f32_16x16x32_bf16 v[8:11], a[96:99], v[32:35], v[8:11]
 v_mfma_f32_16x16x32_bf16 v[4:7], a[32:35], v[36:39], v[4:7]
 v_mfma_f32_16x16x32_bf16 v[12:15], a[96:99], v[36:39], v[12:15]
 s_waitcnt lgkmcnt(2)
 v_mfma_f32_16x16x32_bf16 v[0:3], a[36:39], v[16:19], v[0:3]
 ds_read_b128 v[32:35], v248 offset:11264
 ds_read_b128 v[36:39], v248 offset:27648
 v_mfma_f32_16x16x32_bf16 v[8:11], a[100:103], v[16:19], v[8:11]
 v_mfma_f32_16x16x32_bf16 v[4:7], a[36:39], v[20:23], v[4:7]
 s_add_u32 s70, s94, 20480
 buffer_store_dwordx4 v[228:231], v212, s[36:39], s70 offen
 v_mfma_f32_16x16x32_bf16 v[12:15], a[100:103], v[20:23], v[12:15]
 s_waitcnt lgkmcnt(2)
 v_mfma_f32_16x16x32_bf16 v[0:3], a[40:43], v[24:27], v[0:3]
 ds_read_b128 v[16:19], v248 offset:12288
 ds_read_b128 v[20:23], v248 offset:28672
 v_mfma_f32_16x16x32_bf16 v[8:11], a[104:107], v[24:27], v[8:11]
 v_mfma_f32_16x16x32_bf16 v[4:7], a[40:43], v[28:31], v[4:7]
 s_add_u32 s70, s94, 24576
 buffer_store_dwordx4 v[228:231], v212, s[36:39], s70 offen
 v_mfma_f32_16x16x32_bf16 v[12:15], a[104:107], v[28:31], v[12:15]
 s_waitcnt lgkmcnt(2)
 v_mfma_f32_16x16x32_bf16 v[0:3], a[44:47], v[32:35], v[0:3]
 ds_read_b128 v[24:27], v248 offset:13312
 ds_read_b128 v[28:31], v248 offset:29696
 v_mfma_f32_16x16x32_bf16 v[8:11], a[108:111], v[32:35], v[8:11]
 v_mfma_f32_16x16x32_bf16 v[4:7], a[44:47], v[36:39], v[4:7]
 v_mfma_f32_16x16x32_bf16 v[12:15], a[108:111], v[36:39], v[12:15]
 s_waitcnt lgkmcnt(2)
 v_mfma_f32_16x16x32_bf16 v[0:3], a[48:51], v[16:19], v[0:3]
 ds_read_b128 v[32:35], v248 offset:14336
 ds_read_b128 v[36:39], v248 offset:30720
 v_mfma_f32_16x16x32_bf16 v[8:11], a[112:115], v[16:19], v[8:11]
 v_mfma_f32_16x16x32_bf16 v[4:7], a[48:51], v[20:23], v[4:7]
 s_add_u32 s70, s94, 28672
 buffer_store_dwordx4 v[228:231], v212, s[36:39], s70 offen
 v_mfma_f32_16x16x32_bf16 v[12:15], a[112:115], v[20:23], v[12:15]
 s_waitcnt lgkmcnt(2)
 v_mfma_f32_16x16x32_bf16 v[0:3], a[52:55], v[24:27], v[0:3]
 ds_read_b128 v[16:19], v248 offset:15360
 ds_read_b128 v[20:23], v248 offset:31744
 v_mfma_f32_16x16x32_bf16 v[8:11], a[116:119], v[24:27], v[8:11]
 v_mfma_f32_16x16x32_bf16 v[4:7], a[52:55], v[28:31], v[4:7]
 v_mfma_f32_16x16x32_bf16 v[12:15], a[116:119], v[28:31], v[12:15]
 s_waitcnt lgkmcnt(2)
 v_mfma_f32_16x16x32_bf16 v[0:3], a[56:59], v[32:35], v[0:3]
 v_mfma_f32_16x16x32_bf16 v[8:11], a[120:123], v[32:35], v[8:11]
 v_mfma_f32_16x16x32_bf16 v[4:7], a[56:59], v[36:39], v[4:7]
 v_mfma_f32_16x16x32_bf16 v[12:15], a[120:123], v[36:39], v[12:15]
 s_waitcnt lgkmcnt(0)
 v_mfma_f32_16x16x32_bf16 v[0:3], a[60:63], v[16:19], v[0:3]
 v_mfma_f32_16x16x32_bf16 v[8:11], a[124:127], v[16:19], v[8:11]
 v_mfma_f32_16x16x32_bf16 v[4:7], a[60:63], v[20:23], v[4:7]
 v_mfma_f32_16x16x32_bf16 v[12:15], a[124:127], v[20:23], v[12:15]
 v_cvt_pk_bf16_f32 v16, v0, v8
 v_cvt_pk_bf16_f32 v17, v1, v9
 v_cvt_pk_bf16_f32 v18, v2, v10
 v_cvt_pk_bf16_f32 v19, v3, v11
 ds_write_b128 v251, v[16:19] offset:0
 s_nop 1
 v_cvt_pk_bf16_f32 v20, v4, v12
 v_cvt_pk_bf16_f32 v21, v5, v13
 v_cvt_pk_bf16_f32 v22, v6, v14
 v_cvt_pk_bf16_f32 v23, v7, v15
 ds_write_b128 v251, v[20:23] offset:4096
 s_waitcnt vmcnt(8) lgkmcnt(0)
 s_barrier
 ds_read_b128 v[32:35], v215 offset:0
 ds_read_b128 v[48:51], v248 offset:34816
 ds_read_b128 v[52:55], v248 offset:35840
 ds_read_b128 v[36:39], v215 offset:1024
 ds_read_b128 v[56:59], v248 offset:38912
 ds_read_b128 v[60:63], v248 offset:39936
 ds_read_b128 v[40:43], v215 offset:2048
 ds_read_b128 v[64:67], v248 offset:43008
 ds_read_b128 v[68:71], v248 offset:44032
 ds_read_b128 v[44:47], v215 offset:3072
 ds_read_b128 v[72:75], v248 offset:47104
 ds_read_b128 v[76:79], v248 offset:48128
 s_waitcnt lgkmcnt(9)
 v_mfma_f32_16x16x32_bf16 v[0:3], v[48:51], v[32:35], 0
 v_mfma_f32_16x16x32_bf16 v[4:7], v[52:55], v[32:35], 0
 s_waitcnt lgkmcnt(6)
 v_mfma_f32_16x16x32_bf16 v[0:3], v[56:59], v[36:39], v[0:3]
 v_mfma_f32_16x16x32_bf16 v[4:7], v[60:63], v[36:39], v[4:7]
 s_waitcnt lgkmcnt(3)
 v_mfma_f32_16x16x32_bf16 v[0:3], v[64:67], v[40:43], v[0:3]
 v_mfma_f32_16x16x32_bf16 v[4:7], v[68:71], v[40:43], v[4:7]
 s_waitcnt lgkmcnt(0)
 v_mfma_f32_16x16x32_bf16 v[0:3], v[72:75], v[44:47], v[0:3]
 v_mfma_f32_16x16x32_bf16 v[4:7], v[76:79], v[44:47], v[4:7]
 ds_read_b128 v[80:83], v250 offset:0
 ds_read_b128 v[84:87], v250 offset:1024
 ds_read_b128 v[88:91], v250 offset:4096
 ds_read_b128 v[92:95], v250 offset:5120
 s_and_b32 s70, s58, 1
 s_lshl_b32 s70, s70, 20
 s_lshl_b32 s71, s56, 21
 s_add_u32 s70, s70, s71
 s_add_u32 s70, s70, 16777216
 s_lshl_b32 s71, s5, 10
 s_add_u32 s63, s70, s71
 s_add_u32 s64, s63, 524288
 s_lshl_b32 s71, s5, 15
 s_add_u32 s62, s70, s71
 s_lshl_b32 s69, s59, 5
 s_add_u32 s69, s69, s5
 s_lshl_b32 s69, s69, 10
 v_mov_b32 v220, 0xceabfb8f
 v_mul_f32 v0, s68, v0
 v_mul_f32 v1, s68, v1
 v_mul_f32 v2, s68, v2
 v_mul_f32 v3, s68, v3
 v_mul_f32 v4, s68, v4
 v_mul_f32 v5, s68, v5
 v_mul_f32 v6, s68, v6
 v_mul_f32 v7, s68, v7
 v_cndmask_b32 v0, v220, v0, s[74:75]
 v_cndmask_b32 v1, v220, v1, s[76:77]
 v_cndmask_b32 v2, v220, v2, s[78:79]
 v_cndmask_b32 v3, v220, v3, s[80:81]
 v_cndmask_b32 v4, v220, v4, s[82:83]
 v_cndmask_b32 v5, v220, v5, s[84:85]
 v_cndmask_b32 v6, v220, v6, s[86:87]
 v_cndmask_b32 v7, v220, v7, s[88:89]
 v_max3_f32 v136, v0, v1, v2
 v_max3_f32 v137, v3, v4, v5
 v_max3_f32 v138, v6, v7, v136
 buffer_load_dwordx2 v[244:245], v213, s[52:55], s69 offen offset:0
 buffer_load_dwordx2 v[246:247], v213, s[52:55], s69 offen offset:512
 v_add_u32 v220, s92, v249
 s_xor_b32 s92, s92, 49152
 s_cmp_ge_u32 s93, 64
 s_cbranch_scc1 L_qo_nf
 s_mov_b32 s7, 524288
L42:
 v_readfirstlane_b32 s70, v253
 s_cmp_gt_u32 s70, s66
 s_cbranch_scc1 L43
 buffer_load_dword v253, v217, s[36:39], s67 offen sc1
 s_sub_u32 s7, s7, 1
 s_cbranch_scc1 L_abort
 s_waitcnt vmcnt(0)
 s_branch L42
L43:
 s_lshl_b32 s70, s93, 15
 s_lshl_b32 s71, s4, 13
 s_add_u32 s70, s70, s71
 s_add_u32 m0, s71, s92
 s_add_u32 s70, s70, 0
 buffer_load_dwordx4 v205, s[36:39], s70 offen offset:0 sc1 lds
 buffer_load_dwordx4 v205, s[36:39], s70 offen offset:1024 sc1 lds
 buffer_load_dwordx4 v205, s[36:39], s70 offen offset:2048 sc1 lds
 buffer_load_dwordx4 v205, s[36:39], s70 offen offset:3072 sc1 lds
 s_add_u32 s70, s70, 4096
 s_add_u32 m0, m0, 4096
 s_nop 0
 buffer_load_dwordx4 v205, s[36:39], s70 offen offset:0 sc1 lds
 buffer_load_dwordx4 v205, s[36:39], s70 offen offset:1024 sc1 lds
 buffer_load_dwordx4 v205, s[36:39], s70 offen offset:2048 sc1 lds
 buffer_load_dwordx4 v205, s[36:39], s70 offen offset:3072 sc1 lds
 s_lshl_b32 s70, s93, 5
 s_add_u32 s70, s70, s5
 s_lshl_b32 s70, s70, 14
 s_add_u32 s70, s70, 33554432
 s_lshl_b32 s71, s4, 12
 s_add_u32 s71, s71, s92
 s_add_u32 m0, s71, 32768
 s_nop 0
 buffer_load_dwordx4 v206, s[36:39], s70 offen offset:0 sc1 lds
 buffer_load_dwordx4 v206, s[36:39], s70 offen offset:1024 sc1 lds
 buffer_load_dwordx4 v206, s[36:39], s70 offen offset:2048 sc1 lds
 buffer_load_dwordx4 v206, s[36:39], s70 offen offset:3072 sc1 lds
L_qo_nf:
 s_mov_b32 s7, 524288
 s_branch L_qo_km1
L_qo_km:
L_qo_km1:
 buffer_load_dwordx4 v[240:243], v205, s[36:39], s65 offen sc1
 s_sub_u32 s7, s7, 1
 s_cbranch_scc1 L_abort
 s_waitcnt vmcnt(0)
 v_max3_u32 v218, v240, v240, v241
 v_max3_u32 v218, v218, v242, v243
 v_cmp_eq_u32 vcc, -1, v218
 ds_write2_b32 v207, v240, v241 offset1:16
 ds_write_b64 v208, v[242:243]
 s_cbranch_vccnz L_qo_km
 s_waitcnt lgkmcnt(0)
 s_barrier
 ds_read_b128 v[96:99], v209 offset:0
 ds_read_b128 v[100:103], v209 offset:512
 ds_read_b128 v[104:107], v209 offset:1024
 ds_read_b128 v[108:111], v209 offset:1536
 ds_read_b64 v[112:113], v210 offset:0
 ds_read_b64 v[114:115], v210 offset:512
 s_waitcnt lgkmcnt(5)
 v_mfma_f32_16x16x32_bf16 v[8:11], v[96:99], v[32:35], 0
 s_waitcnt lgkmcnt(4)
 v_mfma_f32_16x16x32_bf16 v[8:11], v[100:103], v[36:39], v[8:11]
 s_waitcnt lgkmcnt(3)
 v_mfma_f32_16x16x32_bf16 v[8:11], v[104:107], v[40:43], v[8:11]
 s_waitcnt lgkmcnt(2)
 v_mfma_f32_16x16x32_bf16 v[8:11], v[108:111], v[44:47], v[8:11]
 s_nop 6
 v_mul_f32 v8, s68, v8
 v_mul_f32 v9, s68, v9
 v_max3_f32 v136, v8, v9, v137
 v_max_f32 v137, v136, v138
 v_max_f32 v139, v136, v138
 s_nop 1
 v_permlane16_swap_b32 v137, v139
 v_max_f32 v136, v137, v139
 v_max_f32 v138, v137, v139
 s_nop 1
 v_permlane32_swap_b32 v136, v138
 v_max_f32 v136, v136, v138
 v_sub_f32 v0, v0, v136
 v_exp_f32 v0, v0
 v_sub_f32 v1, v1, v136
 v_exp_f32 v1, v1
 v_sub_f32 v2, v2, v136
 v_exp_f32 v2, v2
 v_sub_f32 v3, v3, v136
 v_exp_f32 v3, v3
 v_sub_f32 v4, v4, v136
 v_exp_f32 v4, v4
 v_sub_f32 v5, v5, v136
 v_exp_f32 v5, v5
 v_sub_f32 v6, v6, v136
 v_exp_f32 v6, v6
 v_sub_f32 v7, v7, v136
 v_exp_f32 v7, v7
 v_sub_f32 v8, v8, v136
 v_exp_f32 v8, v8
 v_sub_f32 v9, v9, v136
 v_exp_f32 v9, v9
 v_cvt_pk_bf16_f32 v12, v0, v1
 v_cvt_pk_bf16_f32 v13, v2, v3
 v_cvt_pk_bf16_f32 v14, v4, v5
 v_cvt_pk_bf16_f32 v15, v6, v7
 v_cvt_pk_bf16_f32 v236, v8, v9
 v_cvt_pk_bf16_f32 v239, v8, v9
 s_waitcnt lgkmcnt(0)
 v_mfma_f32_16x16x32_bf16 v[132:135], v[232:235], v[12:15], 0
 v_mfma_f32_16x16x32_bf16 v[116:119], v[80:83], v[12:15], 0
 v_mfma_f32_16x16x32_bf16 v[120:123], v[84:87], v[12:15], 0
 v_mfma_f32_16x16x32_bf16 v[124:127], v[88:91], v[12:15], 0
 v_mfma_f32_16x16x32_bf16 v[128:131], v[92:95], v[12:15], 0
 v_mfma_f32_16x16x16_bf16 v[132:135], v[232:233], v[236:237], v[132:135]
 v_mfma_f32_16x16x16_bf16 v[116:119], v[112:113], v[236:237], v[116:119]
 v_mfma_f32_16x16x16_bf16 v[120:123], v[112:113], v[238:239], v[120:123]
 v_mfma_f32_16x16x16_bf16 v[124:127], v[114:115], v[236:237], v[124:127]
 v_mfma_f32_16x16x16_bf16 v[128:131], v[114:115], v[238:239], v[128:131]
 v_rcp_f32 v132, v132
 s_nop 0
 v_mul_f32 v116, v116, v132
 v_mul_f32 v117, v117, v132
 v_mul_f32 v118, v118, v132
 v_mul_f32 v119, v119, v132
 v_mul_f32 v120, v120, v132
 v_mul_f32 v121, v121, v132
 v_mul_f32 v122, v122, v132
 v_mul_f32 v123, v123, v132
 v_cvt_pk_bf16_f32 v16, v116, v117
 v_cvt_pk_bf16_f32 v17, v118, v119
 v_cvt_pk_bf16_f32 v18, v120, v121
 v_cvt_pk_bf16_f32 v19, v122, v123
 ds_write_b128 v220, v[16:19] offset:0
 v_mul_f32 v124, v124, v132
 v_mul_f32 v125, v125, v132
 v_mul_f32 v126, v126, v132
 v_mul_f32 v127, v127, v132
 v_mul_f32 v128, v128, v132
 v_mul_f32 v129, v129, v132
 v_mul_f32 v130, v130, v132
 v_mul_f32 v131, v131, v132
 v_cvt_pk_bf16_f32 v20, v124, v125
 v_cvt_pk_bf16_f32 v21, v126, v127
 v_cvt_pk_bf16_f32 v22, v128, v129
 v_cvt_pk_bf16_f32 v23, v130, v131
 ds_write_b128 v220, v[20:23] offset:1024
 s_waitcnt lgkmcnt(0)
 s_barrier
 ds_read_b128 v[32:35], v248 offset:0
 ds_read_b128 v[36:39], v248 offset:1024
 ds_read_b128 v[40:43], v248 offset:2048
 ds_read_b128 v[44:47], v248 offset:3072
 ds_read_b128 v[48:51], v248 offset:4096
 ds_read_b128 v[52:55], v248 offset:5120
 ds_read_b128 v[56:59], v248 offset:6144
 ds_read_b128 v[60:63], v248 offset:7168
 s_waitcnt lgkmcnt(0)
 v_mfma_f32_16x16x32_bf16 v[64:67], a[128:131], v[32:35], 0
 v_mfma_f32_16x16x32_bf16 v[64:67], a[132:135], v[36:39], v[64:67]
 v_mfma_f32_16x16x32_bf16 v[64:67], a[136:139], v[40:43], v[64:67]
 v_mfma_f32_16x16x32_bf16 v[64:67], a[140:143], v[44:47], v[64:67]
 v_mfma_f32_16x16x32_bf16 v[68:71], a[144:147], v[32:35], 0
 v_mfma_f32_16x16x32_bf16 v[68:71], a[148:151], v[36:39], v[68:71]
 v_mfma_f32_16x16x32_bf16 v[68:71], a[152:155], v[40:43], v[68:71]
 v_mfma_f32_16x16x32_bf16 v[68:71], a[156:159], v[44:47], v[68:71]
 v_mfma_f32_16x16x32_bf16 v[72:75], a[128:131], v[48:51], 0
 v_mfma_f32_16x16x32_bf16 v[72:75], a[132:135], v[52:55], v[72:75]
 v_mfma_f32_16x16x32_bf16 v[72:75], a[136:139], v[56:59], v[72:75]
 v_cvt_pk_bf16_f32 v16, v64, v65
 v_mfma_f32_16x16x32_bf16 v[72:75], a[140:143], v[60:63], v[72:75]
 v_cvt_pk_bf16_f32 v17, v66, v67
 v_mfma_f32_16x16x32_bf16 v[76:79], a[144:147], v[48:51], 0
 v_cvt_pk_bf16_f32 v18, v68, v69
 v_cvt_pk_bf16_f32 v19, v70, v71
 v_mfma_f32_16x16x32_bf16 v[76:79], a[148:151], v[52:55], v[76:79]
 buffer_store_dwordx4 v[16:19], v211, s[36:39], s63 offen offset:0
 v_mfma_f32_16x16x32_bf16 v[76:79], a[152:155], v[56:59], v[76:79]
 v_mfma_f32_16x16x32_bf16 v[76:79], a[156:159], v[60:63], v[76:79]
 v_mfma_f32_16x16x32_bf16 v[80:83], a[160:163], v[32:35], 0
 v_mfma_f32_16x16x32_bf16 v[80:83], a[164:167], v[36:39], v[80:83]
 v_mfma_f32_16x16x32_bf16 v[80:83], a[168:171], v[40:43], v[80:83]
 v_cvt_pk_bf16_f32 v20, v72, v73
 v_mfma_f32_16x16x32_bf16 v[80:83], a[172:175], v[44:47], v[80:83]
 v_cvt_pk_bf16_f32 v21, v74, v75
 v_mfma_f32_16x16x32_bf16 v[84:87], a[176:179], v[32:35], 0
 v_cvt_pk_bf16_f32 v22, v76, v77
 v_cvt_pk_bf16_f32 v23, v78, v79
 v_mfma_f32_16x16x32_bf16 v[84:87], a[180:183], v[36:39], v[84:87]
 buffer_store_dwordx4 v[20:23], v211, s[36:39], s64 offen offset:0
 v_mfma_f32_16x16x32_bf16 v[84:87], a[184:187], v[40:43], v[84:87]
 v_mfma_f32_16x16x32_bf16 v[84:87], a[188:191], v[44:47], v[84:87]
 v_mfma_f32_16x16x32_bf16 v[88:91], a[160:163], v[48:51], 0
 v_mfma_f32_16x16x32_bf16 v[88:91], a[164:167], v[52:55], v[88:91]
 v_mfma_f32_16x16x32_bf16 v[88:91], a[168:171], v[56:59], v[88:91]
 v_cvt_pk_bf16_f32 v16, v80, v81
 v_mfma_f32_16x16x32_bf16 v[88:91], a[172:175], v[60:63], v[88:91]
 v_cvt_pk_bf16_f32 v17, v82, v83
 v_mfma_f32_16x16x32_bf16 v[92:95], a[176:179], v[48:51], 0
 v_cvt_pk_bf16_f32 v18, v84, v85
 v_cvt_pk_bf16_f32 v19, v86, v87
 v_mfma_f32_16x16x32_bf16 v[92:95], a[180:183], v[52:55], v[92:95]
 buffer_store_dwordx4 v[16:19], v211, s[36:39], s63 offen offset:64
 v_mfma_f32_16x16x32_bf16 v[92:95], a[184:187], v[56:59], v[92:95]
 v_mfma_f32_16x16x32_bf16 v[92:95], a[188:191], v[60:63], v[92:95]
 v_mfma_f32_16x16x32_bf16 v[96:99], a[192:195], v[32:35], 0
 v_mfma_f32_16x16x32_bf16 v[96:99], a[196:199], v[36:39], v[96:99]
 v_mfma_f32_16x16x32_bf16 v[96:99], a[200:203], v[40:43], v[96:99]
 v_cvt_pk_bf16_f32 v20, v88, v89
 v_mfma_f32_16x16x32_bf16 v[96:99], a[204:207], v[44:47], v[96:99]
 v_cvt_pk_bf16_f32 v21, v90, v91
 v_mfma_f32_16x16x32_bf16 v[100:103], a[208:211], v[32:35], 0
 v_cvt_pk_bf16_f32 v22, v92, v93
 v_cvt_pk_bf16_f32 v23, v94, v95
 v_mfma_f32_16x16x32_bf16 v[100:103], a[212:215], v[36:39], v[100:103]
 buffer_store_dwordx4 v[20:23], v211, s[36:39], s64 offen offset:64
 v_mfma_f32_16x16x32_bf16 v[100:103], a[216:219], v[40:43], v[100:103]
 v_mfma_f32_16x16x32_bf16 v[100:103], a[220:223], v[44:47], v[100:103]
 v_mfma_f32_16x16x32_bf16 v[104:107], a[192:195], v[48:51], 0
 v_mfma_f32_16x16x32_bf16 v[104:107], a[196:199], v[52:55], v[104:107]
 v_mfma_f32_16x16x32_bf16 v[104:107], a[200:203], v[56:59], v[104:107]
 v_cvt_pk_bf16_f32 v16, v96, v97
 v_mfma_f32_16x16x32_bf16 v[104:107], a[204:207], v[60:63], v[104:107]
 v_cvt_pk_bf16_f32 v17, v98, v99
 v_mfma_f32_16x16x32_bf16 v[108:111], a[208:211], v[48:51], 0
 v_cvt_pk_bf16_f32 v18, v100, v101
 v_cvt_pk_bf16_f32 v19, v102, v103
 v_mfma_f32_16x16x32_bf16 v[108:111], a[212:215], v[52:55], v[108:111]
 buffer_store_dwordx4 v[16:19], v211, s[36:39], s63 offen offset:128
 v_mfma_f32_16x16x32_bf16 v[108:111], a[216:219], v[56:59], v[108:111]
 v_mfma_f32_16x16x32_bf16 v[108:111], a[220:223], v[60:63], v[108:111]
 v_mfma_f32_16x16x32_bf16 v[112:115], a[224:227], v[32:35], 0
 v_mfma_f32_16x16x32_bf16 v[112:115], a[228:231], v[36:39], v[112:115]
 v_mfma_f32_16x16x32_bf16 v[112:115], a[232:235], v[40:43], v[112:115]
 v_cvt_pk_bf16_f32 v20, v104, v105
 v_mfma_f32_16x16x32_bf16 v[112:115], a[236:239], v[44:47], v[112:115]
 v_cvt_pk_bf16_f32 v21, v106, v107
 v_mfma_f32_16x16x32_bf16 v[116:119], a[240:243], v[32:35], 0
 v_cvt_pk_bf16_f32 v22, v108, v109
 v_cvt_pk_bf16_f32 v23, v110, v111
 v_mfma_f32_16x16x32_bf16 v[116:119], a[244:247], v[36:39], v[116:119]
 buffer_store_dwordx4 v[20:23], v211, s[36:39], s64 offen offset:128
 v_mfma_f32_16x16x32_bf16 v[116:119], a[248:251], v[40:43], v[116:119]
 v_mfma_f32_16x16x32_bf16 v[116:119], a[252:255], v[44:47], v[116:119]
 v_mfma_f32_16x16x32_bf16 v[120:123], a[224:227], v[48:51], 0
 v_mfma_f32_16x16x32_bf16 v[120:123], a[228:231], v[52:55], v[120:123]
 v_mfma_f32_16x16x32_bf16 v[120:123], a[232:235], v[56:59], v[120:123]
 v_cvt_pk_bf16_f32 v16, v112, v113
 v_mfma_f32_16x16x32_bf16 v[120:123], a[236:239], v[60:63], v[120:123]
 v_cvt_pk_bf16_f32 v17, v114, v115
 v_mfma_f32_16x16x32_bf16 v[124:127], a[240:243], v[48:51], 0
 v_cvt_pk_bf16_f32 v18, v116, v117
 v_cvt_pk_bf16_f32 v19, v118, v119
 v_mfma_f32_16x16x32_bf16 v[124:127], a[244:247], v[52:55], v[124:127]
 buffer_store_dwordx4 v[16:19], v211, s[36:39], s63 offen offset:192
 v_mfma_f32_16x16x32_bf16 v[124:127], a[248:251], v[56:59], v[124:127]
 v_mfma_f32_16x16x32_bf16 v[124:127], a[252:255], v[60:63], v[124:127]
 v_cvt_pk_bf16_f32 v20, v120, v121
 v_cvt_pk_bf16_f32 v21, v122, v123
 s_nop 4
 v_cvt_pk_bf16_f32 v22, v124, v125
 v_cvt_pk_bf16_f32 v23, v126, v127
 buffer_store_dwordx4 v[20:23], v211, s[36:39], s64 offen offset:192
 s_mov_b32 s7, 524288
 s_mov_b64 vcc, -1
L44:
 s_mov_b64 exec, vcc
 buffer_load_dwordx4 v[0:3], v212, s[36:39], s62 offen sc1
 s_add_u32 s70, s62, 4096
 buffer_load_dwordx4 v[4:7], v212, s[36:39], s70 offen sc1
 s_add_u32 s70, s62, 8192
 buffer_load_dwordx4 v[8:11], v212, s[36:39], s70 offen sc1
 s_add_u32 s70, s62, 12288
 buffer_load_dwordx4 v[12:15], v212, s[36:39], s70 offen sc1
 s_add_u32 s70, s62, 16384
 buffer_load_dwordx4 v[16:19], v212, s[36:39], s70 offen sc1
 s_add_u32 s70, s62, 20480
 buffer_load_dwordx4 v[20:23], v212, s[36:39], s70 offen sc1
 s_add_u32 s70, s62, 24576
 buffer_load_dwordx4 v[24:27], v212, s[36:39], s70 offen sc1
 s_add_u32 s70, s62, 28672
 buffer_load_dwordx4 v[28:31], v212, s[36:39], s70 offen sc1
 s_mov_b64 exec, -1
 s_sub_u32 s7, s7, 1
 s_cbranch_scc1 L_abort
 s_waitcnt vmcnt(7)
 v_mfma_f32_16x16x32_bf16 v[128:131], v[224:227], v[0:3], 0
 v_max3_u32 v218, v0, v0, v1
 v_max3_u32 v218, v218, v2, v3
 s_waitcnt vmcnt(6)
 v_mfma_f32_16x16x32_bf16 v[128:131], v[224:227], v[4:7], v[128:131]
 v_max3_u32 v218, v218, v4, v5
 v_max3_u32 v218, v218, v6, v7
 s_waitcnt vmcnt(5)
 v_mfma_f32_16x16x32_bf16 v[128:131], v[224:227], v[8:11], v[128:131]
 v_max3_u32 v218, v218, v8, v9
 v_max3_u32 v218, v218, v10, v11
 s_waitcnt vmcnt(4)
 v_mfma_f32_16x16x32_bf16 v[128:131], v[224:227], v[12:15], v[128:131]
 v_max3_u32 v218, v218, v12, v13
 v_max3_u32 v218, v218, v14, v15
 s_waitcnt vmcnt(3)
 v_mfma_f32_16x16x32_bf16 v[128:131], v[224:227], v[16:19], v[128:131]
 v_max3_u32 v218, v218, v16, v17
 v_max3_u32 v218, v218, v18, v19
 s_waitcnt vmcnt(2)
 v_mfma_f32_16x16x32_bf16 v[128:131], v[224:227], v[20:23], v[128:131]
 v_max3_u32 v218, v218, v20, v21
 v_max3_u32 v218, v218, v22, v23
 s_waitcnt vmcnt(1)
 v_mfma_f32_16x16x32_bf16 v[128:131], v[224:227], v[24:27], v[128:131]
 v_max3_u32 v218, v218, v24, v25
 v_max3_u32 v218, v218, v26, v27
 s_waitcnt vmcnt(0)
 v_mfma_f32_16x16x32_bf16 v[128:131], v[224:227], v[28:31], v[128:131]
 v_max3_u32 v218, v218, v28, v29
 v_max3_u32 v218, v218, v30, v31
 v_cmp_eq_u32 vcc, -1, v218
 s_cbranch_vccnz L44
 s_lshr_b32 s70, s4, 1
 s_lshl_b32 s70, s70, 10
 v_add_u32 v220, s70, v252
 s_add_u32 s58, s58, 1
 s_mov_b64 exec, s[90:91]
 ds_write_b128 v220, v[128:131]
 s_mov_b64 exec, -1
 s_waitcnt lgkmcnt(0)
 s_barrier
 s_cmp_lg_u32 s4, 0
 s_cbranch_scc1 L_qo_next
 ds_read_b128 v[128:131], v252
 ds_read_b128 v[132:135], v252 offset:1024
 v_and_b32 v137, 0xffff0000, v244
 v_lshlrev_b32 v136, 16, v244
 v_and_b32 v139, 0xffff0000, v245
 v_lshlrev_b32 v138, 16, v245
 v_and_b32 v141, 0xffff0000, v246
 v_lshlrev_b32 v140, 16, v246
 v_and_b32 v143, 0xffff0000, v247
 v_lshlrev_b32 v142, 16, v247
 s_waitcnt lgkmcnt(0)
 v_cvt_pk_bf16_f32 v144, v128, v129
 v_cvt_pk_bf16_f32 v145, v130, v131
 v_cvt_pk_bf16_f32 v146, v132, v133
 v_cvt_pk_bf16_f32 v147, v134, v135
 v_and_b32 v129, 0xffff0000, v144
 v_lshlrev_b32 v128, 16, v144
 v_and_b32 v131, 0xffff0000, v145
 v_lshlrev_b32 v130, 16, v145
 v_and_b32 v133, 0xffff0000, v146
 v_lshlrev_b32 v132, 16, v146
 v_and_b32 v135, 0xffff0000, v147
 v_lshlrev_b32 v134, 16, v147
 v_add_f32 v128, v128, v136
 v_add_f32 v129, v129, v137
 v_add_f32 v130, v130, v138
 v_add_f32 v131, v131, v139
 v_add_f32 v132, v132, v140
 v_add_f32 v133, v133, v141
 v_add_f32 v134, v134, v142
 v_add_f32 v135, v135, v143
 v_cvt_pk_bf16_f32 v144, v128, v129
 v_cvt_pk_bf16_f32 v145, v130, v131
 v_cvt_pk_bf16_f32 v146, v132, v133
 v_cvt_pk_bf16_f32 v147, v134, v135
 v_and_b32 v129, 0xffff0000, v144
 v_lshlrev_b32 v128, 16, v144
 v_and_b32 v131, 0xffff0000, v145
 v_lshlrev_b32 v130, 16, v145
 v_and_b32 v133, 0xffff0000, v146
 v_lshlrev_b32 v132, 16, v146
 v_and_b32 v135, 0xffff0000, v147
 v_lshlrev_b32 v134, 16, v147
 v_add_f32 v150, v128, v129
 v_add_f32 v150, v150, v130
 v_add_f32 v150, v150, v131
 v_add_f32 v150, v150, v132
 v_add_f32 v150, v150, v133
 v_add_f32 v150, v150, v134
 v_add_f32 v150, v150, v135
 v_min_u32 v144, -2, v144
 v_min_u32 v145, -2, v145
 v_min_u32 v146, -2, v146
 v_min_u32 v147, -2, v147
 s_add_u32 s70, s69, 4194304
 buffer_store_dwordx4 v[144:147], v205, s[36:39], s70 offen sc1
 v_add_f32_dpp v150, v150, v150 row_ror:8 row_mask:0xf bank_mask:0xf
 s_nop 1
 v_add_f32_dpp v150, v150, v150 row_ror:4 row_mask:0xf bank_mask:0xf
 s_nop 1
 v_add_f32_dpp v150, v150, v150 row_ror:2 row_mask:0xf bank_mask:0xf
 s_nop 1
 v_add_f32_dpp v150, v150, v150 row_ror:1 row_mask:0xf bank_mask:0xf
 v_mov_b32 v218, v150
 s_nop 1
 v_permlane16_swap_b32 v150, v218
 v_add_f32 v150, v150, v218
 v_mov_b32 v218, v150
 s_nop 1
 v_permlane32_swap_b32 v150, v218
 v_add_f32 v150, v150, v218
 v_mul_f32 v150, 0x3b000000, v150
 v_sub_f32 v136, v128, v150
 v_sub_f32 v137, v129, v150
 v_sub_f32 v138, v130, v150
 v_sub_f32 v139, v131, v150
 v_sub_f32 v140, v132, v150
 v_sub_f32 v141, v133, v150
 v_sub_f32 v142, v134, v150
 v_sub_f32 v143, v135, v150
 v_mul_f32 v151, v136, v136
 v_fmac_f32 v151, v137, v137
 v_fmac_f32 v151, v138, v138
 v_fmac_f32 v151, v139, v139
 v_fmac_f32 v151, v140, v140
 v_fmac_f32 v151, v141, v141
 v_fmac_f32 v151, v142, v142
 v_fmac_f32 v151, v143, v143
 v_cvt_pk_bf16_f32 v150, v150, v150
 v_and_b32 v150, 0xffff0000, v150
 v_add_f32_dpp v151, v151, v151 row_ror:8 row_mask:0xf bank_mask:0xf
 s_nop 1
 v_add_f32_dpp v151, v151, v151 row_ror:4 row_mask:0xf bank_mask:0xf
 s_nop 1
 v_add_f32_dpp v151, v151, v151 row_ror:2 row_mask:0xf bank_mask:0xf
 s_nop 1
 v_add_f32_dpp v151, v151, v151 row_ror:1 row_mask:0xf bank_mask:0xf
 v_mov_b32 v218, v151
 s_nop 1
 v_permlane16_swap_b32 v151, v218
 v_add_f32 v151, v151, v218
 v_mov_b32 v218, v151
 s_nop 1
 v_permlane32_swap_b32 v151, v218
 v_add_f32 v151, v151, v218
 v_mul_f32 v151, 0x3b000000, v151
 v_cvt_pk_bf16_f32 v151, v151, v151
 v_and_b32 v151, 0xffff0000, v151
 v_add_f32 v151, 0x3727c5ac, v151
 v_cvt_pk_bf16_f32 v151, v151, v151
 v_and_b32 v151, 0xffff0000, v151
 v_sqrt_f32 v151, v151
 s_nop 0
 v_cvt_pk_bf16_f32 v151, v151, v151
 v_and_b32 v151, 0xffff0000, v151
 v_rcp_f32 v151, v151
 v_sub_f32 v128, v128, v150
 v_sub_f32 v129, v129, v150
 v_sub_f32 v130, v130, v150
 v_sub_f32 v131, v131, v150
 v_sub_f32 v132, v132, v150
 v_sub_f32 v133, v133, v150
 v_sub_f32 v134, v134, v150
 v_sub_f32 v135, v135, v150
 v_cvt_pk_bf16_f32 v136, v128, v129
 v_cvt_pk_bf16_f32 v137, v130, v131
 v_cvt_pk_bf16_f32 v138, v132, v133
 v_cvt_pk_bf16_f32 v139, v134, v135
 v_and_b32 v129, 0xffff0000, v136
 v_lshlrev_b32 v128, 16, v136
 v_and_b32 v131, 0xffff0000, v137
 v_lshlrev_b32 v130, 16, v137
 v_and_b32 v133, 0xffff0000, v138
 v_lshlrev_b32 v132, 16, v138
 v_and_b32 v135, 0xffff0000, v139
 v_lshlrev_b32 v134, 16, v139
 v_mul_f32 v128, v128, v151
 v_mul_f32 v129, v129, v151
 v_mul_f32 v130, v130, v151
 v_mul_f32 v131, v131, v151
 v_mul_f32 v132, v132, v151
 v_mul_f32 v133, v133, v151
 v_mul_f32 v134, v134, v151
 v_mul_f32 v135, v135, v151
 v_cvt_pk_bf16_f32 v136, v128, v129
 v_cvt_pk_bf16_f32 v137, v130, v131
 v_cvt_pk_bf16_f32 v138, v132, v133
 v_cvt_pk_bf16_f32 v139, v134, v135
 v_min_u32 v136, -2, v136
 v_min_u32 v137, -2, v137
 v_min_u32 v138, -2, v138
 v_min_u32 v139, -2, v139
 s_add_u32 s70, s69, 2097152
 buffer_store_dwordx4 v[136:139], v205, s[36:39], s70 offen sc1
L_qo_next:
 s_mov_b32 s94, s62
 s_mov_b32 s59, s93
 s_cmp_lt_u32 s59, 64
 s_cbranch_scc1 L_qo_loop
 s_endpgm
L_ffn:
 s_mov_b32 s58, s3
L_ffn2:
 s_mov_b32 s56, s3
 s_mov_b32 s52, s8
 s_mov_b32 s53, s9
 s_mov_b32 s54, 0x200000
 s_mov_b32 s55, 0x20000
 v_and_b32 v140, 63, v0
 s_lshl_b32 s57, s56, 5
 s_add_u32 s57, s57, s5
 s_cmp_ge_u32 s57, 64
 s_cbranch_scc1 L_ffn_noln
 s_lshl_b32 s70, s57, 15
 s_lshl_b32 s71, s4, 13
 s_add_u32 s70, s70, s71
 v_lshrrev_b32 v134, 3, v140
 v_and_b32 v131, 7, v140
 v_lshlrev_b32 v130, 4, v131
 v_lshl_add_u32 v130, v134, 10, v130
 buffer_load_dwordx4 v[8:11], v130, s[52:55], s70 offen offset:0
 buffer_load_dwordx4 v[12:15], v130, s[52:55], s70 offen offset:128
 buffer_load_dwordx4 v[16:19], v130, s[52:55], s70 offen offset:256
 buffer_load_dwordx4 v[20:23], v130, s[52:55], s70 offen offset:384
 buffer_load_dwordx4 v[24:27], v130, s[52:55], s70 offen offset:512
 buffer_load_dwordx4 v[28:31], v130, s[52:55], s70 offen offset:640
 buffer_load_dwordx4 v[32:35], v130, s[52:55], s70 offen offset:768
 buffer_load_dwordx4 v[36:39], v130, s[52:55], s70 offen offset:896
 s_and_b32 s71, s4, 1
 s_lshl_b32 s71, s71, 7
 v_lshl_add_u32 v130, v134, 4, s71
 s_lshr_b32 s71, s4, 1
 s_mul_i32 s71, s71, 17408
 v_add_u32 v130, s71, v130
 v_lshrrev_b32 v134, 2, v131
 v_mul_u32_u24 v134, 1088, v134
 v_add_u32 v130, v134, v130
 v_and_b32 v134, 3, v131
 v_mul_u32_u24 v134, 272, v134
 v_add_u32 v130, v134, v130
 s_waitcnt vmcnt(7)
 v_lshlrev_b32 v64, 16, v8
 v_and_b32 v65, 0xffff0000, v8
 v_lshlrev_b32 v66, 16, v9
 v_and_b32 v67, 0xffff0000, v9
 v_lshlrev_b32 v68, 16, v10
 v_and_b32 v69, 0xffff0000, v10
 v_lshlrev_b32 v70, 16, v11
 v_and_b32 v71, 0xffff0000, v11
 s_waitcnt vmcnt(6)
 v_lshlrev_b32 v72, 16, v12
 v_and_b32 v73, 0xffff0000, v12
 v_lshlrev_b32 v74, 16, v13
 v_and_b32 v75, 0xffff0000, v13
 v_lshlrev_b32 v76, 16, v14
 v_and_b32 v77, 0xffff0000, v14
 v_lshlrev_b32 v78, 16, v15
 v_and_b32 v79, 0xffff0000, v15
 s_waitcnt vmcnt(5)
 v_lshlrev_b32 v80, 16, v16
 v_and_b32 v81, 0xffff0000, v16
 v_lshlrev_b32 v82, 16, v17
 v_and_b32 v83, 0xffff0000, v17
 v_lshlrev_b32 v84, 16, v18
 v_and_b32 v85, 0xffff0000, v18
 v_lshlrev_b32 v86, 16, v19
 v_and_b32 v87, 0xffff0000, v19
 s_waitcnt vmcnt(4)
 v_lshlrev_b32 v88, 16, v20
 v_and_b32 v89, 0xffff0000, v20
 v_lshlrev_b32 v90, 16, v21
 v_and_b32 v91, 0xffff0000, v21
 v_lshlrev_b32 v92, 16, v22
 v_and_b32 v93, 0xffff0000, v22
 v_lshlrev_b32 v94, 16, v23
 v_and_b32 v95, 0xffff0000, v23
 s_waitcnt vmcnt(3)
 v_lshlrev_b32 v96, 16, v24
 v_and_b32 v97, 0xffff0000, v24
 v_lshlrev_b32 v98, 16, v25
 v_and_b32 v99, 0xffff0000, v25
 v_lshlrev_b32 v100, 16, v26
 v_and_b32 v101, 0xffff0000, v26
 v_lshlrev_b32 v102, 16, v27
 v_and_b32 v103, 0xffff0000, v27
 s_waitcnt vmcnt(2)
 v_lshlrev_b32 v104, 16, v28
 v_and_b32 v105, 0xffff0000, v28
 v_lshlrev_b32 v106, 16, v29
 v_and_b32 v107, 0xffff0000, v29
 v_lshlrev_b32 v108, 16, v30
 v_and_b32 v109, 0xffff0000, v30
 v_lshlrev_b32 v110, 16, v31
 v_and_b32 v111, 0xffff0000, v31
 s_waitcnt vmcnt(1)
 v_lshlrev_b32 v112, 16, v32
 v_and_b32 v113, 0xffff0000, v32
 v_lshlrev_b32 v114, 16, v33
 v_and_b32 v115, 0xffff0000, v33
 v_lshlrev_b32 v116, 16, v34
 v_and_b32 v117, 0xffff0000, v34
 v_lshlrev_b32 v118, 16, v35
 v_and_b32 v119, 0xffff0000, v35
 s_waitcnt vmcnt(0)
 v_lshlrev_b32 v120, 16, v36
 v_and_b32 v121, 0xffff0000, v36
 v_lshlrev_b32 v122, 16, v37
 v_and_b32 v123, 0xffff0000, v37
 v_lshlrev_b32 v124, 16, v38
 v_and_b32 v125, 0xffff0000, v38
 v_lshlrev_b32 v126, 16, v39
 v_and_b32 v127, 0xffff0000, v39
 v_add_f32 v132, v64, v65
 v_add_f32 v132, v132, v66
 v_add_f32 v132, v132, v67
 v_add_f32 v132, v132, v68
 v_add_f32 v132, v132, v69
 v_add_f32 v132, v132, v70
 v_add_f32 v132, v132, v71
 v_add_f32 v132, v132, v72
 v_add_f32 v132, v132, v73
 v_add_f32 v132, v132, v74
 v_add_f32 v132, v132, v75
 v_add_f32 v132, v132, v76
 v_add_f32 v132, v132, v77
 v_add_f32 v132, v132, v78
 v_add_f32 v132, v132, v79
 v_add_f32 v132, v132, v80
 v_add_f32 v132, v132, v81
 v_add_f32 v132, v132, v82
 v_add_f32 v132, v132, v83
 v_add_f32 v132, v132, v84
 v_add_f32 v132, v132, v85
 v_add_f32 v132, v132, v86
 v_add_f32 v132, v132, v87
 v_add_f32 v132, v132, v88
 v_add_f32 v132, v132, v89
 v_add_f32 v132, v132, v90
 v_add_f32 v132, v132, v91
 v_add_f32 v132, v132, v92
 v_add_f32 v132, v132, v93
 v_add_f32 v132, v132, v94
 v_add_f32 v132, v132, v95
 v_add_f32 v132, v132, v96
 v_add_f32 v132, v132, v97
 v_add_f32 v132, v132, v98
 v_add_f32 v132, v132, v99
 v_add_f32 v132, v132, v100
 v_add_f32 v132, v132, v101
 v_add_f32 v132, v132, v102
 v_add_f32 v132, v132, v103
 v_add_f32 v132, v132, v104
 v_add_f32 v132, v132, v105
 v_add_f32 v132, v132, v106
 v_add_f32 v132, v132, v107
 v_add_f32 v132, v132, v108
 v_add_f32 v132, v132, v109
 v_add_f32 v132, v132, v110
 v_add_f32 v132, v132, v111
 v_add_f32 v132, v132, v112
 v_add_f32 v132, v132, v113
 v_add_f32 v132, v132, v114
 v_add_f32 v132, v132, v115
 v_add_f32 v132, v132, v116
 v_add_f32 v132, v132, v117
 v_add_f32 v132, v132, v118
 v_add_f32 v132, v132, v119
 v_add_f32 v132, v132, v120
 v_add_f32 v132, v132, v121
 v_add_f32 v132, v132, v122
 v_add_f32 v132, v132, v123
 v_add_f32 v132, v132, v124
 v_add_f32 v132, v132, v125
 v_add_f32 v132, v132, v126
 v_add_f32 v132, v132, v127
 s_nop 1
 v_add_f32_dpp v132, v132, v132 quad_perm:[1,0,3,2] row_mask:0xf bank_mask:0xf
 s_nop 1
 v_add_f32_dpp v132, v132, v132 quad_perm:[2,3,0,1] row_mask:0xf bank_mask:0xf
 s_nop 1
 v_add_f32_dpp v132, v132, v132 row_half_mirror row_mask:0xf bank_mask:0xf
 v_mul_f32 v132, 0x3b000000, v132
 v_sub_f32 v134, v64, v132
 v_mul_f32 v133, v134, v134
 v_sub_f32 v134, v65, v132
 v_fmac_f32 v133, v134, v134
 v_sub_f32 v134, v66, v132
 v_fmac_f32 v133, v134, v134
 v_sub_f32 v134, v67, v132
 v_fmac_f32 v133, v134, v134
 v_sub_f32 v134, v68, v132
 v_fmac_f32 v133, v134, v134
 v_sub_f32 v134, v69, v132
 v_fmac_f32 v133, v134, v134
 v_sub_f32 v134, v70, v132
 v_fmac_f32 v133, v134, v134
 v_sub_f32 v134, v71, v132
 v_fmac_f32 v133, v134, v134
 v_sub_f32 v134, v72, v132
 v_fmac_f32 v133, v134, v134
 v_sub_f32 v134, v73, v132
 v_fmac_f32 v133, v134, v134
 v_sub_f32 v134, v74, v132
 v_fmac_f32 v133, v134, v134
 v_sub_f32 v134, v75, v132
 v_fmac_f32 v133, v134, v134
 v_sub_f32 v134, v76, v132
 v_fmac_f32 v133, v134, v134
 v_sub_f32 v134, v77, v132
 v_fmac_f32 v133, v134, v134
 v_sub_f32 v134, v78, v132
 v_fmac_f32 v133, v134, v134
 v_sub_f32 v134, v79, v132
 v_fmac_f32 v133, v134, v134
 v_sub_f32 v134, v80, v132
 v_fmac_f32 v133, v134, v134
 v_sub_f32 v134, v81, v132
 v_fmac_f32 v133, v134, v134
 v_sub_f32 v134, v82, v132
 v_fmac_f32 v133, v134, v134
 v_sub_f32 v134, v83, v132
 v_fmac_f32 v133, v134, v134
 v_sub_f32 v134, v84, v132
 v_fmac_f32 v133, v134, v134
 v_sub_f32 v134, v85, v132
 v_fmac_f32 v133, v134, v134
 v_sub_f32 v134, v86, v132
 v_fmac_f32 v133, v134, v134
 v_sub_f32 v134, v87, v132
 v_fmac_f32 v133, v134, v134
 v_sub_f32 v134, v88, v132
 v_fmac_f32 v133, v134, v134
 v_sub_f32 v134, v89, v132
 v_fmac_f32 v133, v134, v134
 v_sub_f32 v134, v90, v132
 v_fmac_f32 v133, v134, v134
 v_sub_f32 v134, v91, v132
 v_fmac_f32 v133, v134, v134
 v_sub_f32 v134, v92, v132
 v_fmac_f32 v133, v134, v134
 v_sub_f32 v134, v93, v132
 v_fmac_f32 v133, v134, v134
 v_sub_f32 v134, v94, v132
 v_fmac_f32 v133, v134, v134
 v_sub_f32 v134, v95, v132
 v_fmac_f32 v133, v134, v134
 v_sub_f32 v134, v96, v132
 v_fmac_f32 v133, v134, v134
 v_sub_f32 v134, v97, v132
 v_fmac_f32 v133, v134, v134
 v_sub_f32 v134, v98, v132
 v_fmac_f32 v133, v134, v134
 v_sub_f32 v134, v99, v132
 v_fmac_f32 v133, v134, v134
 v_sub_f32 v134, v100, v132
 v_fmac_f32 v133, v134, v134
 v_sub_f32 v134, v101, v132
 v_fmac_f32 v133, v134, v134
 v_sub_f32 v134, v102, v132
 v_fmac_f32 v133, v134, v134
 v_sub_f32 v134, v103, v132
 v_fmac_f32 v133, v134, v134
 v_sub_f32 v134, v104, v132
 v_fmac_f32 v133, v134, v134
 v_sub_f32 v134, v105, v132
 v_fmac_f32 v133, v134, v134
 v_sub_f32 v134, v106, v132
 v_fmac_f32 v133, v134, v134
 v_sub_f32 v134, v107, v132
 v_fmac_f32 v133, v134, v134
 v_sub_f32 v134, v108, v132
 v_fmac_f32 v133, v134, v134
 v_sub_f32 v134, v109, v132
 v_fmac_f32 v133, v134, v134
 v_sub_f32 v134, v110, v132
 v_fmac_f32 v133, v134, v134
 v_sub_f32 v134, v111, v132
 v_fmac_f32 v133, v134, v134
 v_sub_f32 v134, v112, v132
 v_fmac_f32 v133, v134, v134
 v_sub_f32 v134, v113, v132
 v_fmac_f32 v133, v134, v134
 v_sub_f32 v134, v114, v132
 v_fmac_f32 v133, v134, v134
 v_sub_f32 v134, v115, v132
 v_fmac_f32 v133, v134, v134
 v_sub_f32 v134, v116, v132
 v_fmac_f32 v133, v134, v134
 v_sub_f32 v134, v117, v132
 v_fmac_f32 v133, v134, v134
 v_sub_f32 v134, v118, v132
 v_fmac_f32 v133, v134, v134
 v_sub_f32 v134, v119, v132
 v_fmac_f32 v133, v134, v134
 v_sub_f32 v134, v120, v132
 v_fmac_f32 v133, v134, v134
 v_sub_f32 v134, v121, v132
 v_fmac_f32 v133, v134, v134
 v_sub_f32 v134, v122, v132
 v_fmac_f32 v133, v134, v134
 v_sub_f32 v134, v123, v132
 v_fmac_f32 v133, v134, v134
 v_sub_f32 v134, v124, v132
 v_fmac_f32 v133, v134, v134
 v_sub_f32 v134, v125, v132
 v_fmac_f32 v133, v134, v134
 v_sub_f32 v134, v126, v132
 v_fmac_f32 v133, v134, v134
 v_sub_f32 v134, v127, v132
 v_fmac_f32 v133, v134, v134
 s_nop 1
 v_add_f32_dpp v133, v133, v133 quad_perm:[1,0,3,2] row_mask:0xf bank_mask:0xf
 s_nop 1
 v_add_f32_dpp v133, v133, v133 quad_perm:[2,3,0,1] row_mask:0xf bank_mask:0xf
 s_nop 1
 v_add_f32_dpp v133, v133, v133 row_half_mirror row_mask:0xf bank_mask:0xf
 v_mul_f32 v133, 0x3b000000, v133
 v_cvt_pk_bf16_f32 v133, v133, v133
 v_and_b32 v133, 0xffff0000, v133
 v_add_f32 v133, 0x3727c5ac, v133
 v_cvt_pk_bf16_f32 v133, v133, v133
 v_and_b32 v133, 0xffff0000, v133
 v_sqrt_f32 v133, v133
 s_nop 0
 v_cvt_pk_bf16_f32 v133, v133, v133
 v_and_b32 v133, 0xffff0000, v133
 v_rcp_f32 v133, v133
 v_cvt_pk_bf16_f32 v132, v132, v132
 v_and_b32 v132, 0xffff0000, v132
 v_sub_f32 v64, v64, v132
 v_sub_f32 v65, v65, v132
 v_cvt_pk_bf16_f32 v134, v64, v65
 v_lshlrev_b32 v64, 16, v134
 v_and_b32 v65, 0xffff0000, v134
 v_mul_f32 v64, v64, v133
 v_mul_f32 v65, v65, v133
 v_cvt_pk_bf16_f32 v8, v64, v65
 v_sub_f32 v66, v66, v132
 v_sub_f32 v67, v67, v132
 v_cvt_pk_bf16_f32 v134, v66, v67
 v_lshlrev_b32 v66, 16, v134
 v_and_b32 v67, 0xffff0000, v134
 v_mul_f32 v66, v66, v133
 v_mul_f32 v67, v67, v133
 v_cvt_pk_bf16_f32 v9, v66, v67
 v_sub_f32 v68, v68, v132
 v_sub_f32 v69, v69, v132
 v_cvt_pk_bf16_f32 v134, v68, v69
 v_lshlrev_b32 v68, 16, v134
 v_and_b32 v69, 0xffff0000, v134
 v_mul_f32 v68, v68, v133
 v_mul_f32 v69, v69, v133
 v_cvt_pk_bf16_f32 v10, v68, v69
 v_sub_f32 v70, v70, v132
 v_sub_f32 v71, v71, v132
 v_cvt_pk_bf16_f32 v134, v70, v71
 v_lshlrev_b32 v70, 16, v134
 v_and_b32 v71, 0xffff0000, v134
 v_mul_f32 v70, v70, v133
 v_mul_f32 v71, v71, v133
 v_cvt_pk_bf16_f32 v11, v70, v71
 ds_write_b128 v130, v[8:11] offset:0
 v_sub_f32 v72, v72, v132
 v_sub_f32 v73, v73, v132
 v_cvt_pk_bf16_f32 v134, v72, v73
 v_lshlrev_b32 v72, 16, v134
 v_and_b32 v73, 0xffff0000, v134
 v_mul_f32 v72, v72, v133
 v_mul_f32 v73, v73, v133
 v_cvt_pk_bf16_f32 v12, v72, v73
 v_sub_f32 v74, v74, v132
 v_sub_f32 v75, v75, v132
 v_cvt_pk_bf16_f32 v134, v74, v75
 v_lshlrev_b32 v74, 16, v134
 v_and_b32 v75, 0xffff0000, v134
 v_mul_f32 v74, v74, v133
 v_mul_f32 v75, v75, v133
 v_cvt_pk_bf16_f32 v13, v74, v75
 v_sub_f32 v76, v76, v132
 v_sub_f32 v77, v77, v132
 v_cvt_pk_bf16_f32 v134, v76, v77
 v_lshlrev_b32 v76, 16, v134
 v_and_b32 v77, 0xffff0000, v134
 v_mul_f32 v76, v76, v133
 v_mul_f32 v77, v77, v133
 v_cvt_pk_bf16_f32 v14, v76, v77
 v_sub_f32 v78, v78, v132
 v_sub_f32 v79, v79, v132
 v_cvt_pk_bf16_f32 v134, v78, v79
 v_lshlrev_b32 v78, 16, v134
 v_and_b32 v79, 0xffff0000, v134
 v_mul_f32 v78, v78, v133
 v_mul_f32 v79, v79, v133
 v_cvt_pk_bf16_f32 v15, v78, v79
 ds_write_b128 v130, v[12:15] offset:2176
 v_sub_f32 v80, v80, v132
 v_sub_f32 v81, v81, v132
 v_cvt_pk_bf16_f32 v134, v80, v81
 v_lshlrev_b32 v80, 16, v134
 v_and_b32 v81, 0xffff0000, v134
 v_mul_f32 v80, v80, v133
 v_mul_f32 v81, v81, v133
 v_cvt_pk_bf16_f32 v16, v80, v81
 v_sub_f32 v82, v82, v132
 v_sub_f32 v83, v83, v132
 v_cvt_pk_bf16_f32 v134, v82, v83
 v_lshlrev_b32 v82, 16, v134
 v_and_b32 v83, 0xffff0000, v134
 v_mul_f32 v82, v82, v133
 v_mul_f32 v83, v83, v133
 v_cvt_pk_bf16_f32 v17, v82, v83
 v_sub_f32 v84, v84, v132
 v_sub_f32 v85, v85, v132
 v_cvt_pk_bf16_f32 v134, v84, v85
 v_lshlrev_b32 v84, 16, v134
 v_and_b32 v85, 0xffff0000, v134
 v_mul_f32 v84, v84, v133
 v_mul_f32 v85, v85, v133
 v_cvt_pk_bf16_f32 v18, v84, v85
 v_sub_f32 v86, v86, v132
 v_sub_f32 v87, v87, v132
 v_cvt_pk_bf16_f32 v134, v86, v87
 v_lshlrev_b32 v86, 16, v134
 v_and_b32 v87, 0xffff0000, v134
 v_mul_f32 v86, v86, v133
 v_mul_f32 v87, v87, v133
 v_cvt_pk_bf16_f32 v19, v86, v87
 ds_write_b128 v130, v[16:19] offset:4352
 v_sub_f32 v88, v88, v132
 v_sub_f32 v89, v89, v132
 v_cvt_pk_bf16_f32 v134, v88, v89
 v_lshlrev_b32 v88, 16, v134
 v_and_b32 v89, 0xffff0000, v134
 v_mul_f32 v88, v88, v133
 v_mul_f32 v89, v89, v133
 v_cvt_pk_bf16_f32 v20, v88, v89
 v_sub_f32 v90, v90, v132
 v_sub_f32 v91, v91, v132
 v_cvt_pk_bf16_f32 v134, v90, v91
 v_lshlrev_b32 v90, 16, v134
 v_and_b32 v91, 0xffff0000, v134
 v_mul_f32 v90, v90, v133
 v_mul_f32 v91, v91, v133
 v_cvt_pk_bf16_f32 v21, v90, v91
 v_sub_f32 v92, v92, v132
 v_sub_f32 v93, v93, v132
 v_cvt_pk_bf16_f32 v134, v92, v93
 v_lshlrev_b32 v92, 16, v134
 v_and_b32 v93, 0xffff0000, v134
 v_mul_f32 v92, v92, v133
 v_mul_f32 v93, v93, v133
 v_cvt_pk_bf16_f32 v22, v92, v93
 v_sub_f32 v94, v94, v132
 v_sub_f32 v95, v95, v132
 v_cvt_pk_bf16_f32 v134, v94, v95
 v_lshlrev_b32 v94, 16, v134
 v_and_b32 v95, 0xffff0000, v134
 v_mul_f32 v94, v94, v133
 v_mul_f32 v95, v95, v133
 v_cvt_pk_bf16_f32 v23, v94, v95
 ds_write_b128 v130, v[20:23] offset:6528
 v_sub_f32 v96, v96, v132
 v_sub_f32 v97, v97, v132
 v_cvt_pk_bf16_f32 v134, v96, v97
 v_lshlrev_b32 v96, 16, v134
 v_and_b32 v97, 0xffff0000, v134
 v_mul_f32 v96, v96, v133
 v_mul_f32 v97, v97, v133
 v_cvt_pk_bf16_f32 v24, v96, v97
 v_sub_f32 v98, v98, v132
 v_sub_f32 v99, v99, v132
 v_cvt_pk_bf16_f32 v134, v98, v99
 v_lshlrev_b32 v98, 16, v134
 v_and_b32 v99, 0xffff0000, v134
 v_mul_f32 v98, v98, v133
 v_mul_f32 v99, v99, v133
 v_cvt_pk_bf16_f32 v25, v98, v99
 v_sub_f32 v100, v100, v132
 v_sub_f32 v101, v101, v132
 v_cvt_pk_bf16_f32 v134, v100, v101
 v_lshlrev_b32 v100, 16, v134
 v_and_b32 v101, 0xffff0000, v134
 v_mul_f32 v100, v100, v133
 v_mul_f32 v101, v101, v133
 v_cvt_pk_bf16_f32 v26, v100, v101
 v_sub_f32 v102, v102, v132
 v_sub_f32 v103, v103, v132
 v_cvt_pk_bf16_f32 v134, v102, v103
 v_lshlrev_b32 v102, 16, v134
 v_and_b32 v103, 0xffff0000, v134
 v_mul_f32 v102, v102, v133
 v_mul_f32 v103, v103, v133
 v_cvt_pk_bf16_f32 v27, v102, v103
 ds_write_b128 v130, v[24:27] offset:8704
 v_sub_f32 v104, v104, v132
 v_sub_f32 v105, v105, v132
 v_cvt_pk_bf16_f32 v134, v104, v105
 v_lshlrev_b32 v104, 16, v134
 v_and_b32 v105, 0xffff0000, v134
 v_mul_f32 v104, v104, v133
 v_mul_f32 v105, v105, v133
 v_cvt_pk_bf16_f32 v28, v104, v105
 v_sub_f32 v106, v106, v132
 v_sub_f32 v107, v107, v132
 v_cvt_pk_bf16_f32 v134, v106, v107
 v_lshlrev_b32 v106, 16, v134
 v_and_b32 v107, 0xffff0000, v134
 v_mul_f32 v106, v106, v133
 v_mul_f32 v107, v107, v133
 v_cvt_pk_bf16_f32 v29, v106, v107
 v_sub_f32 v108, v108, v132
 v_sub_f32 v109, v109, v132
 v_cvt_pk_bf16_f32 v134, v108, v109
 v_lshlrev_b32 v108, 16, v134
 v_and_b32 v109, 0xffff0000, v134
 v_mul_f32 v108, v108, v133
 v_mul_f32 v109, v109, v133
 v_cvt_pk_bf16_f32 v30, v108, v109
 v_sub_f32 v110, v110, v132
 v_sub_f32 v111, v111, v132
 v_cvt_pk_bf16_f32 v134, v110, v111
 v_lshlrev_b32 v110, 16, v134
 v_and_b32 v111, 0xffff0000, v134
 v_mul_f32 v110, v110, v133
 v_mul_f32 v111, v111, v133
 v_cvt_pk_bf16_f32 v31, v110, v111
 ds_write_b128 v130, v[28:31] offset:10880
 v_sub_f32 v112, v112, v132
 v_sub_f32 v113, v113, v132
 v_cvt_pk_bf16_f32 v134, v112, v113
 v_lshlrev_b32 v112, 16, v134
 v_and_b32 v113, 0xffff0000, v134
 v_mul_f32 v112, v112, v133
 v_mul_f32 v113, v113, v133
 v_cvt_pk_bf16_f32 v32, v112, v113
 v_sub_f32 v114, v114, v132
 v_sub_f32 v115, v115, v132
 v_cvt_pk_bf16_f32 v134, v114, v115
 v_lshlrev_b32 v114, 16, v134
 v_and_b32 v115, 0xffff0000, v134
 v_mul_f32 v114, v114, v133
 v_mul_f32 v115, v115, v133
 v_cvt_pk_bf16_f32 v33, v114, v115
 v_sub_f32 v116, v116, v132
 v_sub_f32 v117, v117, v132
 v_cvt_pk_bf16_f32 v134, v116, v117
 v_lshlrev_b32 v116, 16, v134
 v_and_b32 v117, 0xffff0000, v134
 v_mul_f32 v116, v116, v133
 v_mul_f32 v117, v117, v133
 v_cvt_pk_bf16_f32 v34, v116, v117
 v_sub_f32 v118, v118, v132
 v_sub_f32 v119, v119, v132
 v_cvt_pk_bf16_f32 v134, v118, v119
 v_lshlrev_b32 v118, 16, v134
 v_and_b32 v119, 0xffff0000, v134
 v_mul_f32 v118, v118, v133
 v_mul_f32 v119, v119, v133
 v_cvt_pk_bf16_f32 v35, v118, v119
 ds_write_b128 v130, v[32:35] offset:13056
 v_sub_f32 v120, v120, v132
 v_sub_f32 v121, v121, v132
 v_cvt_pk_bf16_f32 v134, v120, v121
 v_lshlrev_b32 v120, 16, v134
 v_and_b32 v121, 0xffff0000, v134
 v_mul_f32 v120, v120, v133
 v_mul_f32 v121, v121, v133
 v_cvt_pk_bf16_f32 v36, v120, v121
 v_sub_f32 v122, v122, v132
 v_sub_f32 v123, v123, v132
 v_cvt_pk_bf16_f32 v134, v122, v123
 v_lshlrev_b32 v122, 16, v134
 v_and_b32 v123, 0xffff0000, v134
 v_mul_f32 v122, v122, v133
 v_mul_f32 v123, v123, v133
 v_cvt_pk_bf16_f32 v37, v122, v123
 v_sub_f32 v124, v124, v132
 v_sub_f32 v125, v125, v132
 v_cvt_pk_bf16_f32 v134, v124, v125
 v_lshlrev_b32 v124, 16, v134
 v_and_b32 v125, 0xffff0000, v134
 v_mul_f32 v124, v124, v133
 v_mul_f32 v125, v125, v133
 v_cvt_pk_bf16_f32 v38, v124, v125
 v_sub_f32 v126, v126, v132
 v_sub_f32 v127, v127, v132
 v_cvt_pk_bf16_f32 v134, v126, v127
 v_lshlrev_b32 v126, 16, v134
 v_and_b32 v127, 0xffff0000, v134
 v_mul_f32 v126, v126, v133
 v_mul_f32 v127, v127, v133
 v_cvt_pk_bf16_f32 v39, v126, v127
 ds_write_b128 v130, v[36:39] offset:15232
 s_lshr_b32 s71, s4, 1
 s_mul_i32 s71, s71, 17408
 v_lshrrev_b32 v134, 4, v140
 v_mul_u32_u24 v134, 272, v134
 v_and_b32 v130, 15, v140
 v_lshl_add_u32 v130, v130, 4, v134
 v_add_u32 v130, s71, v130
 s_and_b32 s71, s4, 1
 s_mul_i32 s71, s71, 8704
 v_add_u32 v130, s71, v130
 v_lshlrev_b32 v131, 4, v140
 s_waitcnt lgkmcnt(0)
 s_barrier
 ds_read_b128 v[8:11], v130 offset:0
 ds_read_b128 v[12:15], v130 offset:1088
 ds_read_b128 v[16:19], v130 offset:2176
 ds_read_b128 v[20:23], v130 offset:3264
 ds_read_b128 v[24:27], v130 offset:4352
 ds_read_b128 v[28:31], v130 offset:5440
 ds_read_b128 v[32:35], v130 offset:6528
 ds_read_b128 v[36:39], v130 offset:7616
 s_waitcnt lgkmcnt(7)
 buffer_store_dwordx4 v[8:11], v131, s[36:39], s70 offen offset:0 sc1
 s_waitcnt lgkmcnt(6)
 buffer_store_dwordx4 v[12:15], v131, s[36:39], s70 offen offset:1024 sc1
 s_waitcnt lgkmcnt(5)
 buffer_store_dwordx4 v[16:19], v131, s[36:39], s70 offen offset:2048 sc1
 s_waitcnt lgkmcnt(4)
 buffer_store_dwordx4 v[20:23], v131, s[36:39], s70 offen offset:3072 sc1
 s_add_u32 s70, s70, 4096
 s_waitcnt lgkmcnt(3)
 buffer_store_dwordx4 v[24:27], v131, s[36:39], s70 offen offset:0 sc1
 s_waitcnt lgkmcnt(2)
 buffer_store_dwordx4 v[28:31], v131, s[36:39], s70 offen offset:1024 sc1
 s_waitcnt lgkmcnt(1)
 buffer_store_dwordx4 v[32:35], v131, s[36:39], s70 offen offset:2048 sc1
 s_waitcnt lgkmcnt(0)
 buffer_store_dwordx4 v[36:39], v131, s[36:39], s70 offen offset:3072 sc1
 s_waitcnt vmcnt(0)
 s_barrier
 s_cmp_lg_u32 s4, 0
 s_cbranch_scc1 L45
 v_mov_b32 v1, 64
 v_mov_b32 v2, 1
 s_mov_b64 exec, 1
 global_atomic_add v1, v2, s[32:33] sc1
 s_mov_b64 exec, -1
L45:
L_ffn_noln:
 v_and_b32 v96, 63, v0
 v_lshlrev_b32 v101, 4, v96
 v_mov_b32 v109, 0
 v_lshrrev_b32 v110, 4, v96
 v_and_b32 v111, 15, v96
 v_lshlrev_b32 v106, 4, v111
 v_lshl_or_b32 v106, v110, 10, v106
 s_lshl_b32 s70, s4, 8
 v_add_u32 v106, s70, v106
 v_and_b32 v107, 3, v96
 v_lshlrev_b32 v107, 3, v107
 v_bfe_u32 v110, v96, 4, 1
 v_lshl_or_b32 v107, v110, 5, v107
 v_bfe_u32 v110, v96, 2, 2
 v_lshl_or_b32 v107, v110, 6, v107
 v_lshrrev_b32 v110, 5, v96
 v_lshl_or_b32 v107, v110, 8, v107
 v_and_b32 v110, 1, v96
 v_lshlrev_b32 v110, 4, v110
 v_mov_b32 v116, 0x3f80
 v_lshlrev_b32 v110, v110, v116
 v_lshrrev_b32 v111, 1, v111
 s_and_b32 s70, s4, 1
 s_lshl_b32 s70, s70, 2
 v_subrev_u32 v111, s70, v111
 s_bitcmp1_b32 s4, 0
 s_cselect_b32 s76, 0, -1
 s_cselect_b32 s77, -1, 0
 v_cmp_eq_u32 vcc, 0, v111
 s_nop 1
 v_cndmask_b32 v116, 0, v110, vcc
 v_cmp_eq_u32 vcc, 1, v111
 s_nop 1
 v_cndmask_b32 v117, 0, v110, vcc
 v_cmp_eq_u32 vcc, 2, v111
 s_nop 1
 v_cndmask_b32 v118, 0, v110, vcc
 v_cmp_eq_u32 vcc, 3, v111
 s_nop 1
 v_cndmask_b32 v119, 0, v110, vcc
 v_mov_b64 v[120:121], -1
 v_mov_b64 v[122:123], -1
 v_cmp_gt_u32 vcc, 32, v96
 s_nop 1
 v_cndmask_b32 v124, 0, -1, vcc
 v_cndmask_b32 v125, 0, -1, vcc
 v_cndmask_b32 v126, 0, -1, vcc
 v_cndmask_b32 v127, 0, -1, vcc
 s_lshl_b32 s61, s56, 8
 s_add_u32 s61, s61, 15863808
 s_lshl_b32 s78, s56, 20
 s_add_u32 s78, s78, 25165824
 s_cmp_eq_u32 s56, 2
 s_cbranch_scc1 L_ffn_w
 s_lshl_b32 s70, s5, 2
 s_add_u32 s70, s70, s61
 s_mov_b64 exec, 1
 buffer_store_dword v109, v109, s[36:39], s70 offen
 s_mov_b64 exec, -1
 s_lshl_b32 s62, s5, 14
 s_add_u32 s62, s62, s78
 s_add_u32 s62, s62, 0
 buffer_store_dwordx4 v[120:123], v106, s[36:39], s62 offen
 s_add_u32 s70, s62, 4096
 buffer_store_dwordx4 v[120:123], v106, s[36:39], s70 offen
 s_add_u32 s70, s62, 8192
 buffer_store_dwordx4 v[120:123], v106, s[36:39], s70 offen
 s_add_u32 s70, s62, 12288
 buffer_store_dwordx4 v[124:127], v106, s[36:39], s70 offen
 s_lshl_b32 s62, s5, 14
 s_add_u32 s62, s62, s78
 s_add_u32 s62, s62, 524288
 buffer_store_dwordx4 v[120:123], v106, s[36:39], s62 offen
 s_add_u32 s70, s62, 4096
 buffer_store_dwordx4 v[120:123], v106, s[36:39], s70 offen
 s_add_u32 s70, s62, 8192
 buffer_store_dwordx4 v[120:123], v106, s[36:39], s70 offen
 s_add_u32 s70, s62, 12288
 buffer_store_dwordx4 v[124:127], v106, s[36:39], s70 offen
 s_waitcnt vmcnt(0)
 s_barrier
 s_cmp_lg_u32 s4, 0
 s_cbranch_scc1 L46
 v_mov_b32 v110, 192
 v_mov_b32 v111, 1
 s_mov_b64 exec, 1
 global_atomic_add v110, v111, s[32:33] sc1
 s_mov_b64 exec, -1
L46:
L_ffn_w:
 s_mov_b32 s40, s24
 s_mov_b32 s41, s25
 s_mov_b32 s42, 0x1c0000
 s_mov_b32 s43, 0x20000
 s_mov_b32 s44, s26
 s_mov_b32 s45, s27
 s_mov_b32 s46, 0x1c0000
 s_mov_b32 s47, 0x20000
 s_mov_b32 s48, s28
 s_mov_b32 s49, s29
 s_mov_b32 s50, 0x1c0000
 s_mov_b32 s51, 0x20000
 s_mov_b32 s52, s30
 s_mov_b32 s53, s31
 s_mov_b32 s54, 0x200000
 s_mov_b32 s55, 0x20000
 s_cmp_ge_u32 s5, 14
 s_cselect_b32 s65, 1, 0
 s_cselect_b32 s70, 14, 0
 s_sub_u32 s64, s5, s70
 v_lshrrev_b32 v110, 2, v96
 v_mul_u32_u24 v110, 1088, v110
 v_and_b32 v111, 3, v96
 v_mul_u32_u24 v111, 272, v111
 s_lshl_b32 s70, s4, 6
 v_add3_u32 v102, v110, v111, s70
 v_and_b32 v110, 15, v96
 v_lshrrev_b32 v111, 4, v96
 v_mul_u32_u24 v112, 272, v111
 v_lshl_add_u32 v103, v110, 4, v112
 s_lshl_b32 s70, s4, 10
 v_add_u32 v104, s70, v101
 s_lshl_b32 s70, s4, 8
 v_lshlrev_b32 v112, 4, v111
 v_lshl_or_b32 v112, v110, 14, v112
 v_add_u32 v105, s70, v112
 s_mov_b32 s69, 0xbfb8aa3b
 v_and_b32 v108, 31, v96
 v_lshlrev_b32 v113, 7, v108
 v_lshlrev_b32 v108, 2, v108
 s_lshr_b32 s70, s4, 1
 s_lshl_b32 s71, s70, 3
 v_add_u32 v114, s71, v101
 s_lshl_b32 s71, s70, 9
 v_add_u32 v107, s71, v107
 s_mov_b32 s59, 0
 s_mov_b32 s60, s58
 s_cmp_ge_u32 s5, 28
 s_cbranch_scc1 L_ffn_go
 v_lshrrev_b32 v110, 4, v96
 s_lshr_b32 s70, s4, 1
 s_lshl_b32 s70, s70, 2
 v_or_b32 v110, s70, v110
 v_bfe_u32 v111, v96, 1, 3
 v_xor_b32 v110, v110, v111
 v_lshlrev_b32 v110, 5, v110
 v_and_b32 v111, 1, v96
 v_lshl_or_b32 v112, v111, 4, v110
 s_and_b32 s70, s4, 1
 s_lshl_b32 s70, s70, 4
 s_lshr_b32 s71, s4, 1
 s_lshl_b32 s71, s71, 2
 s_add_u32 s70, s70, s71
 v_lshrrev_b32 v110, 4, v96
 v_add_u32 v110, s70, v110
 v_lshl_add_u32 v98, v110, 10, v112
 s_and_b32 s70, s4, 1
 s_lshl_b32 s70, s70, 8
 s_lshr_b32 s71, s4, 1
 s_lshl_b32 s71, s71, 2
 s_add_u32 s70, s70, s71
 v_lshrrev_b32 v110, 4, v96
 v_add_u32 v110, s70, v110
 v_mul_u32_u24 v110, 3584, v110
 v_add_u32 v97, v110, v112
 s_lshl_b32 s66, s64, 8
 s_lshl_b32 s67, s64, 17
 v_lshrrev_b32 v110, 4, v96
 v_bfe_u32 v111, v96, 2, 2
 v_lshl_add_u32 v99, v110, 3, v111
 v_lshlrev_b32 v99, 8, v99
 v_and_b32 v110, 1, v110
 v_lshl_or_b32 v110, v110, 2, v111
 v_lshl_or_b32 v99, v110, 5, v99
 v_and_b32 v110, 3, v96
 v_lshl_or_b32 v99, v110, 3, v99
 s_lshl_b32 s70, s4, 6
 v_xor_b32 v100, s70, v99
 s_lshl_b32 s71, s4, 10
 s_lshl_b32 s71, s4, 10
 s_add_u32 m0, s71, 0
 s_add_u32 s70, s66, 0
 buffer_load_dwordx4 v97, s[40:43], s70 offen  lds
 s_add_u32 m0, s71, 4096
 s_add_u32 s70, s66, 28672
 buffer_load_dwordx4 v97, s[40:43], s70 offen  lds
 s_add_u32 m0, s71, 8192
 s_add_u32 s70, s66, 114688
 buffer_load_dwordx4 v97, s[40:43], s70 offen  lds
 s_add_u32 m0, s71, 12288
 s_add_u32 s70, s66, 143360
 buffer_load_dwordx4 v97, s[40:43], s70 offen  lds
 s_waitcnt vmcnt(0)
 s_barrier
 s_lshl_b32 s71, s4, 10
 s_add_u32 m0, s71, 16384
 s_add_u32 s70, s66, 0
 buffer_load_dwordx4 v97, s[44:47], s70 offen  lds
 s_add_u32 m0, s71, 20480
 s_add_u32 s70, s66, 28672
 buffer_load_dwordx4 v97, s[44:47], s70 offen  lds
 s_add_u32 m0, s71, 24576
 s_add_u32 s70, s66, 114688
 buffer_load_dwordx4 v97, s[44:47], s70 offen  lds
 s_add_u32 m0, s71, 28672
 s_add_u32 s70, s66, 143360
 buffer_load_dwordx4 v97, s[44:47], s70 offen  lds
 v_add_u32 v110, 0, v100
 v_xor_b32 v111, 32, v110
 ds_read_b64_tr_b16 a[0:1], v110 offset:0
 ds_read_b64_tr_b16 a[2:3], v110 offset:1024
 ds_read_b64_tr_b16 a[4:5], v110 offset:8192
 ds_read_b64_tr_b16 a[6:7], v110 offset:9216
 ds_read_b64_tr_b16 a[64:65], v111 offset:0
 ds_read_b64_tr_b16 a[66:67], v111 offset:1024
 ds_read_b64_tr_b16 a[68:69], v111 offset:8192
 ds_read_b64_tr_b16 a[70:71], v111 offset:9216
 s_waitcnt lgkmcnt(0)
 s_waitcnt vmcnt(0)
 s_barrier
 s_lshl_b32 s71, s4, 10
 s_add_u32 m0, s71, 32768
 s_add_u32 s70, s66, 229376
 buffer_load_dwordx4 v97, s[40:43], s70 offen  lds
 s_add_u32 m0, s71, 36864
 s_add_u32 s70, s66, 258048
 buffer_load_dwordx4 v97, s[40:43], s70 offen  lds
 s_add_u32 m0, s71, 40960
 s_add_u32 s70, s66, 344064
 buffer_load_dwordx4 v97, s[40:43], s70 offen  lds
 s_add_u32 m0, s71, 45056
 s_add_u32 s70, s66, 372736
 buffer_load_dwordx4 v97, s[40:43], s70 offen  lds
 v_add_u32 v110, 16384, v100
 v_xor_b32 v111, 32, v110
 ds_read_b64_tr_b16 a[128:129], v110 offset:0
 ds_read_b64_tr_b16 a[130:131], v110 offset:1024
 ds_read_b64_tr_b16 a[132:133], v110 offset:8192
 ds_read_b64_tr_b16 a[134:135], v110 offset:9216
 ds_read_b64_tr_b16 a[192:193], v111 offset:0
 ds_read_b64_tr_b16 a[194:195], v111 offset:1024
 ds_read_b64_tr_b16 a[196:197], v111 offset:8192
 ds_read_b64_tr_b16 a[198:199], v111 offset:9216
 s_waitcnt lgkmcnt(0)
 s_waitcnt vmcnt(0)
 s_barrier
 s_lshl_b32 s71, s4, 10
 s_add_u32 m0, s71, 49152
 s_add_u32 s70, s66, 229376
 buffer_load_dwordx4 v97, s[44:47], s70 offen  lds
 s_add_u32 m0, s71, 53248
 s_add_u32 s70, s66, 258048
 buffer_load_dwordx4 v97, s[44:47], s70 offen  lds
 s_add_u32 m0, s71, 57344
 s_add_u32 s70, s66, 344064
 buffer_load_dwordx4 v97, s[44:47], s70 offen  lds
 s_add_u32 m0, s71, 61440
 s_add_u32 s70, s66, 372736
 buffer_load_dwordx4 v97, s[44:47], s70 offen  lds
 v_add_u32 v110, 32768, v100
 v_xor_b32 v111, 32, v110
 ds_read_b64_tr_b16 a[8:9], v110 offset:0
 ds_read_b64_tr_b16 a[10:11], v110 offset:1024
 ds_read_b64_tr_b16 a[12:13], v110 offset:8192
 ds_read_b64_tr_b16 a[14:15], v110 offset:9216
 ds_read_b64_tr_b16 a[72:73], v111 offset:0
 ds_read_b64_tr_b16 a[74:75], v111 offset:1024
 ds_read_b64_tr_b16 a[76:77], v111 offset:8192
 ds_read_b64_tr_b16 a[78:79], v111 offset:9216
 s_waitcnt lgkmcnt(0)
 s_waitcnt vmcnt(0)
 s_barrier
 s_lshl_b32 s71, s4, 10
 s_add_u32 m0, s71, 65536
 s_add_u32 s70, s66, 57344
 buffer_load_dwordx4 v97, s[40:43], s70 offen  lds
 s_add_u32 m0, s71, 69632
 s_add_u32 s70, s66, 86016
 buffer_load_dwordx4 v97, s[40:43], s70 offen  lds
 s_add_u32 m0, s71, 73728
 s_add_u32 s70, s66, 172032
 buffer_load_dwordx4 v97, s[40:43], s70 offen  lds
 s_add_u32 m0, s71, 77824
 s_add_u32 s70, s66, 200704
 buffer_load_dwordx4 v97, s[40:43], s70 offen  lds
 v_add_u32 v110, 49152, v100
 v_xor_b32 v111, 32, v110
 ds_read_b64_tr_b16 a[136:137], v110 offset:0
 ds_read_b64_tr_b16 a[138:139], v110 offset:1024
 ds_read_b64_tr_b16 a[140:141], v110 offset:8192
 ds_read_b64_tr_b16 a[142:143], v110 offset:9216
 ds_read_b64_tr_b16 a[200:201], v111 offset:0
 ds_read_b64_tr_b16 a[202:203], v111 offset:1024
 ds_read_b64_tr_b16 a[204:205], v111 offset:8192
 ds_read_b64_tr_b16 a[206:207], v111 offset:9216
 s_waitcnt lgkmcnt(0)
 s_waitcnt vmcnt(0)
 s_barrier
 s_lshl_b32 s71, s4, 10
 s_add_u32 m0, s71, 81920
 s_add_u32 s70, s66, 57344
 buffer_load_dwordx4 v97, s[44:47], s70 offen  lds
 s_add_u32 m0, s71, 86016
 s_add_u32 s70, s66, 86016
 buffer_load_dwordx4 v97, s[44:47], s70 offen  lds
 s_add_u32 m0, s71, 90112
 s_add_u32 s70, s66, 172032
 buffer_load_dwordx4 v97, s[44:47], s70 offen  lds
 s_add_u32 m0, s71, 94208
 s_add_u32 s70, s66, 200704
 buffer_load_dwordx4 v97, s[44:47], s70 offen  lds
 v_add_u32 v110, 65536, v100
 v_xor_b32 v111, 32, v110
 ds_read_b64_tr_b16 a[16:17], v110 offset:0
 ds_read_b64_tr_b16 a[18:19], v110 offset:1024
 ds_read_b64_tr_b16 a[20:21], v110 offset:8192
 ds_read_b64_tr_b16 a[22:23], v110 offset:9216
 ds_read_b64_tr_b16 a[80:81], v111 offset:0
 ds_read_b64_tr_b16 a[82:83], v111 offset:1024
 ds_read_b64_tr_b16 a[84:85], v111 offset:8192
 ds_read_b64_tr_b16 a[86:87], v111 offset:9216
 s_waitcnt lgkmcnt(0)
 s_waitcnt vmcnt(0)
 s_barrier
 s_lshl_b32 s71, s4, 10
 s_add_u32 m0, s71, 98304
 s_add_u32 s70, s66, 286720
 buffer_load_dwordx4 v97, s[40:43], s70 offen  lds
 s_add_u32 m0, s71, 102400
 s_add_u32 s70, s66, 315392
 buffer_load_dwordx4 v97, s[40:43], s70 offen  lds
 s_add_u32 m0, s71, 106496
 s_add_u32 s70, s66, 401408
 buffer_load_dwordx4 v97, s[40:43], s70 offen  lds
 s_add_u32 m0, s71, 110592
 s_add_u32 s70, s66, 430080
 buffer_load_dwordx4 v97, s[40:43], s70 offen  lds
 v_add_u32 v110, 81920, v100
 v_xor_b32 v111, 32, v110
 ds_read_b64_tr_b16 a[144:145], v110 offset:0
 ds_read_b64_tr_b16 a[146:147], v110 offset:1024
 ds_read_b64_tr_b16 a[148:149], v110 offset:8192
 ds_read_b64_tr_b16 a[150:151], v110 offset:9216
 ds_read_b64_tr_b16 a[208:209], v111 offset:0
 ds_read_b64_tr_b16 a[210:211], v111 offset:1024
 ds_read_b64_tr_b16 a[212:213], v111 offset:8192
 ds_read_b64_tr_b16 a[214:215], v111 offset:9216
 s_waitcnt lgkmcnt(0)
 s_waitcnt vmcnt(0)
 s_barrier
 s_lshl_b32 s71, s4, 10
 s_add_u32 m0, s71, 114688
 s_add_u32 s70, s66, 286720
 buffer_load_dwordx4 v97, s[44:47], s70 offen  lds
 s_add_u32 m0, s71, 118784
 s_add_u32 s70, s66, 315392
 buffer_load_dwordx4 v97, s[44:47], s70 offen  lds
 s_add_u32 m0, s71, 122880
 s_add_u32 s70, s66, 401408
 buffer_load_dwordx4 v97, s[44:47], s70 offen  lds
 s_add_u32 m0, s71, 126976
 s_add_u32 s70, s66, 430080
 buffer_load_dwordx4 v97, s[44:47], s70 offen  lds
 v_add_u32 v110, 98304, v100
 v_xor_b32 v111, 32, v110
 ds_read_b64_tr_b16 a[24:25], v110 offset:0
 ds_read_b64_tr_b16 a[26:27], v110 offset:1024
 ds_read_b64_tr_b16 a[28:29], v110 offset:8192
 ds_read_b64_tr_b16 a[30:31], v110 offset:9216
 ds_read_b64_tr_b16 a[88:89], v111 offset:0
 ds_read_b64_tr_b16 a[90:91], v111 offset:1024
 ds_read_b64_tr_b16 a[92:93], v111 offset:8192
 ds_read_b64_tr_b16 a[94:95], v111 offset:9216
 s_waitcnt lgkmcnt(0)
 s_waitcnt vmcnt(0)
 s_barrier
 s_lshl_b32 s71, s4, 10
 s_add_u32 m0, s71, 131072
 s_add_u32 s70, s66, 458752
 buffer_load_dwordx4 v97, s[40:43], s70 offen  lds
 s_add_u32 m0, s71, 135168
 s_add_u32 s70, s66, 487424
 buffer_load_dwordx4 v97, s[40:43], s70 offen  lds
 s_add_u32 m0, s71, 139264
 s_add_u32 s70, s66, 573440
 buffer_load_dwordx4 v97, s[40:43], s70 offen  lds
 s_add_u32 m0, s71, 143360
 s_add_u32 s70, s66, 602112
 buffer_load_dwordx4 v97, s[40:43], s70 offen  lds
 v_add_u32 v110, 114688, v100
 v_xor_b32 v111, 32, v110
 ds_read_b64_tr_b16 a[152:153], v110 offset:0
 ds_read_b64_tr_b16 a[154:155], v110 offset:1024
 ds_read_b64_tr_b16 a[156:157], v110 offset:8192
 ds_read_b64_tr_b16 a[158:159], v110 offset:9216
 ds_read_b64_tr_b16 a[216:217], v111 offset:0
 ds_read_b64_tr_b16 a[218:219], v111 offset:1024
 ds_read_b64_tr_b16 a[220:221], v111 offset:8192
 ds_read_b64_tr_b16 a[222:223], v111 offset:9216
 s_waitcnt lgkmcnt(0)
 s_waitcnt vmcnt(0)
 s_barrier
 s_lshl_b32 s71, s4, 10
 s_add_u32 m0, s71, 147456
 s_add_u32 s70, s66, 458752
 buffer_load_dwordx4 v97, s[44:47], s70 offen  lds
 s_add_u32 m0, s71, 151552
 s_add_u32 s70, s66, 487424
 buffer_load_dwordx4 v97, s[44:47], s70 offen  lds
 s_add_u32 m0, s71, 155648
 s_add_u32 s70, s66, 573440
 buffer_load_dwordx4 v97, s[44:47], s70 offen  lds
 s_add_u32 m0, s71, 159744
 s_add_u32 s70, s66, 602112
 buffer_load_dwordx4 v97, s[44:47], s70 offen  lds
 v_add_u32 v110, 131072, v100
 v_xor_b32 v111, 32, v110
 ds_read_b64_tr_b16 a[32:33], v110 offset:0
 ds_read_b64_tr_b16 a[34:35], v110 offset:1024
 ds_read_b64_tr_b16 a[36:37], v110 offset:8192
 ds_read_b64_tr_b16 a[38:39], v110 offset:9216
 ds_read_b64_tr_b16 a[96:97], v111 offset:0
 ds_read_b64_tr_b16 a[98:99], v111 offset:1024
 ds_read_b64_tr_b16 a[100:101], v111 offset:8192
 ds_read_b64_tr_b16 a[102:103], v111 offset:9216
 s_waitcnt lgkmcnt(0)
 s_waitcnt vmcnt(0)
 s_barrier
 s_lshl_b32 s71, s4, 10
 s_add_u32 m0, s71, 0
 s_add_u32 s70, s66, 688128
 buffer_load_dwordx4 v97, s[40:43], s70 offen  lds
 s_add_u32 m0, s71, 4096
 s_add_u32 s70, s66, 716800
 buffer_load_dwordx4 v97, s[40:43], s70 offen  lds
 s_add_u32 m0, s71, 8192
 s_add_u32 s70, s66, 802816
 buffer_load_dwordx4 v97, s[40:43], s70 offen  lds
 s_add_u32 m0, s71, 12288
 s_add_u32 s70, s66, 831488
 buffer_load_dwordx4 v97, s[40:43], s70 offen  lds
 v_add_u32 v110, 147456, v100
 v_xor_b32 v111, 32, v110
 ds_read_b64_tr_b16 a[160:161], v110 offset:0
 ds_read_b64_tr_b16 a[162:163], v110 offset:1024
 ds_read_b64_tr_b16 a[164:165], v110 offset:8192
 ds_read_b64_tr_b16 a[166:167], v110 offset:9216
 ds_read_b64_tr_b16 a[224:225], v111 offset:0
 ds_read_b64_tr_b16 a[226:227], v111 offset:1024
 ds_read_b64_tr_b16 a[228:229], v111 offset:8192
 ds_read_b64_tr_b16 a[230:231], v111 offset:9216
 s_waitcnt lgkmcnt(0)
 s_waitcnt vmcnt(0)
 s_barrier
 s_lshl_b32 s71, s4, 10
 s_add_u32 m0, s71, 16384
 s_add_u32 s70, s66, 688128
 buffer_load_dwordx4 v97, s[44:47], s70 offen  lds
 s_add_u32 m0, s71, 20480
 s_add_u32 s70, s66, 716800
 buffer_load_dwordx4 v97, s[44:47], s70 offen  lds
 s_add_u32 m0, s71, 24576
 s_add_u32 s70, s66, 802816
 buffer_load_dwordx4 v97, s[44:47], s70 offen  lds
 s_add_u32 m0, s71, 28672
 s_add_u32 s70, s66, 831488
 buffer_load_dwordx4 v97, s[44:47], s70 offen  lds
 v_add_u32 v110, 0, v100
 v_xor_b32 v111, 32, v110
 ds_read_b64_tr_b16 a[40:41], v110 offset:0
 ds_read_b64_tr_b16 a[42:43], v110 offset:1024
 ds_read_b64_tr_b16 a[44:45], v110 offset:8192
 ds_read_b64_tr_b16 a[46:47], v110 offset:9216
 ds_read_b64_tr_b16 a[104:105], v111 offset:0
 ds_read_b64_tr_b16 a[106:107], v111 offset:1024
 ds_read_b64_tr_b16 a[108:109], v111 offset:8192
 ds_read_b64_tr_b16 a[110:111], v111 offset:9216
 s_waitcnt lgkmcnt(0)
 s_waitcnt vmcnt(0)
 s_barrier
 s_lshl_b32 s71, s4, 10
 s_add_u32 m0, s71, 32768
 s_add_u32 s70, s66, 516096
 buffer_load_dwordx4 v97, s[40:43], s70 offen  lds
 s_add_u32 m0, s71, 36864
 s_add_u32 s70, s66, 544768
 buffer_load_dwordx4 v97, s[40:43], s70 offen  lds
 s_add_u32 m0, s71, 40960
 s_add_u32 s70, s66, 630784
 buffer_load_dwordx4 v97, s[40:43], s70 offen  lds
 s_add_u32 m0, s71, 45056
 s_add_u32 s70, s66, 659456
 buffer_load_dwordx4 v97, s[40:43], s70 offen  lds
 v_add_u32 v110, 16384, v100
 v_xor_b32 v111, 32, v110
 ds_read_b64_tr_b16 a[168:169], v110 offset:0
 ds_read_b64_tr_b16 a[170:171], v110 offset:1024
 ds_read_b64_tr_b16 a[172:173], v110 offset:8192
 ds_read_b64_tr_b16 a[174:175], v110 offset:9216
 ds_read_b64_tr_b16 a[232:233], v111 offset:0
 ds_read_b64_tr_b16 a[234:235], v111 offset:1024
 ds_read_b64_tr_b16 a[236:237], v111 offset:8192
 ds_read_b64_tr_b16 a[238:239], v111 offset:9216
 s_waitcnt lgkmcnt(0)
 s_waitcnt vmcnt(0)
 s_barrier
 s_lshl_b32 s71, s4, 10
 s_add_u32 m0, s71, 49152
 s_add_u32 s70, s66, 516096
 buffer_load_dwordx4 v97, s[44:47], s70 offen  lds
 s_add_u32 m0, s71, 53248
 s_add_u32 s70, s66, 544768
 buffer_load_dwordx4 v97, s[44:47], s70 offen  lds
 s_add_u32 m0, s71, 57344
 s_add_u32 s70, s66, 630784
 buffer_load_dwordx4 v97, s[44:47], s70 offen  lds
 s_add_u32 m0, s71, 61440
 s_add_u32 s70, s66, 659456
 buffer_load_dwordx4 v97, s[44:47], s70 offen  lds
 v_add_u32 v110, 32768, v100
 v_xor_b32 v111, 32, v110
 ds_read_b64_tr_b16 a[48:49], v110 offset:0
 ds_read_b64_tr_b16 a[50:51], v110 offset:1024
 ds_read_b64_tr_b16 a[52:53], v110 offset:8192
 ds_read_b64_tr_b16 a[54:55], v110 offset:9216
 ds_read_b64_tr_b16 a[112:113], v111 offset:0
 ds_read_b64_tr_b16 a[114:115], v111 offset:1024
 ds_read_b64_tr_b16 a[116:117], v111 offset:8192
 ds_read_b64_tr_b16 a[118:119], v111 offset:9216
 s_waitcnt lgkmcnt(0)
 s_waitcnt vmcnt(0)
 s_barrier
 s_lshl_b32 s71, s4, 10
 s_add_u32 m0, s71, 65536
 s_add_u32 s70, s66, 745472
 buffer_load_dwordx4 v97, s[40:43], s70 offen  lds
 s_add_u32 m0, s71, 69632
 s_add_u32 s70, s66, 774144
 buffer_load_dwordx4 v97, s[40:43], s70 offen  lds
 s_add_u32 m0, s71, 73728
 s_add_u32 s70, s66, 860160
 buffer_load_dwordx4 v97, s[40:43], s70 offen  lds
 s_add_u32 m0, s71, 77824
 s_add_u32 s70, s66, 888832
 buffer_load_dwordx4 v97, s[40:43], s70 offen  lds
 v_add_u32 v110, 49152, v100
 v_xor_b32 v111, 32, v110
 ds_read_b64_tr_b16 a[176:177], v110 offset:0
 ds_read_b64_tr_b16 a[178:179], v110 offset:1024
 ds_read_b64_tr_b16 a[180:181], v110 offset:8192
 ds_read_b64_tr_b16 a[182:183], v110 offset:9216
 ds_read_b64_tr_b16 a[240:241], v111 offset:0
 ds_read_b64_tr_b16 a[242:243], v111 offset:1024
 ds_read_b64_tr_b16 a[244:245], v111 offset:8192
 ds_read_b64_tr_b16 a[246:247], v111 offset:9216
 s_waitcnt lgkmcnt(0)
 s_waitcnt vmcnt(0)
 s_barrier
 s_lshl_b32 s71, s4, 10
 s_add_u32 m0, s71, 81920
 s_add_u32 s70, s66, 745472
 buffer_load_dwordx4 v97, s[44:47], s70 offen  lds
 s_add_u32 m0, s71, 86016
 s_add_u32 s70, s66, 774144
 buffer_load_dwordx4 v97, s[44:47], s70 offen  lds
 s_add_u32 m0, s71, 90112
 s_add_u32 s70, s66, 860160
 buffer_load_dwordx4 v97, s[44:47], s70 offen  lds
 s_add_u32 m0, s71, 94208
 s_add_u32 s70, s66, 888832
 buffer_load_dwordx4 v97, s[44:47], s70 offen  lds
 v_add_u32 v110, 65536, v100
 v_xor_b32 v111, 32, v110
 ds_read_b64_tr_b16 a[56:57], v110 offset:0
 ds_read_b64_tr_b16 a[58:59], v110 offset:1024
 ds_read_b64_tr_b16 a[60:61], v110 offset:8192
 ds_read_b64_tr_b16 a[62:63], v110 offset:9216
 ds_read_b64_tr_b16 a[120:121], v111 offset:0
 ds_read_b64_tr_b16 a[122:123], v111 offset:1024
 ds_read_b64_tr_b16 a[124:125], v111 offset:8192
 ds_read_b64_tr_b16 a[126:127], v111 offset:9216
 s_waitcnt lgkmcnt(0)
 s_waitcnt vmcnt(0)
 s_barrier
 s_lshl_b32 s71, s4, 10
 s_add_u32 m0, s71, 98304
 s_add_u32 s70, s67, 0
 buffer_load_dwordx4 v98, s[48:51], s70 offen  lds
 s_add_u32 m0, s71, 102400
 s_add_u32 s70, s67, 8192
 buffer_load_dwordx4 v98, s[48:51], s70 offen  lds
 s_add_u32 m0, s71, 106496
 s_add_u32 s70, s67, 32768
 buffer_load_dwordx4 v98, s[48:51], s70 offen  lds
 s_add_u32 m0, s71, 110592
 s_add_u32 s70, s67, 40960
 buffer_load_dwordx4 v98, s[48:51], s70 offen  lds
 v_add_u32 v110, 81920, v100
 v_xor_b32 v111, 32, v110
 ds_read_b64_tr_b16 a[184:185], v110 offset:0
 ds_read_b64_tr_b16 a[186:187], v110 offset:1024
 ds_read_b64_tr_b16 a[188:189], v110 offset:8192
 ds_read_b64_tr_b16 a[190:191], v110 offset:9216
 ds_read_b64_tr_b16 a[248:249], v111 offset:0
 ds_read_b64_tr_b16 a[250:251], v111 offset:1024
 ds_read_b64_tr_b16 a[252:253], v111 offset:8192
 ds_read_b64_tr_b16 a[254:255], v111 offset:9216
 s_waitcnt lgkmcnt(0)
 s_waitcnt vmcnt(0)
 s_barrier
 s_lshl_b32 s71, s4, 10
 s_add_u32 m0, s71, 114688
 s_add_u32 s70, s67, 256
 buffer_load_dwordx4 v98, s[48:51], s70 offen  lds
 s_add_u32 m0, s71, 118784
 s_add_u32 s70, s67, 8448
 buffer_load_dwordx4 v98, s[48:51], s70 offen  lds
 s_add_u32 m0, s71, 122880
 s_add_u32 s70, s67, 33024
 buffer_load_dwordx4 v98, s[48:51], s70 offen  lds
 s_add_u32 m0, s71, 126976
 s_add_u32 s70, s67, 41216
 buffer_load_dwordx4 v98, s[48:51], s70 offen  lds
 s_cmp_lg_u32 s4, 0
 s_cbranch_scc1 L47
 v_add_u32 v110, 98304, v99
 v_xor_b32 v111, 0, v110
 ds_read_b64_tr_b16 v[128:129], v111 offset:0
 ds_read_b64_tr_b16 v[130:131], v111 offset:1024
 ds_read_b64_tr_b16 v[132:133], v111 offset:8192
 ds_read_b64_tr_b16 v[134:135], v111 offset:9216
 v_xor_b32 v111, 32, v110
 ds_read_b64_tr_b16 v[144:145], v111 offset:0
 ds_read_b64_tr_b16 v[146:147], v111 offset:1024
 ds_read_b64_tr_b16 v[148:149], v111 offset:8192
 ds_read_b64_tr_b16 v[150:151], v111 offset:9216
 v_xor_b32 v111, 64, v110
 ds_read_b64_tr_b16 v[160:161], v111 offset:0
 ds_read_b64_tr_b16 v[162:163], v111 offset:1024
 ds_read_b64_tr_b16 v[164:165], v111 offset:8192
 ds_read_b64_tr_b16 v[166:167], v111 offset:9216
 v_xor_b32 v111, 96, v110
 ds_read_b64_tr_b16 v[176:177], v111 offset:0
 ds_read_b64_tr_b16 v[178:179], v111 offset:1024
 ds_read_b64_tr_b16 v[180:181], v111 offset:8192
 ds_read_b64_tr_b16 v[182:183], v111 offset:9216
 v_xor_b32 v111, 128, v110
 ds_read_b64_tr_b16 v[192:193], v111 offset:0
 ds_read_b64_tr_b16 v[194:195], v111 offset:1024
 ds_read_b64_tr_b16 v[196:197], v111 offset:8192
 ds_read_b64_tr_b16 v[198:199], v111 offset:9216
 v_xor_b32 v111, 160, v110
 ds_read_b64_tr_b16 v[208:209], v111 offset:0
 ds_read_b64_tr_b16 v[210:211], v111 offset:1024
 ds_read_b64_tr_b16 v[212:213], v111 offset:8192
 ds_read_b64_tr_b16 v[214:215], v111 offset:9216
 v_xor_b32 v111, 192, v110
 ds_read_b64_tr_b16 v[224:225], v111 offset:0
 ds_read_b64_tr_b16 v[226:227], v111 offset:1024
 ds_read_b64_tr_b16 v[228:229], v111 offset:8192
 ds_read_b64_tr_b16 v[230:231], v111 offset:9216
 v_xor_b32 v111, 224, v110
 ds_read_b64_tr_b16 v[240:241], v111 offset:0
 ds_read_b64_tr_b16 v[242:243], v111 offset:1024
 ds_read_b64_tr_b16 v[244:245], v111 offset:8192
 ds_read_b64_tr_b16 v[246:247], v111 offset:9216
L47:
 s_waitcnt lgkmcnt(0)
 s_waitcnt vmcnt(0)
 s_barrier
 s_lshl_b32 s71, s4, 10
 s_add_u32 m0, s71, 131072
 s_add_u32 s70, s67, 512
 buffer_load_dwordx4 v98, s[48:51], s70 offen  lds
 s_add_u32 m0, s71, 135168
 s_add_u32 s70, s67, 8704
 buffer_load_dwordx4 v98, s[48:51], s70 offen  lds
 s_add_u32 m0, s71, 139264
 s_add_u32 s70, s67, 33280
 buffer_load_dwordx4 v98, s[48:51], s70 offen  lds
 s_add_u32 m0, s71, 143360
 s_add_u32 s70, s67, 41472
 buffer_load_dwordx4 v98, s[48:51], s70 offen  lds
 s_cmp_lg_u32 s4, 1
 s_cbranch_scc1 L48
 v_add_u32 v110, 114688, v99
 v_xor_b32 v111, 0, v110
 ds_read_b64_tr_b16 v[128:129], v111 offset:0
 ds_read_b64_tr_b16 v[130:131], v111 offset:1024
 ds_read_b64_tr_b16 v[132:133], v111 offset:8192
 ds_read_b64_tr_b16 v[134:135], v111 offset:9216
 v_xor_b32 v111, 32, v110
 ds_read_b64_tr_b16 v[144:145], v111 offset:0
 ds_read_b64_tr_b16 v[146:147], v111 offset:1024
 ds_read_b64_tr_b16 v[148:149], v111 offset:8192
 ds_read_b64_tr_b16 v[150:151], v111 offset:9216
 v_xor_b32 v111, 64, v110
 ds_read_b64_tr_b16 v[160:161], v111 offset:0
 ds_read_b64_tr_b16 v[162:163], v111 offset:1024
 ds_read_b64_tr_b16 v[164:165], v111 offset:8192
 ds_read_b64_tr_b16 v[166:167], v111 offset:9216
 v_xor_b32 v111, 96, v110
 ds_read_b64_tr_b16 v[176:177], v111 offset:0
 ds_read_b64_tr_b16 v[178:179], v111 offset:1024
 ds_read_b64_tr_b16 v[180:181], v111 offset:8192
 ds_read_b64_tr_b16 v[182:183], v111 offset:9216
 v_xor_b32 v111, 128, v110
 ds_read_b64_tr_b16 v[192:193], v111 offset:0
 ds_read_b64_tr_b16 v[194:195], v111 offset:1024
 ds_read_b64_tr_b16 v[196:197], v111 offset:8192
 ds_read_b64_tr_b16 v[198:199], v111 offset:9216
 v_xor_b32 v111, 160, v110
 ds_read_b64_tr_b16 v[208:209], v111 offset:0
 ds_read_b64_tr_b16 v[210:211], v111 offset:1024
 ds_read_b64_tr_b16 v[212:213], v111 offset:8192
 ds_read_b64_tr_b16 v[214:215], v111 offset:9216
 v_xor_b32 v111, 192, v110
 ds_read_b64_tr_b16 v[224:225], v111 offset:0
 ds_read_b64_tr_b16 v[226:227], v111 offset:1024
 ds_read_b64_tr_b16 v[228:229], v111 offset:8192
 ds_read_b64_tr_b16 v[230:231], v111 offset:9216
 v_xor_b32 v111, 224, v110
 ds_read_b64_tr_b16 v[240:241], v111 offset:0
 ds_read_b64_tr_b16 v[242:243], v111 offset:1024
 ds_read_b64_tr_b16 v[244:245], v111 offset:8192
 ds_read_b64_tr_b16 v[246:247], v111 offset:9216
L48:
 s_waitcnt lgkmcnt(0)
 s_waitcnt vmcnt(0)
 s_barrier
 s_lshl_b32 s71, s4, 10
 s_add_u32 m0, s71, 147456
 s_add_u32 s70, s67, 768
 buffer_load_dwordx4 v98, s[48:51], s70 offen  lds
 s_add_u32 m0, s71, 151552
 s_add_u32 s70, s67, 8960
 buffer_load_dwordx4 v98, s[48:51], s70 offen  lds
 s_add_u32 m0, s71, 155648
 s_add_u32 s70, s67, 33536
 buffer_load_dwordx4 v98, s[48:51], s70 offen  lds
 s_add_u32 m0, s71, 159744
 s_add_u32 s70, s67, 41728
 buffer_load_dwordx4 v98, s[48:51], s70 offen  lds
 s_cmp_lg_u32 s4, 2
 s_cbranch_scc1 L49
 v_add_u32 v110, 131072, v99
 v_xor_b32 v111, 0, v110
 ds_read_b64_tr_b16 v[128:129], v111 offset:0
 ds_read_b64_tr_b16 v[130:131], v111 offset:1024
 ds_read_b64_tr_b16 v[132:133], v111 offset:8192
 ds_read_b64_tr_b16 v[134:135], v111 offset:9216
 v_xor_b32 v111, 32, v110
 ds_read_b64_tr_b16 v[144:145], v111 offset:0
 ds_read_b64_tr_b16 v[146:147], v111 offset:1024
 ds_read_b64_tr_b16 v[148:149], v111 offset:8192
 ds_read_b64_tr_b16 v[150:151], v111 offset:9216
 v_xor_b32 v111, 64, v110
 ds_read_b64_tr_b16 v[160:161], v111 offset:0
 ds_read_b64_tr_b16 v[162:163], v111 offset:1024
 ds_read_b64_tr_b16 v[164:165], v111 offset:8192
 ds_read_b64_tr_b16 v[166:167], v111 offset:9216
 v_xor_b32 v111, 96, v110
 ds_read_b64_tr_b16 v[176:177], v111 offset:0
 ds_read_b64_tr_b16 v[178:179], v111 offset:1024
 ds_read_b64_tr_b16 v[180:181], v111 offset:8192
 ds_read_b64_tr_b16 v[182:183], v111 offset:9216
 v_xor_b32 v111, 128, v110
 ds_read_b64_tr_b16 v[192:193], v111 offset:0
 ds_read_b64_tr_b16 v[194:195], v111 offset:1024
 ds_read_b64_tr_b16 v[196:197], v111 offset:8192
 ds_read_b64_tr_b16 v[198:199], v111 offset:9216
 v_xor_b32 v111, 160, v110
 ds_read_b64_tr_b16 v[208:209], v111 offset:0
 ds_read_b64_tr_b16 v[210:211], v111 offset:1024
 ds_read_b64_tr_b16 v[212:213], v111 offset:8192
 ds_read_b64_tr_b16 v[214:215], v111 offset:9216
 v_xor_b32 v111, 192, v110
 ds_read_b64_tr_b16 v[224:225], v111 offset:0
 ds_read_b64_tr_b16 v[226:227], v111 offset:1024
 ds_read_b64_tr_b16 v[228:229], v111 offset:8192
 ds_read_b64_tr_b16 v[230:231], v111 offset:9216
 v_xor_b32 v111, 224, v110
 ds_read_b64_tr_b16 v[240:241], v111 offset:0
 ds_read_b64_tr_b16 v[242:243], v111 offset:1024
 ds_read_b64_tr_b16 v[244:245], v111 offset:8192
 ds_read_b64_tr_b16 v[246:247], v111 offset:9216
L49:
 s_waitcnt lgkmcnt(0)
 s_waitcnt vmcnt(0)
 s_barrier
 s_lshl_b32 s71, s4, 10
 s_add_u32 m0, s71, 0
 s_add_u32 s70, s67, 65536
 buffer_load_dwordx4 v98, s[48:51], s70 offen  lds
 s_add_u32 m0, s71, 4096
 s_add_u32 s70, s67, 73728
 buffer_load_dwordx4 v98, s[48:51], s70 offen  lds
 s_add_u32 m0, s71, 8192
 s_add_u32 s70, s67, 98304
 buffer_load_dwordx4 v98, s[48:51], s70 offen  lds
 s_add_u32 m0, s71, 12288
 s_add_u32 s70, s67, 106496
 buffer_load_dwordx4 v98, s[48:51], s70 offen  lds
 s_cmp_lg_u32 s4, 3
 s_cbranch_scc1 L50
 v_add_u32 v110, 147456, v99
 v_xor_b32 v111, 0, v110
 ds_read_b64_tr_b16 v[128:129], v111 offset:0
 ds_read_b64_tr_b16 v[130:131], v111 offset:1024
 ds_read_b64_tr_b16 v[132:133], v111 offset:8192
 ds_read_b64_tr_b16 v[134:135], v111 offset:9216
 v_xor_b32 v111, 32, v110
 ds_read_b64_tr_b16 v[144:145], v111 offset:0
 ds_read_b64_tr_b16 v[146:147], v111 offset:1024
 ds_read_b64_tr_b16 v[148:149], v111 offset:8192
 ds_read_b64_tr_b16 v[150:151], v111 offset:9216
 v_xor_b32 v111, 64, v110
 ds_read_b64_tr_b16 v[160:161], v111 offset:0
 ds_read_b64_tr_b16 v[162:163], v111 offset:1024
 ds_read_b64_tr_b16 v[164:165], v111 offset:8192
 ds_read_b64_tr_b16 v[166:167], v111 offset:9216
 v_xor_b32 v111, 96, v110
 ds_read_b64_tr_b16 v[176:177], v111 offset:0
 ds_read_b64_tr_b16 v[178:179], v111 offset:1024
 ds_read_b64_tr_b16 v[180:181], v111 offset:8192
 ds_read_b64_tr_b16 v[182:183], v111 offset:9216
 v_xor_b32 v111, 128, v110
 ds_read_b64_tr_b16 v[192:193], v111 offset:0
 ds_read_b64_tr_b16 v[194:195], v111 offset:1024
 ds_read_b64_tr_b16 v[196:197], v111 offset:8192
 ds_read_b64_tr_b16 v[198:199], v111 offset:9216
 v_xor_b32 v111, 160, v110
 ds_read_b64_tr_b16 v[208:209], v111 offset:0
 ds_read_b64_tr_b16 v[210:211], v111 offset:1024
 ds_read_b64_tr_b16 v[212:213], v111 offset:8192
 ds_read_b64_tr_b16 v[214:215], v111 offset:9216
 v_xor_b32 v111, 192, v110
 ds_read_b64_tr_b16 v[224:225], v111 offset:0
 ds_read_b64_tr_b16 v[226:227], v111 offset:1024
 ds_read_b64_tr_b16 v[228:229], v111 offset:8192
 ds_read_b64_tr_b16 v[230:231], v111 offset:9216
 v_xor_b32 v111, 224, v110
 ds_read_b64_tr_b16 v[240:241], v111 offset:0
 ds_read_b64_tr_b16 v[242:243], v111 offset:1024
 ds_read_b64_tr_b16 v[244:245], v111 offset:8192
 ds_read_b64_tr_b16 v[246:247], v111 offset:9216
L50:
 s_waitcnt lgkmcnt(0)
 s_waitcnt vmcnt(0)
 s_barrier
 s_lshl_b32 s71, s4, 10
 s_add_u32 m0, s71, 16384
 s_add_u32 s70, s67, 65792
 buffer_load_dwordx4 v98, s[48:51], s70 offen  lds
 s_add_u32 m0, s71, 20480
 s_add_u32 s70, s67, 73984
 buffer_load_dwordx4 v98, s[48:51], s70 offen  lds
 s_add_u32 m0, s71, 24576
 s_add_u32 s70, s67, 98560
 buffer_load_dwordx4 v98, s[48:51], s70 offen  lds
 s_add_u32 m0, s71, 28672
 s_add_u32 s70, s67, 106752
 buffer_load_dwordx4 v98, s[48:51], s70 offen  lds
 s_cmp_lg_u32 s4, 0
 s_cbranch_scc1 L51
 v_add_u32 v110, 0, v99
 v_xor_b32 v111, 0, v110
 ds_read_b64_tr_b16 v[136:137], v111 offset:0
 ds_read_b64_tr_b16 v[138:139], v111 offset:1024
 ds_read_b64_tr_b16 v[140:141], v111 offset:8192
 ds_read_b64_tr_b16 v[142:143], v111 offset:9216
 v_xor_b32 v111, 32, v110
 ds_read_b64_tr_b16 v[152:153], v111 offset:0
 ds_read_b64_tr_b16 v[154:155], v111 offset:1024
 ds_read_b64_tr_b16 v[156:157], v111 offset:8192
 ds_read_b64_tr_b16 v[158:159], v111 offset:9216
 v_xor_b32 v111, 64, v110
 ds_read_b64_tr_b16 v[168:169], v111 offset:0
 ds_read_b64_tr_b16 v[170:171], v111 offset:1024
 ds_read_b64_tr_b16 v[172:173], v111 offset:8192
 ds_read_b64_tr_b16 v[174:175], v111 offset:9216
 v_xor_b32 v111, 96, v110
 ds_read_b64_tr_b16 v[184:185], v111 offset:0
 ds_read_b64_tr_b16 v[186:187], v111 offset:1024
 ds_read_b64_tr_b16 v[188:189], v111 offset:8192
 ds_read_b64_tr_b16 v[190:191], v111 offset:9216
 v_xor_b32 v111, 128, v110
 ds_read_b64_tr_b16 v[200:201], v111 offset:0
 ds_read_b64_tr_b16 v[202:203], v111 offset:1024
 ds_read_b64_tr_b16 v[204:205], v111 offset:8192
 ds_read_b64_tr_b16 v[206:207], v111 offset:9216
 v_xor_b32 v111, 160, v110
 ds_read_b64_tr_b16 v[216:217], v111 offset:0
 ds_read_b64_tr_b16 v[218:219], v111 offset:1024
 ds_read_b64_tr_b16 v[220:221], v111 offset:8192
 ds_read_b64_tr_b16 v[222:223], v111 offset:9216
 v_xor_b32 v111, 192, v110
 ds_read_b64_tr_b16 v[232:233], v111 offset:0
 ds_read_b64_tr_b16 v[234:235], v111 offset:1024
 ds_read_b64_tr_b16 v[236:237], v111 offset:8192
 ds_read_b64_tr_b16 v[238:239], v111 offset:9216
 v_xor_b32 v111, 224, v110
 ds_read_b64_tr_b16 v[248:249], v111 offset:0
 ds_read_b64_tr_b16 v[250:251], v111 offset:1024
 ds_read_b64_tr_b16 v[252:253], v111 offset:8192
 ds_read_b64_tr_b16 v[254:255], v111 offset:9216
L51:
 s_waitcnt lgkmcnt(0)
 s_waitcnt vmcnt(0)
 s_barrier
 s_lshl_b32 s71, s4, 10
 s_add_u32 m0, s71, 32768
 s_add_u32 s70, s67, 66048
 buffer_load_dwordx4 v98, s[48:51], s70 offen  lds
 s_add_u32 m0, s71, 36864
 s_add_u32 s70, s67, 74240
 buffer_load_dwordx4 v98, s[48:51], s70 offen  lds
 s_add_u32 m0, s71, 40960
 s_add_u32 s70, s67, 98816
 buffer_load_dwordx4 v98, s[48:51], s70 offen  lds
 s_add_u32 m0, s71, 45056
 s_add_u32 s70, s67, 107008
 buffer_load_dwordx4 v98, s[48:51], s70 offen  lds
 s_cmp_lg_u32 s4, 1
 s_cbranch_scc1 L52
 v_add_u32 v110, 16384, v99
 v_xor_b32 v111, 0, v110
 ds_read_b64_tr_b16 v[136:137], v111 offset:0
 ds_read_b64_tr_b16 v[138:139], v111 offset:1024
 ds_read_b64_tr_b16 v[140:141], v111 offset:8192
 ds_read_b64_tr_b16 v[142:143], v111 offset:9216
 v_xor_b32 v111, 32, v110
 ds_read_b64_tr_b16 v[152:153], v111 offset:0
 ds_read_b64_tr_b16 v[154:155], v111 offset:1024
 ds_read_b64_tr_b16 v[156:157], v111 offset:8192
 ds_read_b64_tr_b16 v[158:159], v111 offset:9216
 v_xor_b32 v111, 64, v110
 ds_read_b64_tr_b16 v[168:169], v111 offset:0
 ds_read_b64_tr_b16 v[170:171], v111 offset:1024
 ds_read_b64_tr_b16 v[172:173], v111 offset:8192
 ds_read_b64_tr_b16 v[174:175], v111 offset:9216
 v_xor_b32 v111, 96, v110
 ds_read_b64_tr_b16 v[184:185], v111 offset:0
 ds_read_b64_tr_b16 v[186:187], v111 offset:1024
 ds_read_b64_tr_b16 v[188:189], v111 offset:8192
 ds_read_b64_tr_b16 v[190:191], v111 offset:9216
 v_xor_b32 v111, 128, v110
 ds_read_b64_tr_b16 v[200:201], v111 offset:0
 ds_read_b64_tr_b16 v[202:203], v111 offset:1024
 ds_read_b64_tr_b16 v[204:205], v111 offset:8192
 ds_read_b64_tr_b16 v[206:207], v111 offset:9216
 v_xor_b32 v111, 160, v110
 ds_read_b64_tr_b16 v[216:217], v111 offset:0
 ds_read_b64_tr_b16 v[218:219], v111 offset:1024
 ds_read_b64_tr_b16 v[220:221], v111 offset:8192
 ds_read_b64_tr_b16 v[222:223], v111 offset:9216
 v_xor_b32 v111, 192, v110
 ds_read_b64_tr_b16 v[232:233], v111 offset:0
 ds_read_b64_tr_b16 v[234:235], v111 offset:1024
 ds_read_b64_tr_b16 v[236:237], v111 offset:8192
 ds_read_b64_tr_b16 v[238:239], v111 offset:9216
 v_xor_b32 v111, 224, v110
 ds_read_b64_tr_b16 v[248:249], v111 offset:0
 ds_read_b64_tr_b16 v[250:251], v111 offset:1024
 ds_read_b64_tr_b16 v[252:253], v111 offset:8192
 ds_read_b64_tr_b16 v[254:255], v111 offset:9216
L52:
 s_waitcnt lgkmcnt(0)
 s_waitcnt vmcnt(0)
 s_barrier
 s_lshl_b32 s71, s4, 10
 s_add_u32 m0, s71, 49152
 s_add_u32 s70, s67, 66304
 buffer_load_dwordx4 v98, s[48:51], s70 offen  lds
 s_add_u32 m0, s71, 53248
 s_add_u32 s70, s67, 74496
 buffer_load_dwordx4 v98, s[48:51], s70 offen  lds
 s_add_u32 m0, s71, 57344
 s_add_u32 s70, s67, 99072
 buffer_load_dwordx4 v98, s[48:51], s70 offen  lds
 s_add_u32 m0, s71, 61440
 s_add_u32 s70, s67, 107264
 buffer_load_dwordx4 v98, s[48:51], s70 offen  lds
 s_cmp_lg_u32 s4, 2
 s_cbranch_scc1 L53
 v_add_u32 v110, 32768, v99
 v_xor_b32 v111, 0, v110
 ds_read_b64_tr_b16 v[136:137], v111 offset:0
 ds_read_b64_tr_b16 v[138:139], v111 offset:1024
 ds_read_b64_tr_b16 v[140:141], v111 offset:8192
 ds_read_b64_tr_b16 v[142:143], v111 offset:9216
 v_xor_b32 v111, 32, v110
 ds_read_b64_tr_b16 v[152:153], v111 offset:0
 ds_read_b64_tr_b16 v[154:155], v111 offset:1024
 ds_read_b64_tr_b16 v[156:157], v111 offset:8192
 ds_read_b64_tr_b16 v[158:159], v111 offset:9216
 v_xor_b32 v111, 64, v110
 ds_read_b64_tr_b16 v[168:169], v111 offset:0
 ds_read_b64_tr_b16 v[170:171], v111 offset:1024
 ds_read_b64_tr_b16 v[172:173], v111 offset:8192
 ds_read_b64_tr_b16 v[174:175], v111 offset:9216
 v_xor_b32 v111, 96, v110
 ds_read_b64_tr_b16 v[184:185], v111 offset:0
 ds_read_b64_tr_b16 v[186:187], v111 offset:1024
 ds_read_b64_tr_b16 v[188:189], v111 offset:8192
 ds_read_b64_tr_b16 v[190:191], v111 offset:9216
 v_xor_b32 v111, 128, v110
 ds_read_b64_tr_b16 v[200:201], v111 offset:0
 ds_read_b64_tr_b16 v[202:203], v111 offset:1024
 ds_read_b64_tr_b16 v[204:205], v111 offset:8192
 ds_read_b64_tr_b16 v[206:207], v111 offset:9216
 v_xor_b32 v111, 160, v110
 ds_read_b64_tr_b16 v[216:217], v111 offset:0
 ds_read_b64_tr_b16 v[218:219], v111 offset:1024
 ds_read_b64_tr_b16 v[220:221], v111 offset:8192
 ds_read_b64_tr_b16 v[222:223], v111 offset:9216
 v_xor_b32 v111, 192, v110
 ds_read_b64_tr_b16 v[232:233], v111 offset:0
 ds_read_b64_tr_b16 v[234:235], v111 offset:1024
 ds_read_b64_tr_b16 v[236:237], v111 offset:8192
 ds_read_b64_tr_b16 v[238:239], v111 offset:9216
 v_xor_b32 v111, 224, v110
 ds_read_b64_tr_b16 v[248:249], v111 offset:0
 ds_read_b64_tr_b16 v[250:251], v111 offset:1024
 ds_read_b64_tr_b16 v[252:253], v111 offset:8192
 ds_read_b64_tr_b16 v[254:255], v111 offset:9216
L53:
 s_waitcnt lgkmcnt(0)
 s_waitcnt vmcnt(0)
 s_barrier
 s_cmp_lg_u32 s4, 3
 s_cbranch_scc1 L54
 v_add_u32 v110, 49152, v99
 v_xor_b32 v111, 0, v110
 ds_read_b64_tr_b16 v[136:137], v111 offset:0
 ds_read_b64_tr_b16 v[138:139], v111 offset:1024
 ds_read_b64_tr_b16 v[140:141], v111 offset:8192
 ds_read_b64_tr_b16 v[142:143], v111 offset:9216
 v_xor_b32 v111, 32, v110
 ds_read_b64_tr_b16 v[152:153], v111 offset:0
 ds_read_b64_tr_b16 v[154:155], v111 offset:1024
 ds_read_b64_tr_b16 v[156:157], v111 offset:8192
 ds_read_b64_tr_b16 v[158:159], v111 offset:9216
 v_xor_b32 v111, 64, v110
 ds_read_b64_tr_b16 v[168:169], v111 offset:0
 ds_read_b64_tr_b16 v[170:171], v111 offset:1024
 ds_read_b64_tr_b16 v[172:173], v111 offset:8192
 ds_read_b64_tr_b16 v[174:175], v111 offset:9216
 v_xor_b32 v111, 96, v110
 ds_read_b64_tr_b16 v[184:185], v111 offset:0
 ds_read_b64_tr_b16 v[186:187], v111 offset:1024
 ds_read_b64_tr_b16 v[188:189], v111 offset:8192
 ds_read_b64_tr_b16 v[190:191], v111 offset:9216
 v_xor_b32 v111, 128, v110
 ds_read_b64_tr_b16 v[200:201], v111 offset:0
 ds_read_b64_tr_b16 v[202:203], v111 offset:1024
 ds_read_b64_tr_b16 v[204:205], v111 offset:8192
 ds_read_b64_tr_b16 v[206:207], v111 offset:9216
 v_xor_b32 v111, 160, v110
 ds_read_b64_tr_b16 v[216:217], v111 offset:0
 ds_read_b64_tr_b16 v[218:219], v111 offset:1024
 ds_read_b64_tr_b16 v[220:221], v111 offset:8192
 ds_read_b64_tr_b16 v[222:223], v111 offset:9216
 v_xor_b32 v111, 192, v110
 ds_read_b64_tr_b16 v[232:233], v111 offset:0
 ds_read_b64_tr_b16 v[234:235], v111 offset:1024
 ds_read_b64_tr_b16 v[236:237], v111 offset:8192
 ds_read_b64_tr_b16 v[238:239], v111 offset:9216
 v_xor_b32 v111, 224, v110
 ds_read_b64_tr_b16 v[248:249], v111 offset:0
 ds_read_b64_tr_b16 v[250:251], v111 offset:1024
 ds_read_b64_tr_b16 v[252:253], v111 offset:8192
 ds_read_b64_tr_b16 v[254:255], v111 offset:9216
L54:
 s_waitcnt lgkmcnt(0)
L_ffn_go:
 s_cmp_lg_u32 s4, 0
 s_cbranch_scc1 L55
 s_mov_b32 s7, 524288
 v_mov_b32 v110, 192
 s_branch L57
L56:
 s_sleep 4
L57:
 global_load_dword v111, v110, s[32:33] sc1
 s_sub_u32 s7, s7, 1
 s_cbranch_scc1 L_abort
 s_waitcnt vmcnt(0)
 v_readfirstlane_b32 s70, v111
 s_cmp_lt_u32 s70, 256
 s_cbranch_scc1 L56
L55:
 s_barrier
 s_and_b32 s73, s60, 1
 s_lshl_b32 s73, s73, 12
 s_add_u32 s73, s73, 15794176
 s_lshr_b32 s74, s60, 1
 s_add_u32 s74, s74, 1
 s_lshl_b32 s75, s60, 1
 s_add_u32 s75, s75, s65
 s_lshl_b32 s75, s75, 2
 s_add_u32 s75, s75, s4
 s_lshl_b32 s75, s75, 12
 s_add_u32 s75, s75, 2097152
 s_cmp_gt_u32 s60, 63
 s_cselect_b32 s74, 0, s74
 s_mov_b32 s7, 524288
L58:
 buffer_load_dword v97, v113, s[36:39], s73 offen sc1
 s_sub_u32 s7, s7, 1
 s_cbranch_scc1 L_abort
 s_waitcnt vmcnt(0)
 v_cmp_gt_u32 vcc, s74, v97
 s_cbranch_vccnz L58
 v_mov_b64 v[80:81], -1
 v_mov_b64 v[82:83], -1
 v_mov_b64 v[84:85], -1
 v_mov_b64 v[86:87], -1
 v_mov_b64 v[88:89], -1
 v_mov_b64 v[90:91], -1
 v_mov_b64 v[92:93], -1
 v_mov_b64 v[94:95], -1
L_ffn_loop:
 s_and_b32 s70, s59, 1
 s_lshl_b32 s70, s70, 19
 s_add_u32 s70, s70, s78
 s_lshl_b32 s71, s5, 14
 s_add_u32 s62, s70, s71
 s_lshl_b32 s71, s64, 10
 s_add_u32 s63, s70, s71
 s_lshl_b32 s71, s65, 18
 s_add_u32 s63, s63, s71
 s_lshl_b32 s68, s60, 5
 s_add_u32 s68, s68, s5
 s_lshl_b32 s68, s68, 10
 s_add_u32 s59, s59, 1
 s_cmp_ge_u32 s60, 98
 s_addc_u32 s60, s60, 2
 s_cmp_ge_u32 s5, 28
 s_cbranch_scc1 L_ffn_idle
 s_mov_b32 s7, 524288
 s_branch L_ffn_x1
L_ffn_x:
 buffer_load_dwordx4 v[80:83], v101, s[36:39], s75 offen offset:0 sc1
 buffer_load_dwordx4 v[84:87], v101, s[36:39], s75 offen offset:1024 sc1
 buffer_load_dwordx4 v[88:91], v101, s[36:39], s75 offen offset:2048 sc1
 buffer_load_dwordx4 v[92:95], v101, s[36:39], s75 offen offset:3072 sc1
 s_sub_u32 s7, s7, 1
 s_cbranch_scc1 L_abort
L_ffn_x1:
 s_waitcnt vmcnt(3)
 ds_write_b128 v102, v[80:83] offset:0
 v_max3_u32 v110, v80, v80, v81
 v_max3_u32 v110, v110, v82, v83
 s_waitcnt vmcnt(2)
 ds_write_b128 v102, v[84:87] offset:16
 v_max3_u32 v110, v110, v84, v85
 v_max3_u32 v110, v110, v86, v87
 s_waitcnt vmcnt(1)
 ds_write_b128 v102, v[88:91] offset:32
 v_max3_u32 v110, v110, v88, v89
 v_max3_u32 v110, v110, v90, v91
 s_waitcnt vmcnt(0)
 ds_write_b128 v102, v[92:95] offset:48
 v_max3_u32 v110, v110, v92, v93
 v_max3_u32 v110, v110, v94, v95
 v_cmp_eq_u32 vcc, -1, v110
 s_cbranch_vccnz L_ffn_x
 s_waitcnt lgkmcnt(0)
 s_barrier
 ds_read_b128 v[16:19], v103 offset:0
 ds_read_b128 v[20:23], v103 offset:1088
 ds_read_b128 v[24:27], v103 offset:2176
 s_cmp_lg_u32 s4, 0
 s_cbranch_scc1 L59
 s_sub_u32 s71, s59, 1
 v_mov_b32 v110, s71
 s_lshl_b32 s70, s5, 2
 s_add_u32 s70, s70, s61
 s_mov_b64 exec, 1
 buffer_store_dword v110, v109, s[36:39], s70 offen
 s_mov_b64 exec, -1
L59:
 s_add_u32 s71, s68, 4194304
 s_waitcnt lgkmcnt(2)
 v_mfma_f32_16x16x32_bf16 v[0:3], a[0:3], v[16:19], 0
 ds_read_b128 v[28:31], v103 offset:3264
 v_mfma_f32_16x16x32_bf16 v[8:11], a[128:131], v[16:19], 0
 v_mfma_f32_16x16x32_bf16 v[4:7], a[64:67], v[16:19], 0
 v_mfma_f32_16x16x32_bf16 v[12:15], a[192:195], v[16:19], 0
 s_waitcnt lgkmcnt(2)
 v_mfma_f32_16x16x32_bf16 v[0:3], a[4:7], v[20:23], v[0:3]
 ds_read_b128 v[16:19], v103 offset:4352
 v_mfma_f32_16x16x32_bf16 v[8:11], a[132:135], v[20:23], v[8:11]
 buffer_load_dwordx2 v[72:73], v114, s[36:39], s71 offen sc1
 v_mfma_f32_16x16x32_bf16 v[4:7], a[68:71], v[20:23], v[4:7]
 v_mfma_f32_16x16x32_bf16 v[12:15], a[196:199], v[20:23], v[12:15]
 s_waitcnt lgkmcnt(2)
 v_mfma_f32_16x16x32_bf16 v[0:3], a[8:11], v[24:27], v[0:3]
 ds_read_b128 v[20:23], v103 offset:5440
 v_mfma_f32_16x16x32_bf16 v[8:11], a[136:139], v[24:27], v[8:11]
 s_and_b32 s73, s60, 1
 s_lshl_b32 s73, s73, 12
 s_add_u32 s73, s73, 15794176
 s_lshr_b32 s74, s60, 1
 s_add_u32 s74, s74, 1
 s_lshl_b32 s75, s60, 1
 s_add_u32 s75, s75, s65
 s_lshl_b32 s75, s75, 2
 s_add_u32 s75, s75, s4
 s_lshl_b32 s75, s75, 12
 s_add_u32 s75, s75, 2097152
 s_cmp_gt_u32 s60, 63
 s_cselect_b32 s74, 0, s74
 v_mfma_f32_16x16x32_bf16 v[4:7], a[72:75], v[24:27], v[4:7]
 v_mfma_f32_16x16x32_bf16 v[12:15], a[200:203], v[24:27], v[12:15]
 s_waitcnt lgkmcnt(2)
 v_mfma_f32_16x16x32_bf16 v[0:3], a[12:15], v[28:31], v[0:3]
 ds_read_b128 v[24:27], v103 offset:6528
 v_mfma_f32_16x16x32_bf16 v[8:11], a[140:143], v[28:31], v[8:11]
 buffer_load_dword v97, v113, s[36:39], s73 offen sc1
 v_mfma_f32_16x16x32_bf16 v[4:7], a[76:79], v[28:31], v[4:7]
 v_mfma_f32_16x16x32_bf16 v[12:15], a[204:207], v[28:31], v[12:15]
 s_waitcnt lgkmcnt(2)
 v_mfma_f32_16x16x32_bf16 v[0:3], a[16:19], v[16:19], v[0:3]
 ds_read_b128 v[28:31], v103 offset:7616
 v_mfma_f32_16x16x32_bf16 v[8:11], a[144:147], v[16:19], v[8:11]
 s_sub_u32 s72, s59, 2
 s_max_i32 s72, s72, 0
 buffer_load_dword v115, v108, s[36:39], s61 offen sc1
 v_mfma_f32_16x16x32_bf16 v[4:7], a[80:83], v[16:19], v[4:7]
 v_mfma_f32_16x16x32_bf16 v[12:15], a[208:211], v[16:19], v[12:15]
 s_waitcnt lgkmcnt(2)
 v_mfma_f32_16x16x32_bf16 v[0:3], a[20:23], v[20:23], v[0:3]
 ds_read_b128 v[16:19], v103 offset:8704
 v_mfma_f32_16x16x32_bf16 v[8:11], a[148:151], v[20:23], v[8:11]
 v_mfma_f32_16x16x32_bf16 v[4:7], a[84:87], v[20:23], v[4:7]
 v_mfma_f32_16x16x32_bf16 v[12:15], a[212:215], v[20:23], v[12:15]
 s_waitcnt lgkmcnt(2)
 v_mfma_f32_16x16x32_bf16 v[0:3], a[24:27], v[24:27], v[0:3]
 ds_read_b128 v[20:23], v103 offset:9792
 v_mfma_f32_16x16x32_bf16 v[8:11], a[152:155], v[24:27], v[8:11]
 v_mfma_f32_16x16x32_bf16 v[4:7], a[88:91], v[24:27], v[4:7]
 v_mfma_f32_16x16x32_bf16 v[12:15], a[216:219], v[24:27], v[12:15]
 s_waitcnt lgkmcnt(2)
 v_mfma_f32_16x16x32_bf16 v[0:3], a[28:31], v[28:31], v[0:3]
 ds_read_b128 v[24:27], v103 offset:10880
 v_mfma_f32_16x16x32_bf16 v[8:11], a[156:159], v[28:31], v[8:11]
 v_mfma_f32_16x16x32_bf16 v[4:7], a[92:95], v[28:31], v[4:7]
 v_mfma_f32_16x16x32_bf16 v[12:15], a[220:223], v[28:31], v[12:15]
 s_waitcnt lgkmcnt(2)
 v_mfma_f32_16x16x32_bf16 v[0:3], a[32:35], v[16:19], v[0:3]
 ds_read_b128 v[28:31], v103 offset:11968
 v_mfma_f32_16x16x32_bf16 v[8:11], a[160:163], v[16:19], v[8:11]
 v_mfma_f32_16x16x32_bf16 v[4:7], a[96:99], v[16:19], v[4:7]
 v_mfma_f32_16x16x32_bf16 v[12:15], a[224:227], v[16:19], v[12:15]
 s_waitcnt lgkmcnt(2)
 v_mfma_f32_16x16x32_bf16 v[0:3], a[36:39], v[20:23], v[0:3]
 ds_read_b128 v[16:19], v103 offset:13056
 v_mfma_f32_16x16x32_bf16 v[8:11], a[164:167], v[20:23], v[8:11]
 v_mfma_f32_16x16x32_bf16 v[4:7], a[100:103], v[20:23], v[4:7]
 v_mfma_f32_16x16x32_bf16 v[12:15], a[228:231], v[20:23], v[12:15]
 s_waitcnt lgkmcnt(2)
 v_mfma_f32_16x16x32_bf16 v[0:3], a[40:43], v[24:27], v[0:3]
 ds_read_b128 v[20:23], v103 offset:14144
 v_mfma_f32_16x16x32_bf16 v[8:11], a[168:171], v[24:27], v[8:11]
 v_mfma_f32_16x16x32_bf16 v[4:7], a[104:107], v[24:27], v[4:7]
 v_mfma_f32_16x16x32_bf16 v[12:15], a[232:235], v[24:27], v[12:15]
 s_waitcnt lgkmcnt(2)
 v_mfma_f32_16x16x32_bf16 v[0:3], a[44:47], v[28:31], v[0:3]
 ds_read_b128 v[24:27], v103 offset:15232
 v_mfma_f32_16x16x32_bf16 v[8:11], a[172:175], v[28:31], v[8:11]
 v_mfma_f32_16x16x32_bf16 v[4:7], a[108:111], v[28:31], v[4:7]
 v_mfma_f32_16x16x32_bf16 v[12:15], a[236:239], v[28:31], v[12:15]
 s_waitcnt lgkmcnt(2)
 v_mfma_f32_16x16x32_bf16 v[0:3], a[48:51], v[16:19], v[0:3]
 ds_read_b128 v[28:31], v103 offset:16320
 v_mfma_f32_16x16x32_bf16 v[8:11], a[176:179], v[16:19], v[8:11]
 v_mfma_f32_16x16x32_bf16 v[4:7], a[112:115], v[16:19], v[4:7]
 v_mfma_f32_16x16x32_bf16 v[12:15], a[240:243], v[16:19], v[12:15]
 s_waitcnt lgkmcnt(2)
 v_mfma_f32_16x16x32_bf16 v[0:3], a[52:55], v[20:23], v[0:3]
 v_mfma_f32_16x16x32_bf16 v[8:11], a[180:183], v[20:23], v[8:11]
 v_mfma_f32_16x16x32_bf16 v[4:7], a[116:119], v[20:23], v[4:7]
 v_mfma_f32_16x16x32_bf16 v[12:15], a[244:247], v[20:23], v[12:15]
 s_waitcnt lgkmcnt(1)
 v_mfma_f32_16x16x32_bf16 v[0:3], a[56:59], v[24:27], v[0:3]
 v_mfma_f32_16x16x32_bf16 v[8:11], a[184:187], v[24:27], v[8:11]
 v_mfma_f32_16x16x32_bf16 v[4:7], a[120:123], v[24:27], v[4:7]
 v_mfma_f32_16x16x32_bf16 v[12:15], a[248:251], v[24:27], v[12:15]
 s_waitcnt lgkmcnt(0)
 v_mfma_f32_16x16x32_bf16 v[0:3], a[60:63], v[28:31], v[0:3]
 v_mfma_f32_16x16x32_bf16 v[8:11], a[188:191], v[28:31], v[8:11]
 v_mfma_f32_16x16x32_bf16 v[4:7], a[124:127], v[28:31], v[4:7]
 v_mfma_f32_16x16x32_bf16 v[12:15], a[252:255], v[28:31], v[12:15]
 s_waitcnt vmcnt(0)
 v_cmp_gt_u32 vcc, s74, v97
 v_cmp_gt_u32 s[80:81], s72, v115
 v_mul_f32 v16, s69, v0
 v_exp_f32 v16, v16
 v_mul_f32 v17, s69, v1
 v_exp_f32 v17, v17
 v_mul_f32 v18, s69, v2
 v_exp_f32 v18, v18
 v_mul_f32 v19, s69, v3
 v_exp_f32 v19, v19
 v_mul_f32 v20, s69, v4
 v_exp_f32 v20, v20
 v_mul_f32 v21, s69, v5
 v_exp_f32 v21, v21
 v_mul_f32 v22, s69, v6
 v_exp_f32 v22, v22
 v_mul_f32 v23, s69, v7
 v_exp_f32 v23, v23
 v_mul_f32 v8, v8, v0
 v_add_f32 v16, 1.0, v16
 v_rcp_f32 v16, v16
 v_mul_f32 v9, v9, v1
 v_add_f32 v17, 1.0, v17
 v_rcp_f32 v17, v17
 v_mul_f32 v10, v10, v2
 v_add_f32 v18, 1.0, v18
 v_rcp_f32 v18, v18
 v_mul_f32 v11, v11, v3
 v_add_f32 v19, 1.0, v19
 v_rcp_f32 v19, v19
 v_mul_f32 v12, v12, v4
 v_add_f32 v20, 1.0, v20
 v_rcp_f32 v20, v20
 v_mul_f32 v13, v13, v5
 v_add_f32 v21, 1.0, v21
 v_rcp_f32 v21, v21
 v_mul_f32 v14, v14, v6
 v_add_f32 v22, 1.0, v22
 v_rcp_f32 v22, v22
 v_mul_f32 v15, v15, v7
 v_add_f32 v23, 1.0, v23
 v_rcp_f32 v23, v23
 v_mul_f32 v8, v8, v16
 v_mul_f32 v9, v9, v17
 v_mul_f32 v10, v10, v18
 v_mul_f32 v11, v11, v19
 v_mul_f32 v12, v12, v20
 v_mul_f32 v13, v13, v21
 v_mul_f32 v14, v14, v22
 v_mul_f32 v15, v15, v23
 v_cvt_pk_bf16_f32 v24, v8, v9
 v_cvt_pk_bf16_f32 v25, v10, v11
 v_cvt_pk_bf16_f32 v26, v12, v13
 v_cvt_pk_bf16_f32 v27, v14, v15
 ds_write_b128 v104, v[24:27] offset:18432
 s_or_b64 vcc, vcc, s[80:81]
 s_cbranch_vccz L_ffn_fok
 s_mov_b32 s7, 524288
L60:
 buffer_load_dword v97, v113, s[36:39], s73 offen sc1
 s_sub_u32 s7, s7, 1
 s_cbranch_scc1 L_abort
 s_waitcnt vmcnt(0)
 v_cmp_gt_u32 vcc, s74, v97
 s_cbranch_vccnz L60
 s_mov_b32 s7, 524288
L61:
 buffer_load_dword v115, v108, s[36:39], s61 offen sc1
 s_sub_u32 s7, s7, 1
 s_cbranch_scc1 L_abort
 s_waitcnt vmcnt(0)
 v_cmp_gt_u32 vcc, s72, v115
 s_cbranch_vccnz L61
L_ffn_fok:
 s_waitcnt lgkmcnt(0)
 s_barrier
 ds_read_b128 v[16:19], v101 offset:18432
 ds_read_b128 v[20:23], v101 offset:19456
 ds_read_b128 v[24:27], v101 offset:20480
 ds_read_b128 v[28:31], v101 offset:21504
 s_waitcnt lgkmcnt(3)
 v_mfma_f32_16x16x32_bf16 v[32:35], v[128:131], v[16:19], 0
 s_waitcnt lgkmcnt(2)
 v_mfma_f32_16x16x32_bf16 v[32:35], v[132:135], v[20:23], v[32:35]
 s_waitcnt lgkmcnt(1)
 v_mfma_f32_16x16x32_bf16 v[32:35], v[136:139], v[24:27], v[32:35]
 s_waitcnt lgkmcnt(0)
 v_mfma_f32_16x16x32_bf16 v[32:35], v[140:143], v[28:31], v[32:35]
 v_mfma_f32_16x16x32_bf16 v[36:39], v[144:147], v[16:19], 0
 v_mfma_f32_16x16x32_bf16 v[36:39], v[148:151], v[20:23], v[36:39]
 v_mfma_f32_16x16x32_bf16 v[36:39], v[152:155], v[24:27], v[36:39]
 v_mfma_f32_16x16x32_bf16 v[36:39], v[156:159], v[28:31], v[36:39]
 v_mfma_f32_16x16x32_bf16 v[40:43], v[160:163], v[16:19], 0
 v_mfma_f32_16x16x32_bf16 v[40:43], v[164:167], v[20:23], v[40:43]
 v_mfma_f32_16x16x32_bf16 v[40:43], v[168:171], v[24:27], v[40:43]
 v_cvt_pk_bf16_f32 v0, v32, v33
 v_mfma_f32_16x16x32_bf16 v[40:43], v[172:175], v[28:31], v[40:43]
 v_cvt_pk_bf16_f32 v1, v34, v35
 v_mfma_f32_16x16x32_bf16 v[44:47], v[176:179], v[16:19], 0
 v_cvt_pk_bf16_f32 v2, v36, v37
 v_mfma_f32_16x16x32_bf16 v[44:47], v[180:183], v[20:23], v[44:47]
 v_cvt_pk_bf16_f32 v3, v38, v39
 v_mfma_f32_16x16x32_bf16 v[44:47], v[184:187], v[24:27], v[44:47]
 buffer_store_dwordx4 v[0:3], v105, s[36:39], s63 offen offset:0
 v_mfma_f32_16x16x32_bf16 v[44:47], v[188:191], v[28:31], v[44:47]
 v_mfma_f32_16x16x32_bf16 v[48:51], v[192:195], v[16:19], 0
 v_mfma_f32_16x16x32_bf16 v[48:51], v[196:199], v[20:23], v[48:51]
 v_mfma_f32_16x16x32_bf16 v[48:51], v[200:203], v[24:27], v[48:51]
 v_cvt_pk_bf16_f32 v4, v40, v41
 v_mfma_f32_16x16x32_bf16 v[48:51], v[204:207], v[28:31], v[48:51]
 v_cvt_pk_bf16_f32 v5, v42, v43
 v_mfma_f32_16x16x32_bf16 v[52:55], v[208:211], v[16:19], 0
 v_cvt_pk_bf16_f32 v6, v44, v45
 v_mfma_f32_16x16x32_bf16 v[52:55], v[212:215], v[20:23], v[52:55]
 v_cvt_pk_bf16_f32 v7, v46, v47
 v_mfma_f32_16x16x32_bf16 v[52:55], v[216:219], v[24:27], v[52:55]
 buffer_store_dwordx4 v[4:7], v105, s[36:39], s63 offen offset:64
 v_mfma_f32_16x16x32_bf16 v[52:55], v[220:223], v[28:31], v[52:55]
 v_mfma_f32_16x16x32_bf16 v[56:59], v[224:227], v[16:19], 0
 v_mfma_f32_16x16x32_bf16 v[56:59], v[228:231], v[20:23], v[56:59]
 v_mfma_f32_16x16x32_bf16 v[56:59], v[232:235], v[24:27], v[56:59]
 v_cvt_pk_bf16_f32 v0, v48, v49
 v_mfma_f32_16x16x32_bf16 v[56:59], v[236:239], v[28:31], v[56:59]
 v_cvt_pk_bf16_f32 v1, v50, v51
 v_mfma_f32_16x16x32_bf16 v[60:63], v[240:243], v[16:19], 0
 v_cvt_pk_bf16_f32 v2, v52, v53
 v_mfma_f32_16x16x32_bf16 v[60:63], v[244:247], v[20:23], v[60:63]
 v_cvt_pk_bf16_f32 v3, v54, v55
 v_mfma_f32_16x16x32_bf16 v[60:63], v[248:251], v[24:27], v[60:63]
 buffer_store_dwordx4 v[0:3], v105, s[36:39], s63 offen offset:128
 v_mfma_f32_16x16x32_bf16 v[60:63], v[252:255], v[28:31], v[60:63]
 v_cvt_pk_bf16_f32 v4, v56, v57
 v_cvt_pk_bf16_f32 v5, v58, v59
 s_nop 4
 v_cvt_pk_bf16_f32 v6, v60, v61
 v_cvt_pk_bf16_f32 v7, v62, v63
 buffer_store_dwordx4 v[4:7], v105, s[36:39], s63 offen offset:192
 s_branch L_ffn_row
L_ffn_idle:
 s_waitcnt vmcnt(0)
 s_barrier
 s_cmp_lg_u32 s4, 0
 s_cbranch_scc1 L62
 s_sub_u32 s71, s59, 1
 v_mov_b32 v110, s71
 s_lshl_b32 s70, s5, 2
 s_add_u32 s70, s70, s61
 s_mov_b64 exec, 1
 buffer_store_dword v110, v109, s[36:39], s70 offen
 s_mov_b64 exec, -1
L62:
 s_and_b32 s73, s60, 1
 s_lshl_b32 s73, s73, 12
 s_add_u32 s73, s73, 15794176
 s_lshr_b32 s74, s60, 1
 s_add_u32 s74, s74, 1
 s_lshl_b32 s75, s60, 1
 s_add_u32 s75, s75, s65
 s_lshl_b32 s75, s75, 2
 s_add_u32 s75, s75, s4
 s_lshl_b32 s75, s75, 12
 s_add_u32 s75, s75, 2097152
 s_cmp_gt_u32 s60, 63
 s_cselect_b32 s74, 0, s74
 s_mov_b32 s7, 524288
L63:
 buffer_load_dword v97, v113, s[36:39], s73 offen sc1
 s_sub_u32 s7, s7, 1
 s_cbranch_scc1 L_abort
 s_waitcnt vmcnt(0)
 v_cmp_gt_u32 vcc, s74, v97
 s_cbranch_vccnz L63
 s_add_u32 s71, s68, 4194304
 s_mov_b32 s7, 524288
 s_branch L_ffn_h0
L_ffn_h:
L_ffn_h0:
 buffer_load_dwordx2 v[72:73], v114, s[36:39], s71 offen sc1
 s_sub_u32 s7, s7, 1
 s_cbranch_scc1 L_abort
 s_waitcnt vmcnt(0)
 v_max_u32 v110, v72, v73
 v_cmp_eq_u32 vcc, -1, v110
 s_cbranch_vccnz L_ffn_h
L_ffn_row:
 s_mov_b32 s7, 524288
 s_mov_b64 vcc, -1
L64:
 s_mov_b64 exec, vcc
 buffer_load_dwordx4 v[16:19], v106, s[36:39], s62 offen sc1
 s_add_u32 s70, s62, 4096
 buffer_load_dwordx4 v[20:23], v106, s[36:39], s70 offen sc1
 s_add_u32 s70, s62, 8192
 buffer_load_dwordx4 v[24:27], v106, s[36:39], s70 offen sc1
 s_add_u32 s70, s62, 12288
 buffer_load_dwordx4 v[28:31], v106, s[36:39], s70 offen sc1
 s_mov_b64 exec, -1
 s_sub_u32 s7, s7, 1
 s_cbranch_scc1 L_abort
 s_waitcnt vmcnt(3)
 v_mfma_f32_16x16x32_bf16 v[64:67], v[116:119], v[16:19], 0
 v_max3_u32 v110, v16, v16, v17
 v_max3_u32 v110, v110, v18, v19
 s_waitcnt vmcnt(2)
 v_mfma_f32_16x16x32_bf16 v[64:67], v[116:119], v[20:23], v[64:67]
 v_max3_u32 v110, v110, v20, v21
 v_max3_u32 v110, v110, v22, v23
 s_waitcnt vmcnt(1)
 v_mfma_f32_16x16x32_bf16 v[64:67], v[116:119], v[24:27], v[64:67]
 v_max3_u32 v110, v110, v24, v25
 v_max3_u32 v110, v110, v26, v27
 s_waitcnt vmcnt(0)
 v_mfma_f32_16x16x32_bf16 v[64:67], v[116:119], v[28:31], v[64:67]
 v_max3_u32 v110, v110, v28, v29
 v_max3_u32 v110, v110, v30, v31
 v_cmp_eq_u32 vcc, -1, v110
 s_cbranch_vccnz L64
 s_mov_b32 s7, 524288
 s_add_u32 s71, s68, 4194304
L_ffn_h2:
 v_max_u32 v110, v72, v73
 v_cmp_eq_u32 vcc, -1, v110
 s_cbranch_vccz L_ffn_hok
 buffer_load_dwordx2 v[72:73], v114, s[36:39], s71 offen sc1
 s_sub_u32 s7, s7, 1
 s_cbranch_scc1 L_abort
 s_waitcnt vmcnt(0)
 s_branch L_ffn_h2
L_ffn_hok:
 v_and_b32 v69, 0xffff0000, v72
 v_lshlrev_b32 v68, 16, v72
 v_and_b32 v71, 0xffff0000, v73
 v_lshlrev_b32 v70, 16, v73
 v_cvt_pk_bf16_f32 v72, v64, v65
 v_cvt_pk_bf16_f32 v73, v66, v67
 v_and_b32 v65, 0xffff0000, v72
 v_lshlrev_b32 v64, 16, v72
 v_and_b32 v67, 0xffff0000, v73
 v_lshlrev_b32 v66, 16, v73
 v_add_f32 v64, v64, v68
 v_add_f32 v65, v65, v69
 v_add_f32 v66, v66, v70
 v_add_f32 v67, v67, v71
 v_cvt_pk_bf16_f32 v72, v64, v65
 v_cvt_pk_bf16_f32 v73, v66, v67
 s_mov_b64 exec, s[76:77]
 buffer_store_dwordx2 v[72:73], v107, s[52:55], s68 offen
 s_mov_b64 exec, -1
 s_cmp_ge_u32 s60, 64
 s_cbranch_scc1 L_ffn_end
 buffer_store_dwordx4 v[120:123], v106, s[36:39], s62 offen
 s_add_u32 s70, s62, 4096
 buffer_store_dwordx4 v[120:123], v106, s[36:39], s70 offen
 s_add_u32 s70, s62, 8192
 buffer_store_dwordx4 v[120:123], v106, s[36:39], s70 offen
 s_add_u32 s70, s62, 12288
 buffer_store_dwordx4 v[124:127], v106, s[36:39], s70 offen
 s_cmp_ge_u32 s5, 28
 s_cbranch_scc1 L_ffn_loop
 buffer_load_dwordx4 v[80:83], v101, s[36:39], s75 offen offset:0 sc1
 buffer_load_dwordx4 v[84:87], v101, s[36:39], s75 offen offset:1024 sc1
 buffer_load_dwordx4 v[88:91], v101, s[36:39], s75 offen offset:2048 sc1
 buffer_load_dwordx4 v[92:95], v101, s[36:39], s75 offen offset:3072 sc1
 s_branch L_ffn_loop
L_ffn_end:
 s_endpgm
L_end:
.section .rodata,"a"
.p2align 6
.amdhsa_kernel sequential_preLN__memory_aug_recurrent_mem_tr__glu_gated_swiglu__prompt_kernel
  .amdhsa_next_free_vgpr 512
  .amdhsa_next_free_sgpr 102
  .amdhsa_accum_offset 256
  .amdhsa_group_segment_fixed_size 0
  .amdhsa_kernarg_size 112
  .amdhsa_user_sgpr_count 2
  .amdhsa_user_sgpr_kernarg_segment_ptr 1
  .amdhsa_system_sgpr_workgroup_id_x 1
  .amdhsa_float_denorm_mode_32 3
.end_amdhsa_kernel
```
